```python
import torch

def _softmax(x, axis=-1):
    return torch.softmax(x, dim=axis)
def _gelu(x):
    return torch.nn.functional.gelu(x, approximate="tanh")
def _silu(x):
    return torch.nn.functional.silu(x)
def _sigmoid(x):
    return torch.sigmoid(x)
def _layernorm(x, axis=-1, eps=1e-5):
    m = x.mean(dim=axis, keepdim=True)
    v = x.var(dim=axis, keepdim=True, unbiased=False)
    return (x - m) / torch.sqrt(v + eps)
def _scatter_add(tgt, idx, src, axis=0):
    return tgt.clone().index_add_(axis, idx, src)
def _segment_sum(src, seg, n):
    out = torch.zeros((n,) + src.shape[1:], dtype=src.dtype)
    return out.index_add_(0, seg, src)
def _pad(x, pw):
    flat = tuple(v for pair in reversed(pw) for v in pair)
    return torch.nn.functional.pad(x, flat)

kernel_name = 'standalone__modern_conv_block_convnext_v2__vision'

def setup_inputs():

    _w = (lambda a: (lambda t: t.to(torch.bfloat16) if t.is_floating_point() else t)(torch.as_tensor(a)))
    H = W = 224
    C = 192
    K = 3
    return {
        "x": _w((lambda *s: torch.randn(*s, dtype=torch.bfloat16) * 0.05)(1, H, W, C)),
        "dw": _w((lambda *s: torch.randn(*s, dtype=torch.bfloat16) * 0.05)(K, K, C)),
        "w1": _w((lambda *s: torch.randn(*s, dtype=torch.bfloat16) * 0.05)(C, 4 * C)),
        "w2": _w((lambda *s: torch.randn(*s, dtype=torch.bfloat16) * 0.05)(4 * C, C)),
        "grn_gamma": _w((lambda *s: torch.randn(*s, dtype=torch.bfloat16) * 0.05)(4 * C)),
        "grn_beta": _w((lambda *s: torch.randn(*s, dtype=torch.bfloat16) * 0.05)(4 * C)),
    }

def reference(x, dw, w1, w2, grn_gamma, grn_beta):
    B, H, W, C = x.shape
    K = dw.shape[0]
    pad = K // 2
    xp = _pad(x, ((0,0),(pad,pad),(pad,pad),(0,0)))
    out = torch.zeros_like(x)
    for i in range(K):
        for j in range(K):
            out = out + xp[:, i:i+H, j:j+W, :] * dw[i, j][None, None, None, :]
    h = _layernorm(out, axis=-1)
    h = torch.einsum('bhwc,ce->bhwe', h, w1)
    h = _gelu(h)
    gx = torch.sqrt((h * h).sum(axis=(1, 2), keepdims=True) + 1e-6)
    nx = gx / (gx.mean(axis=-1, keepdims=True) + 1e-6)
    h = grn_gamma * (h * nx) + grn_beta + h
    h = torch.einsum('bhwe,ec->bhwc', h, w2)
    return x + h
```

```asm
; @launch grid=(256,1,1) block=(256,1,1) lds=163840
.amdgcn_target "amdgcn-amd-amdhsa--gfx950"
.text
.globl standalone__modern_conv_block_convnext_v2__vision_kernel
.p2align 8
.type standalone__modern_conv_block_convnext_v2__vision_kernel,@function
standalone__modern_conv_block_convnext_v2__vision_kernel:
  s_load_dwordx2 s[8:9], s[0:1], 0
  s_load_dwordx2 s[12:13], s[0:1], 8
  s_load_dwordx2 s[16:17], s[0:1], 16
  s_load_dwordx2 s[20:21], s[0:1], 64
  s_load_dwordx2 s[32:33], s[0:1], 56
  s_getpc_b64 s[66:67]
L_pc0:
  v_lshlrev_b32 v203, 4, v0
  s_cmp_ge_u32 s2, 224
  s_cselect_b32 s68, L_fin-L_pc0-16384, 0
  s_add_u32 s66, s66, s68
  s_addc_u32 s67, s67, 0
  global_load_dwordx4 v[204:207], v203, s[66:67] offset:0
  v_add_u32 v203, 8192, v203
  global_load_dwordx4 v[204:207], v203, s[66:67] offset:-4096
  global_load_dwordx4 v[204:207], v203, s[66:67] offset:0
  v_add_u32 v203, 8192, v203
  global_load_dwordx4 v[204:207], v203, s[66:67] offset:-4096
  v_lshrrev_b32 v1, 6, v0
  v_and_b32 v0, 63, v0
  v_readfirstlane_b32 s3, v1
  v_lshlrev_b32 v248, 4, v0
  s_mov_b32 s18, 294912
  s_mov_b32 s19, 0x20000
  s_mov_b32 s22, 268435456
  s_mov_b32 s23, 0x20000
  s_mov_b32 s34, 256
  s_mov_b32 s35, 0x20000
  s_cmp_ge_u32 s2, 224
  s_cbranch_scc1 L_helper
  s_mov_b32 s10, 19267584
  s_mov_b32 s11, 0x20000
  s_and_b32 s42, s2, 7
  s_lshr_b32 s43, s2, 3
  s_mul_i32 s44, s43, 37
  s_lshr_b32 s44, s44, 8
  s_mul_i32 s45, s44, 7
  s_sub_u32 s45, s43, s45
  s_lshl_b32 s42, s42, 2
  s_add_u32 s42, s42, s44
  s_mul_i32 s36, s42, 7
  s_lshl_b32 s37, s45, 5
  s_movk_i32 s40, 384
  s_lshl_b32 s47, s3, 3
  s_add_u32 s48, s47, 1
  s_movk_i32 s49, 171
  s_mul_i32 s50, s36, 224
  s_add_u32 s50, s50, s37
  s_mul_i32 s70, s50, 384
  s_sub_u32 s38, s70, 86016
  s_mul_i32 s39, s3, 3072
  s_add_u32 s41, s38, s39
  s_add_u32 s39, s39, 17536
  v_mov_b32 v103, -24
  v_mul_u32_u24 v105, s49, v0
  v_lshrrev_b32 v105, 12, v105
  v_mad_i32_i24 v106, v105, v103, v0
  v_add_u32 v107, s48, v105
  v_bfe_u32 v107, v107, 1, 3
  v_xor_b32 v106, v106, v107
  v_mul_u32_u24 v105, s40, v105
  v_lshl_add_u32 v242, v106, 4, v105
  s_cmp_eq_u32 s36, 0
  s_cselect_b32 s52, 0x7fff0000, s41
  s_add_u32 m0, s39, 0
  s_waitcnt lgkmcnt(0)
  buffer_load_dwordx4 v242, s[8:11], s52 offen offset:0 lds
  v_add_u32 v104, 64, v0
  v_mul_u32_u24 v105, s49, v104
  v_lshrrev_b32 v105, 12, v105
  v_mad_i32_i24 v106, v105, v103, v104
  v_add_u32 v107, s48, v105
  v_bfe_u32 v107, v107, 1, 3
  v_xor_b32 v106, v106, v107
  v_subrev_u32 v106, 64, v106
  v_mul_u32_u24 v105, s40, v105
  v_lshl_add_u32 v243, v106, 4, v105
  buffer_load_dwordx4 v243, s[8:11], s52 offen offset:1024 lds
  v_add_u32 v104, 128, v0
  v_mul_u32_u24 v105, s49, v104
  v_lshrrev_b32 v105, 12, v105
  v_mad_i32_i24 v106, v105, v103, v104
  v_add_u32 v107, s48, v105
  v_bfe_u32 v107, v107, 1, 3
  v_xor_b32 v106, v106, v107
  v_subrev_u32 v106, 128, v106
  v_mul_u32_u24 v105, s40, v105
  v_lshl_add_u32 v244, v106, 4, v105
  buffer_load_dwordx4 v244, s[8:11], s52 offen offset:2048 lds
  s_load_dwordx2 s[24:25], s[0:1], 48
  s_load_dwordx2 s[28:29], s[0:1], 32
  s_mov_b32 s14, 3456
  s_mov_b32 s15, 0x20000
  v_and_b32 v96, 31, v0
  v_lshrrev_b32 v97, 5, v0
  v_bfe_u32 v98, v96, 2, 1
  v_lshrrev_b32 v99, 4, v96
  v_lshl_add_u32 v98, v99, 1, v98
  v_sub_u32 v98, v97, v98
  v_add_u32 v98, 2, v98
  v_bfe_u32 v99, v96, 3, 1
  v_and_b32 v100, 3, v96
  v_lshl_add_u32 v99, v99, 2, v100
  s_movk_i32 s52, 1152
  v_lshrrev_b32 v100, 1, v99
  v_lshlrev_b32 v101, 2, v100
  v_mad_u32_u24 v101, v98, s52, v101
  v_cmp_gt_u32 vcc, 3, v98
  v_mov_b32 v102, 0x80000000
  s_mul_i32 s46, s3, 96
  v_cndmask_b32 v101, v102, v101, vcc
  v_cmp_le_u32 vcc, 24, v0
  v_mov_b64 v[238:239], 0
  v_mov_b64 v[240:241], 0
  buffer_load_dword v32, v101, s[12:15], s46 offen offset:0
  v_cndmask_b32 v108, 0, 1, vcc
  v_mad_i32_i24 v109, v108, v103, v0
  v_lshlrev_b32 v109, 4, v109
  buffer_load_dword v33, v101, s[12:15], s46 offen offset:384
  s_mul_i32 s68, s3, 13056
  s_add_u32 s53, s3, 0
  s_mul_i32 s54, s53, 86016
  buffer_load_dword v34, v101, s[12:15], s46 offen offset:768
  s_add_u32 s54, s54, s38
  s_add_u32 s54, s54, 4294893568
  buffer_load_dword v35, v101, s[12:15], s46 offen offset:16
  s_add_u32 s55, s54, 73344
  s_add_u32 s56, s36, s53
  s_sub_u32 s51, s56, 2
  buffer_load_dword v36, v101, s[12:15], s46 offen offset:400
  s_cmp_lt_u32 s51, 224
  s_cselect_b32 s54, s54, 0x80000000
  s_sub_u32 s51, s53, 1
  buffer_load_dword v37, v101, s[12:15], s46 offen offset:784
  s_cmp_lt_u32 s51, 9
  s_cselect_b32 s54, s54, 0x80000000
  buffer_load_dword v38, v101, s[12:15], s46 offen offset:32
  s_cmp_lt_u32 s37, 192
  s_cselect_b32 s54, s54, 0x80000000
  s_sub_u32 s51, s56, 1
  buffer_load_dword v39, v101, s[12:15], s46 offen offset:416
  s_cmp_lt_u32 s51, 224
  s_cselect_b32 s55, s55, 0x80000000
  s_cmp_lt_u32 s53, 9
  s_cselect_b32 s55, s55, 0x80000000
  buffer_load_dword v40, v101, s[12:15], s46 offen offset:800
  s_cmp_gt_u32 s37, 0
  s_cselect_b32 s55, s55, 0x80000000
  buffer_load_dword v41, v101, s[12:15], s46 offen offset:48
  s_sub_u32 s55, s55, s54
  v_mul_lo_u32 v106, v108, s55
  buffer_load_dword v42, v101, s[12:15], s46 offen offset:432
  v_add3_u32 v200, v106, s54, v109
  s_lshl_b32 s53, s3, 10
  v_add_u32 v104, s53, v248
  buffer_load_dword v43, v101, s[12:15], s46 offen offset:816
  ds_write_b128 v104, v[238:241] offset:384
  ds_write_b128 v104, v[238:241] offset:4480
  buffer_load_dword v44, v101, s[12:15], s46 offen offset:64
  ds_write_b128 v104, v[238:241] offset:8576
  ds_write_b128 v104, v[238:241] offset:12672
  v_mfma_f32_32x32x16_bf16 v[16:31], v[238:241], v[238:241], 0
  buffer_load_dword v45, v101, s[12:15], s46 offen offset:448
  v_and_b32 v104, 1, v99
  v_lshlrev_b32 v104, 4, v104
  v_mov_b32 v105, 0xffff
  buffer_load_dword v46, v101, s[12:15], s46 offen offset:832
  v_lshlrev_b32 v104, v104, v105
  v_cmp_eq_u32 vcc, 0, v100
  buffer_load_dword v47, v101, s[12:15], s46 offen offset:80
  v_cmp_eq_u32 s[44:45], 1, v100
  v_cmp_eq_u32 s[54:55], 2, v100
  v_cndmask_b32 v66, 0, v104, vcc
  buffer_load_dword v64, v101, s[12:15], s46 offen offset:464
  v_cmp_eq_u32 vcc, 3, v100
  v_cndmask_b32 v67, 0, v104, s[44:45]
  v_cndmask_b32 v68, 0, v104, s[54:55]
  buffer_load_dword v65, v101, s[12:15], s46 offen offset:848
  v_cndmask_b32 v69, 0, v104, vcc
  v_mfma_f32_32x32x16_bf16 v[48:63], v[238:241], v[238:241], 0
  s_add_u32 m0, s68, 16768
  s_mov_b32 exec_hi, 0xffff
  buffer_load_dwordx4 v200, s[8:11], 0 offen lds
  s_mov_b32 exec_hi, -1
  s_movk_i32 s54, 13056
  v_mul_u32_u24 v104, s54, v97
  v_add_u32 v104, 4096, v104
  s_add_u32 s52, s41, 86016
  s_add_u32 m0, s39, 13056
  s_nop 0
  buffer_load_dwordx4 v242, s[8:11], s52 offen offset:0 lds
  s_add_u32 s61, s46, 16
  s_add_u32 s62, s46, 32
  s_add_u32 s63, s46, 48
  buffer_load_dwordx4 v243, s[8:11], s52 offen offset:1024 lds
  s_add_u32 s64, s46, 64
  s_add_u32 s65, s46, 80
  buffer_load_dwordx4 v244, s[8:11], s52 offen offset:2048 lds
  v_mfma_f32_32x32x16_bf16 v[80:95], v[238:241], v[238:241], 0
  v_bfe_u32 v106, v96, 1, 3
  v_mad_u32_u24 v105, v96, s40, v104
  v_lshlrev_b32 v106, 4, v106
  v_xad_u32 v208, s46, v106, v105
  v_xad_u32 v211, s61, v106, v105
  v_xad_u32 v214, s62, v106, v105
  v_xad_u32 v217, s63, v106, v105
  v_xad_u32 v220, s64, v106, v105
  v_xad_u32 v223, s65, v106, v105
  v_mfma_f32_32x32x16_bf16 v[112:127], v[238:241], v[238:241], 0
  v_add_u32 v105, 1, v96
  v_bfe_u32 v106, v105, 1, 3
  v_mad_u32_u24 v105, v105, s40, v104
  v_lshlrev_b32 v106, 4, v106
  v_xad_u32 v209, s46, v106, v105
  v_xad_u32 v212, s61, v106, v105
  v_xad_u32 v215, s62, v106, v105
  v_xad_u32 v218, s63, v106, v105
  v_xad_u32 v221, s64, v106, v105
  v_xad_u32 v224, s65, v106, v105
  v_mfma_f32_32x32x16_bf16 v[144:159], v[238:241], v[238:241], 0
  v_add_u32 v105, 2, v96
  v_bfe_u32 v106, v105, 1, 3
  v_mad_u32_u24 v105, v105, s40, v104
  v_lshlrev_b32 v106, 4, v106
  v_xad_u32 v210, s46, v106, v105
  v_xad_u32 v213, s61, v106, v105
  s_add_u32 s52, s41, 172032
  s_add_u32 m0, s39, 26112
  s_nop 0
  buffer_load_dwordx4 v242, s[8:11], s52 offen offset:0 lds
  v_xad_u32 v216, s62, v106, v105
  v_xad_u32 v219, s63, v106, v105
  v_xad_u32 v222, s64, v106, v105
  v_xad_u32 v225, s65, v106, v105
  v_mfma_f32_32x32x16_bf16 v[176:191], v[238:241], v[238:241], 0
  s_mul_i32 s55, s3, 3072
  v_lshl_add_u32 v105, v96, 4, v104
  v_add_u32 v246, s55, v105
  s_add_u32 s53, s3, 4
  s_mul_i32 s54, s53, 86016
  s_add_u32 s54, s54, s38
  s_add_u32 s54, s54, 4294893568
  s_add_u32 s55, s54, 73344
  s_add_u32 s56, s36, s53
  s_sub_u32 s51, s56, 2
  s_cmp_lt_u32 s51, 224
  s_cselect_b32 s54, s54, 0x80000000
  s_sub_u32 s51, s53, 1
  s_cmp_lt_u32 s51, 9
  s_cselect_b32 s54, s54, 0x80000000
  s_cmp_lt_u32 s37, 192
  s_cselect_b32 s54, s54, 0x80000000
  s_sub_u32 s51, s56, 1
  s_cmp_lt_u32 s51, 224
  s_cselect_b32 s55, s55, 0x80000000
  s_cmp_lt_u32 s53, 9
  s_cselect_b32 s55, s55, 0x80000000
  s_cmp_gt_u32 s37, 0
  s_cselect_b32 s55, s55, 0x80000000
  buffer_load_dwordx4 v243, s[8:11], s52 offen offset:1024 lds
  s_sub_u32 s55, s55, s54
  v_mul_lo_u32 v106, v108, s55
  v_add3_u32 v201, v106, s54, v109
  s_add_u32 s53, s3, 8
  s_mul_i32 s54, s53, 86016
  s_add_u32 s54, s54, s38
  s_add_u32 s54, s54, 4294893568
  s_add_u32 s55, s54, 73344
  s_add_u32 s56, s36, s53
  s_sub_u32 s51, s56, 2
  s_cmp_lt_u32 s51, 224
  s_cselect_b32 s54, s54, 0x80000000
  s_sub_u32 s51, s53, 1
  s_cmp_lt_u32 s51, 9
  s_cselect_b32 s54, s54, 0x80000000
  s_cmp_lt_u32 s37, 192
  s_cselect_b32 s54, s54, 0x80000000
  s_sub_u32 s51, s56, 1
  s_cmp_lt_u32 s51, 224
  s_cselect_b32 s55, s55, 0x80000000
  s_cmp_lt_u32 s53, 9
  s_cselect_b32 s55, s55, 0x80000000
  s_cmp_gt_u32 s37, 0
  s_cselect_b32 s55, s55, 0x80000000
  s_sub_u32 s55, s55, s54
  v_mul_lo_u32 v106, v108, s55
  v_add3_u32 v202, v106, s54, v109
  buffer_load_dwordx4 v244, s[8:11], s52 offen offset:2048 lds
  s_waitcnt vmcnt(24)
  v_and_b32 v70, v32, v66
  v_and_b32 v71, v32, v67
  v_and_b32 v72, v32, v68
  v_and_b32 v73, v32, v69
  v_accvgpr_write_b32 a144, v70
  v_accvgpr_write_b32 a145, v71
  v_accvgpr_write_b32 a146, v72
  v_accvgpr_write_b32 a147, v73
  s_waitcnt vmcnt(23)
  v_and_b32 v74, v33, v66
  v_and_b32 v75, v33, v67
  v_and_b32 v76, v33, v68
  v_and_b32 v77, v33, v69
  v_accvgpr_write_b32 a148, v74
  v_accvgpr_write_b32 a149, v75
  v_accvgpr_write_b32 a150, v76
  v_accvgpr_write_b32 a151, v77
  s_waitcnt vmcnt(22)
  v_and_b32 v70, v34, v66
  v_and_b32 v71, v34, v67
  v_and_b32 v72, v34, v68
  v_and_b32 v73, v34, v69
  v_accvgpr_write_b32 a152, v70
  s_add_u32 s52, s41, 258048
  s_add_u32 m0, s39, 39168
  s_nop 0
  buffer_load_dwordx4 v242, s[8:11], s52 offen offset:0 lds
  v_accvgpr_write_b32 a153, v71
  v_accvgpr_write_b32 a154, v72
  v_accvgpr_write_b32 a155, v73
  s_waitcnt vmcnt(22)
  v_and_b32 v74, v35, v66
  v_and_b32 v75, v35, v67
  v_and_b32 v76, v35, v68
  v_and_b32 v77, v35, v69
  v_accvgpr_write_b32 a156, v74
  v_accvgpr_write_b32 a157, v75
  v_accvgpr_write_b32 a158, v76
  v_accvgpr_write_b32 a159, v77
  s_waitcnt vmcnt(21)
  v_and_b32 v70, v36, v66
  v_and_b32 v71, v36, v67
  v_and_b32 v72, v36, v68
  v_and_b32 v73, v36, v69
  v_accvgpr_write_b32 a160, v70
  v_accvgpr_write_b32 a161, v71
  v_accvgpr_write_b32 a162, v72
  v_accvgpr_write_b32 a163, v73
  s_waitcnt vmcnt(20)
  v_and_b32 v74, v37, v66
  v_and_b32 v75, v37, v67
  buffer_load_dwordx4 v243, s[8:11], s52 offen offset:1024 lds
  v_and_b32 v76, v37, v68
  v_and_b32 v77, v37, v69
  v_accvgpr_write_b32 a164, v74
  v_accvgpr_write_b32 a165, v75
  v_accvgpr_write_b32 a166, v76
  v_accvgpr_write_b32 a167, v77
  s_waitcnt vmcnt(20)
  v_and_b32 v70, v38, v66
  v_and_b32 v71, v38, v67
  v_and_b32 v72, v38, v68
  v_and_b32 v73, v38, v69
  v_accvgpr_write_b32 a168, v70
  v_accvgpr_write_b32 a169, v71
  v_accvgpr_write_b32 a170, v72
  v_accvgpr_write_b32 a171, v73
  s_waitcnt vmcnt(19)
  v_and_b32 v74, v39, v66
  v_and_b32 v75, v39, v67
  v_and_b32 v76, v39, v68
  v_and_b32 v77, v39, v69
  v_accvgpr_write_b32 a172, v74
  v_accvgpr_write_b32 a173, v75
  buffer_load_dwordx4 v244, s[8:11], s52 offen offset:2048 lds
  v_accvgpr_write_b32 a174, v76
  v_accvgpr_write_b32 a175, v77
  s_waitcnt vmcnt(19)
  v_and_b32 v70, v40, v66
  v_and_b32 v71, v40, v67
  v_and_b32 v72, v40, v68
  v_and_b32 v73, v40, v69
  v_accvgpr_write_b32 a176, v70
  v_accvgpr_write_b32 a177, v71
  v_accvgpr_write_b32 a178, v72
  v_accvgpr_write_b32 a179, v73
  s_waitcnt vmcnt(18)
  v_and_b32 v74, v41, v66
  v_and_b32 v75, v41, v67
  v_and_b32 v76, v41, v68
  v_and_b32 v77, v41, v69
  v_accvgpr_write_b32 a180, v74
  v_accvgpr_write_b32 a181, v75
  v_accvgpr_write_b32 a182, v76
  v_accvgpr_write_b32 a183, v77
  s_waitcnt vmcnt(17)
  v_and_b32 v70, v42, v66
  v_and_b32 v71, v42, v67
  v_and_b32 v72, v42, v68
  s_add_u32 s52, s41, 344064
  s_add_u32 m0, s39, 52224
  s_nop 0
  buffer_load_dwordx4 v242, s[8:11], s52 offen offset:0 lds
  v_and_b32 v73, v42, v69
  v_accvgpr_write_b32 a184, v70
  v_accvgpr_write_b32 a185, v71
  v_accvgpr_write_b32 a186, v72
  v_accvgpr_write_b32 a187, v73
  s_waitcnt vmcnt(17)
  v_and_b32 v74, v43, v66
  v_and_b32 v75, v43, v67
  v_and_b32 v76, v43, v68
  v_and_b32 v77, v43, v69
  v_accvgpr_write_b32 a188, v74
  v_accvgpr_write_b32 a189, v75
  v_accvgpr_write_b32 a190, v76
  v_accvgpr_write_b32 a191, v77
  s_waitcnt vmcnt(16)
  v_and_b32 v70, v44, v66
  v_and_b32 v71, v44, v67
  v_and_b32 v72, v44, v68
  v_and_b32 v73, v44, v69
  v_accvgpr_write_b32 a192, v70
  v_accvgpr_write_b32 a193, v71
  v_accvgpr_write_b32 a194, v72
  buffer_load_dwordx4 v243, s[8:11], s52 offen offset:1024 lds
  v_accvgpr_write_b32 a195, v73
  s_waitcnt vmcnt(16)
  v_and_b32 v74, v45, v66
  v_and_b32 v75, v45, v67
  v_and_b32 v76, v45, v68
  v_and_b32 v77, v45, v69
  v_accvgpr_write_b32 a196, v74
  v_accvgpr_write_b32 a197, v75
  v_accvgpr_write_b32 a198, v76
  v_accvgpr_write_b32 a199, v77
  s_waitcnt vmcnt(15)
  v_and_b32 v70, v46, v66
  v_and_b32 v71, v46, v67
  v_and_b32 v72, v46, v68
  v_and_b32 v73, v46, v69
  v_accvgpr_write_b32 a200, v70
  v_accvgpr_write_b32 a201, v71
  v_accvgpr_write_b32 a202, v72
  v_accvgpr_write_b32 a203, v73
  s_waitcnt vmcnt(14)
  v_and_b32 v74, v47, v66
  v_and_b32 v75, v47, v67
  v_and_b32 v76, v47, v68
  v_and_b32 v77, v47, v69
  buffer_load_dwordx4 v244, s[8:11], s52 offen offset:2048 lds
  v_accvgpr_write_b32 a204, v74
  v_accvgpr_write_b32 a205, v75
  v_accvgpr_write_b32 a206, v76
  v_accvgpr_write_b32 a207, v77
  s_waitcnt vmcnt(14)
  v_and_b32 v70, v64, v66
  v_and_b32 v71, v64, v67
  v_and_b32 v72, v64, v68
  v_and_b32 v73, v64, v69
  v_accvgpr_write_b32 a208, v70
  v_accvgpr_write_b32 a209, v71
  v_accvgpr_write_b32 a210, v72
  v_accvgpr_write_b32 a211, v73
  s_waitcnt vmcnt(13)
  v_and_b32 v74, v65, v66
  v_and_b32 v75, v65, v67
  v_and_b32 v76, v65, v68
  v_and_b32 v77, v65, v69
  v_accvgpr_write_b32 a212, v74
  v_accvgpr_write_b32 a213, v75
  v_accvgpr_write_b32 a214, v76
  v_accvgpr_write_b32 a215, v77
  s_add_u32 m0, s68, 68992
  s_mov_b32 exec_hi, 0xffff
  buffer_load_dwordx4 v201, s[8:11], 0 offen lds
  s_mov_b32 exec_hi, -1
  s_waitcnt vmcnt(13) lgkmcnt(0)
  s_barrier
  ds_read_b128 a[24:27], v208 offset:0
  ds_read_b128 a[28:31], v209 offset:0
  ds_read_b128 a[32:35], v210 offset:0
  ds_read_b128 a[36:39], v211 offset:0
  ds_read_b128 a[40:43], v212 offset:0
  ds_read_b128 a[44:47], v213 offset:0
  ds_read_b128 a[0:3], v214 offset:0
  ds_read_b128 a[4:7], v215 offset:0
  s_waitcnt lgkmcnt(7)
  v_mfma_f32_32x32x16_bf16 v[0:15], a[144:147], a[24:27], 0
  ds_read_b128 a[8:11], v216 offset:0
  s_add_u32 s52, s41, 430080
  s_add_u32 m0, s39, 65280
  s_nop 0
  buffer_load_dwordx4 v242, s[8:11], s52 offen offset:0 lds
  s_lshr_b32 s55, s3, 1
  s_lshl_b32 s55, s55, 10
  s_and_b32 s56, s3, 1
  s_waitcnt lgkmcnt(7)
  v_mfma_f32_32x32x16_bf16 v[0:15], a[148:151], a[28:31], v[0:15]
  ds_read_b128 a[12:15], v217 offset:0
  s_lshl_b32 s56, s56, 3
  s_add_u32 s55, s55, s56
  v_add_u32 v247, s55, v248
  v_add_u32 v249, 4096, v248
  v_add_u32 v250, 56320, v248
  s_waitcnt lgkmcnt(7)
  v_mfma_f32_32x32x16_bf16 v[0:15], a[152:155], a[32:35], v[0:15]
  ds_read_b128 a[16:19], v218 offset:0
  s_lshl_b32 s55, s3, 14
  s_add_u32 s55, s55, 95488
  v_add_u32 v252, s55, v248
  v_lshrrev_b32 v226, 4, v248
  v_lshrrev_b32 v227, 9, v248
  s_waitcnt lgkmcnt(7)
  v_mfma_f32_32x32x16_bf16 v[32:47], a[156:159], a[36:39], 0
  ds_read_b128 a[20:23], v219 offset:0
  buffer_load_dwordx4 v243, s[8:11], s52 offen offset:1024 lds
  v_and_b32 v228, 0x19, v226
  v_lshl_or_b32 v228, v227, 2, v228
  v_lshrrev_b32 v226, 1, v226
  s_waitcnt lgkmcnt(7)
  v_mfma_f32_32x32x16_bf16 v[32:47], a[160:163], a[40:43], v[32:47]
  ds_read_b128 a[24:27], v220 offset:0
  v_and_b32 v227, 2, v226
  v_or_b32 v228, v228, v227
  v_and_b32 v226, 1, v226
  v_lshlrev_b32 v228, 3, v228
  v_lshl_or_b32 v251, v226, 2, v228
  s_waitcnt lgkmcnt(7)
  v_mfma_f32_32x32x16_bf16 v[32:47], a[164:167], a[44:47], v[32:47]
  ds_read_b128 a[28:31], v221 offset:0
  s_mov_b32 s26, 19267584
  s_mov_b32 s27, 0x20000
  s_mov_b32 s30, 1536
  s_mov_b32 s31, 0x20000
  s_mov_b32 s60, 0x30800000
  s_waitcnt lgkmcnt(7)
  v_mfma_f32_32x32x16_bf16 v[64:79], a[168:171], a[0:3], 0
  ds_read_b128 a[32:35], v222 offset:0
  buffer_load_dwordx4 v244, s[8:11], s52 offen offset:2048 lds
  s_mov_b32 s61, 0x30800000
  s_mov_b32 s62, 0x409d30fc
  s_mov_b32 s63, 0x409d30fc
  s_waitcnt lgkmcnt(7)
  v_mfma_f32_32x32x16_bf16 v[64:79], a[172:175], a[4:7], v[64:79]
  ds_read_b128 a[36:39], v223 offset:0
  s_add_u32 s71, s70, 86016
  s_add_u32 s72, s71, 86016
  s_add_u32 s73, s72, 86016
  s_add_u32 s74, s73, 86016
  s_add_u32 s75, s74, 86016
  s_waitcnt lgkmcnt(7)
  v_mfma_f32_32x32x16_bf16 v[64:79], a[176:179], a[8:11], v[64:79]
  ds_read_b128 a[40:43], v224 offset:0
  s_add_u32 s76, s75, 86016
  s_bfe_u32 s55, s2, 0x20003
  s_mul_i32 s55, s55, 6144
  s_mul_i32 s56, s3, 1536
  s_add_u32 s55, s55, s56
  s_waitcnt lgkmcnt(7)
  v_mfma_f32_32x32x16_bf16 v[96:111], a[180:183], a[12:15], 0
  ds_read_b128 a[44:47], v225 offset:0
  s_add_u32 s77, s55, 888832
  s_mul_i32 s78, s3, 73728
  s_mul_i32 s79, s3, 49152
  s_add_u32 s79, s79, 294912
  s_mov_b32 s6, 0xaaaaaaaa
  s_waitcnt lgkmcnt(7)
  v_mfma_f32_32x32x16_bf16 v[96:111], a[184:187], a[16:19], v[96:111]
  s_mov_b32 s7, 0xaaaaaaaa
  s_mov_b32 s64, 0xcccccccc
  s_mov_b32 s65, 0xcccccccc
  s_mov_b32 s59, 0x3baaaaab
  s_add_u32 s36, s78, 24576
  s_add_u32 s37, s78, 28672
  s_waitcnt lgkmcnt(6)
  v_mfma_f32_32x32x16_bf16 v[96:111], a[188:191], a[20:23], v[96:111]
  s_add_u32 s38, s78, 32768
  s_add_u32 s43, s78, 36864
  s_add_u32 s47, s78, 40960
  s_add_u32 s48, s78, 45056
  s_add_u32 s49, s78, 49152
  s_add_u32 s53, s78, 53248
  s_waitcnt lgkmcnt(5)
  v_mfma_f32_32x32x16_bf16 v[128:143], a[192:195], a[24:27], 0
  s_add_u32 s54, s78, 57344
  s_add_u32 s57, s78, 61440
  s_add_u32 s66, s78, 65536
  s_add_u32 s67, s78, 69632
  s_waitcnt lgkmcnt(4)
  v_mfma_f32_32x32x16_bf16 v[128:143], a[196:199], a[28:31], v[128:143]
  s_waitcnt lgkmcnt(3)
  v_mfma_f32_32x32x16_bf16 v[128:143], a[200:203], a[32:35], v[128:143]
  s_waitcnt lgkmcnt(2)
  v_mfma_f32_32x32x16_bf16 v[160:175], a[204:207], a[36:39], 0
  s_waitcnt lgkmcnt(1)
  v_mfma_f32_32x32x16_bf16 v[160:175], a[208:211], a[40:43], v[160:175]
  s_waitcnt lgkmcnt(0)
  v_mfma_f32_32x32x16_bf16 v[160:175], a[212:215], a[44:47], v[160:175]
  s_waitcnt vmcnt(10)
  s_barrier
  ds_read_b128 a[24:27], v208 offset:26112
  ds_read_b128 a[28:31], v209 offset:26112
  ds_read_b128 a[32:35], v210 offset:26112
  ds_read_b128 a[36:39], v211 offset:26112
  ds_read_b128 a[40:43], v212 offset:26112
  ds_read_b128 a[44:47], v213 offset:26112
  ds_read_b128 a[0:3], v214 offset:26112
  ds_read_b128 a[4:7], v215 offset:26112
  s_waitcnt lgkmcnt(7)
  v_mfma_f32_32x32x16_bf16 v[8:23], a[144:147], a[24:27], v[8:23]
  ds_read_b128 a[8:11], v216 offset:26112
  s_add_u32 s52, s41, 516096
  s_add_u32 m0, s39, 78336
  s_nop 0
  buffer_load_dwordx4 v242, s[8:11], s52 offen offset:0 lds
  s_waitcnt lgkmcnt(7)
  v_mfma_f32_32x32x16_bf16 v[8:23], a[148:151], a[28:31], v[8:23]
  ds_read_b128 a[12:15], v217 offset:26112
  s_waitcnt lgkmcnt(7)
  v_mfma_f32_32x32x16_bf16 v[8:23], a[152:155], a[32:35], v[8:23]
  ds_read_b128 a[16:19], v218 offset:26112
  v_mfma_f32_32x32x16_bf16 v[24:39], v[238:241], v[238:241], 0
  s_waitcnt lgkmcnt(7)
  v_mfma_f32_32x32x16_bf16 v[40:55], a[156:159], a[36:39], v[40:55]
  ds_read_b128 a[20:23], v219 offset:26112
  buffer_load_dwordx4 v243, s[8:11], s52 offen offset:1024 lds
  s_waitcnt lgkmcnt(7)
  v_mfma_f32_32x32x16_bf16 v[40:55], a[160:163], a[40:43], v[40:55]
  ds_read_b128 a[24:27], v220 offset:26112
  v_add_f32 v254, v8, v9
  v_mul_f32 v255, v8, v8
  v_fmac_f32 v255, v9, v9
  v_add_f32 v254, v254, v10
  v_fmac_f32 v255, v10, v10
  s_waitcnt lgkmcnt(7)
  v_mfma_f32_32x32x16_bf16 v[40:55], a[164:167], a[44:47], v[40:55]
  ds_read_b128 a[28:31], v221 offset:26112
  v_add_f32 v254, v254, v11
  v_fmac_f32 v255, v11, v11
  v_add_f32 v254, v254, v12
  v_fmac_f32 v255, v12, v12
  v_add_f32 v254, v254, v13
  v_mfma_f32_32x32x16_bf16 v[56:71], v[238:241], v[238:241], 0
  v_fmac_f32 v255, v13, v13
  v_add_f32 v254, v254, v14
  v_fmac_f32 v255, v14, v14
  v_add_f32 v254, v254, v15
  v_fmac_f32 v255, v15, v15
  s_waitcnt lgkmcnt(7)
  v_mfma_f32_32x32x16_bf16 v[72:87], a[168:171], a[0:3], v[72:87]
  ds_read_b128 a[32:35], v222 offset:26112
  buffer_load_dwordx4 v244, s[8:11], s52 offen offset:2048 lds
  s_waitcnt lgkmcnt(7)
  v_mfma_f32_32x32x16_bf16 v[72:87], a[172:175], a[4:7], v[72:87]
  ds_read_b128 a[36:39], v223 offset:26112
  v_add_f32 v254, v254, v40
  v_fmac_f32 v255, v40, v40
  v_add_f32 v254, v254, v41
  v_fmac_f32 v255, v41, v41
  v_add_f32 v254, v254, v42
  s_waitcnt lgkmcnt(7)
  v_mfma_f32_32x32x16_bf16 v[72:87], a[176:179], a[8:11], v[72:87]
  ds_read_b128 a[40:43], v224 offset:26112
  v_fmac_f32 v255, v42, v42
  v_add_f32 v254, v254, v43
  v_fmac_f32 v255, v43, v43
  v_add_f32 v254, v254, v44
  v_fmac_f32 v255, v44, v44
  v_mfma_f32_32x32x16_bf16 v[88:103], v[238:241], v[238:241], 0
  v_add_f32 v254, v254, v45
  v_fmac_f32 v255, v45, v45
  v_add_f32 v254, v254, v46
  v_fmac_f32 v255, v46, v46
  v_add_f32 v254, v254, v47
  v_fmac_f32 v255, v47, v47
  s_waitcnt lgkmcnt(7)
  v_mfma_f32_32x32x16_bf16 v[104:119], a[180:183], a[12:15], v[104:119]
  ds_read_b128 a[44:47], v225 offset:26112
  s_add_u32 s52, s41, 602112
  s_add_u32 m0, s39, 91392
  s_nop 0
  buffer_load_dwordx4 v242, s[8:11], s52 offen offset:0 lds
  s_waitcnt lgkmcnt(7)
  v_mfma_f32_32x32x16_bf16 v[104:119], a[184:187], a[16:19], v[104:119]
  v_add_f32 v254, v254, v72
  v_fmac_f32 v255, v72, v72
  v_add_f32 v254, v254, v73
  v_fmac_f32 v255, v73, v73
  v_add_f32 v254, v254, v74
  v_fmac_f32 v255, v74, v74
  s_waitcnt lgkmcnt(6)
  v_mfma_f32_32x32x16_bf16 v[104:119], a[188:191], a[20:23], v[104:119]
  v_add_f32 v254, v254, v75
  v_fmac_f32 v255, v75, v75
  v_add_f32 v254, v254, v76
  v_fmac_f32 v255, v76, v76
  v_add_f32 v254, v254, v77
  v_fmac_f32 v255, v77, v77
  v_mfma_f32_32x32x16_bf16 v[120:135], v[238:241], v[238:241], 0
  v_add_f32 v254, v254, v78
  v_fmac_f32 v255, v78, v78
  v_add_f32 v254, v254, v79
  v_fmac_f32 v255, v79, v79
  s_waitcnt lgkmcnt(5)
  v_mfma_f32_32x32x16_bf16 v[136:151], a[192:195], a[24:27], v[136:151]
  buffer_load_dwordx4 v243, s[8:11], s52 offen offset:1024 lds
  s_waitcnt lgkmcnt(4)
  v_mfma_f32_32x32x16_bf16 v[136:151], a[196:199], a[28:31], v[136:151]
  v_add_f32 v254, v254, v104
  v_fmac_f32 v255, v104, v104
  v_add_f32 v254, v254, v105
  v_fmac_f32 v255, v105, v105
  v_add_f32 v254, v254, v106
  v_fmac_f32 v255, v106, v106
  s_waitcnt lgkmcnt(3)
  v_mfma_f32_32x32x16_bf16 v[136:151], a[200:203], a[32:35], v[136:151]
  v_add_f32 v254, v254, v107
  v_fmac_f32 v255, v107, v107
  v_add_f32 v254, v254, v108
  v_fmac_f32 v255, v108, v108
  v_add_f32 v254, v254, v109
  v_fmac_f32 v255, v109, v109
  v_mfma_f32_32x32x16_bf16 v[152:167], v[238:241], v[238:241], 0
  v_add_f32 v254, v254, v110
  v_fmac_f32 v255, v110, v110
  v_add_f32 v254, v254, v111
  v_fmac_f32 v255, v111, v111
  s_waitcnt lgkmcnt(2)
  v_mfma_f32_32x32x16_bf16 v[168:183], a[204:207], a[36:39], v[168:183]
  buffer_load_dwordx4 v244, s[8:11], s52 offen offset:2048 lds
  s_waitcnt lgkmcnt(1)
  v_mfma_f32_32x32x16_bf16 v[168:183], a[208:211], a[40:43], v[168:183]
  v_add_f32 v254, v254, v136
  v_fmac_f32 v255, v136, v136
  v_add_f32 v254, v254, v137
  v_fmac_f32 v255, v137, v137
  v_add_f32 v254, v254, v138
  v_fmac_f32 v255, v138, v138
  s_waitcnt lgkmcnt(0)
  v_mfma_f32_32x32x16_bf16 v[168:183], a[212:215], a[44:47], v[168:183]
  v_add_f32 v254, v254, v139
  v_fmac_f32 v255, v139, v139
  v_add_f32 v254, v254, v140
  v_fmac_f32 v255, v140, v140
  v_add_f32 v254, v254, v141
  v_fmac_f32 v255, v141, v141
  v_mfma_f32_32x32x16_bf16 v[184:199], v[238:241], v[238:241], 0
  v_add_f32 v254, v254, v142
  v_fmac_f32 v255, v142, v142
  v_add_f32 v254, v254, v143
  v_fmac_f32 v255, v143, v143
  s_waitcnt vmcnt(9)
  s_barrier
  ds_read_b128 a[24:27], v208 offset:52224
  ds_read_b128 a[28:31], v209 offset:52224
  ds_read_b128 a[32:35], v210 offset:52224
  ds_read_b128 a[36:39], v211 offset:52224
  ds_read_b128 a[40:43], v212 offset:52224
  ds_read_b128 a[44:47], v213 offset:52224
  ds_read_b128 a[0:3], v214 offset:52224
  ds_read_b128 a[4:7], v215 offset:52224
  v_add_f32 v254, v254, v168
  v_fmac_f32 v255, v168, v168
  v_add_f32 v254, v254, v169
  v_fmac_f32 v255, v169, v169
  v_add_f32 v254, v254, v170
  v_fmac_f32 v255, v170, v170
  v_add_f32 v254, v254, v171
  v_fmac_f32 v255, v171, v171
  v_add_f32 v254, v254, v172
  v_fmac_f32 v255, v172, v172
  v_add_f32 v254, v254, v173
  v_fmac_f32 v255, v173, v173
  v_add_f32 v254, v254, v174
  v_fmac_f32 v255, v174, v174
  v_add_f32 v254, v254, v175
  v_fmac_f32 v255, v175, v175
  ds_write_b64 v247, v[254:255] offset:0
  s_waitcnt lgkmcnt(8)
  v_mfma_f32_32x32x16_bf16 v[16:31], a[144:147], a[24:27], v[16:31]
  ds_read_b128 a[8:11], v216 offset:52224
  s_waitcnt lgkmcnt(1)
  v_mfma_f32_32x32x16_bf16 v[16:31], a[148:151], a[28:31], v[16:31]
  s_barrier
  ds_read_b128 v[226:229], v248 offset:0
  ds_read_b128 v[230:233], v248 offset:1024
  ds_read_b128 a[12:15], v217 offset:52224
  v_mfma_f32_32x32x16_bf16 v[16:31], a[152:155], a[32:35], v[16:31]
  ds_read_b128 a[16:19], v218 offset:52224
  s_add_u32 s52, s41, 688128
  s_add_u32 m0, s39, 104448
  s_nop 0
  buffer_load_dwordx4 v242, s[8:11], s52 offen offset:0 lds
  v_mfma_f32_32x32x16_bf16 v[48:63], a[156:159], a[36:39], v[48:63]
  ds_read_b128 a[20:23], v219 offset:52224
  v_mfma_f32_32x32x16_bf16 v[48:63], a[160:163], a[40:43], v[48:63]
  ds_read_b128 a[24:27], v220 offset:52224
  s_waitcnt lgkmcnt(5)
  v_add_f32 v226, v226, v228
  v_add_f32 v227, v227, v229
  s_waitcnt lgkmcnt(4)
  v_add_f32 v230, v230, v232
  v_add_f32 v231, v231, v233
  v_add_f32 v226, v226, v230
  v_mfma_f32_32x32x16_bf16 v[48:63], a[164:167], a[44:47], v[48:63]
  ds_read_b128 a[28:31], v221 offset:52224
  buffer_load_dwordx4 v243, s[8:11], s52 offen offset:1024 lds
  v_add_f32 v227, v227, v231
  v_mul_f32 v226, s59, v226
  v_mul_f32 v228, v226, v226
  v_mfma_f32_32x32x16_bf16 v[80:95], a[168:171], a[0:3], v[80:95]
  ds_read_b128 a[32:35], v222 offset:52224
  v_fma_f32 v227, v227, s59, -v228
  v_max_f32 v227, 0, v227
  v_add_f32 v227, 0x3727c5ac, v227
  v_rsq_f32 v227, v227
  v_subrev_u32 v234, 13056, v246
  v_mfma_f32_32x32x16_bf16 v[80:95], a[172:175], a[4:7], v[80:95]
  ds_read_b128 a[36:39], v223 offset:52224
  v_mul_f32 v228, 0x3eeff558, v227
  v_mul_f32_e64 v229, v226, v228
  v_fma_f32 v8, v8, v228, -v229
  v_fma_f32 v9, v9, v228, -v229
  v_mfma_f32_32x32x16_bf16 v[80:95], a[176:179], a[8:11], v[80:95]
  ds_read_b128 a[40:43], v224 offset:52224
  buffer_load_dwordx4 v244, s[8:11], s52 offen offset:2048 lds
  v_fma_f32 v10, v10, v228, -v229
  v_fma_f32 v11, v11, v228, -v229
  s_waitcnt lgkmcnt(7)
  v_mfma_f32_32x32x16_bf16 v[112:127], a[180:183], a[12:15], v[112:127]
  ds_read_b128 a[44:47], v225 offset:52224
  v_fma_f32 v12, v12, v228, -v229
  v_fma_f32 v13, v13, v228, -v229
  v_fma_f32 v14, v14, v228, -v229
  v_fma_f32 v15, v15, v228, -v229
  s_waitcnt lgkmcnt(7)
  v_mfma_f32_32x32x16_bf16 v[112:127], a[184:187], a[16:19], v[112:127]
  v_fma_f32 v40, v40, v228, -v229
  v_fma_f32 v41, v41, v228, -v229
  v_fma_f32 v42, v42, v228, -v229
  v_fma_f32 v43, v43, v228, -v229
  v_fma_f32 v44, v44, v228, -v229
  v_fma_f32 v45, v45, v228, -v229
  s_waitcnt lgkmcnt(6)
  v_mfma_f32_32x32x16_bf16 v[112:127], a[188:191], a[20:23], v[112:127]
  s_add_u32 m0, s68, 121216
  s_mov_b32 exec_hi, 0xffff
  buffer_load_dwordx4 v202, s[8:11], 0 offen lds
  s_mov_b32 exec_hi, -1
  v_fma_f32 v46, v46, v228, -v229
  v_fma_f32 v47, v47, v228, -v229
  v_cvt_pk_bf16_f32 v8, v8, v9
  v_cvt_pk_bf16_f32 v9, v12, v13
  s_waitcnt lgkmcnt(5)
  v_mfma_f32_32x32x16_bf16 v[144:159], a[192:195], a[24:27], v[144:159]
  v_cvt_pk_bf16_f32 v12, v10, v11
  v_cvt_pk_bf16_f32 v13, v14, v15
  v_cvt_pk_bf16_f32 v10, v40, v41
  v_cvt_pk_bf16_f32 v11, v44, v45
  v_cvt_pk_bf16_f32 v14, v42, v43
  v_cvt_pk_bf16_f32 v15, v46, v47
  s_waitcnt lgkmcnt(4)
  v_mfma_f32_32x32x16_bf16 v[144:159], a[196:199], a[28:31], v[144:159]
  s_mov_b32 exec_lo, 0
  ds_write_b128 v234, v[8:11] offset:0
  s_mov_b32 exec_lo, -1
  s_waitcnt lgkmcnt(4)
  v_mfma_f32_32x32x16_bf16 v[144:159], a[200:203], a[32:35], v[144:159]
  s_mov_b32 exec_lo, 0
  ds_write_b128 v234, v[12:15] offset:512
  s_mov_b32 exec_lo, -1
  s_waitcnt lgkmcnt(4)
  v_mfma_f32_32x32x16_bf16 v[176:191], a[204:207], a[36:39], v[176:191]
  v_fma_f32 v72, v72, v228, -v229
  v_fma_f32 v73, v73, v228, -v229
  v_fma_f32 v74, v74, v228, -v229
  v_fma_f32 v75, v75, v228, -v229
  v_fma_f32 v76, v76, v228, -v229
  v_fma_f32 v77, v77, v228, -v229
  s_waitcnt lgkmcnt(3)
  v_mfma_f32_32x32x16_bf16 v[176:191], a[208:211], a[40:43], v[176:191]
  v_fma_f32 v78, v78, v228, -v229
  v_fma_f32 v79, v79, v228, -v229
  v_fma_f32 v104, v104, v228, -v229
  v_fma_f32 v105, v105, v228, -v229
  v_fma_f32 v106, v106, v228, -v229
  v_fma_f32 v107, v107, v228, -v229
  s_waitcnt lgkmcnt(2)
  v_mfma_f32_32x32x16_bf16 v[176:191], a[212:215], a[44:47], v[176:191]
  v_fma_f32 v108, v108, v228, -v229
  v_fma_f32 v109, v109, v228, -v229
  v_fma_f32 v110, v110, v228, -v229
  v_fma_f32 v111, v111, v228, -v229
  v_cvt_pk_bf16_f32 v72, v72, v73
  v_cvt_pk_bf16_f32 v73, v76, v77
  buffer_load_dword v253, off, s[32:35], 0 offset:128 sc1
  v_cvt_pk_bf16_f32 v76, v74, v75
  v_cvt_pk_bf16_f32 v77, v78, v79
  v_cvt_pk_bf16_f32 v74, v104, v105
  v_cvt_pk_bf16_f32 v75, v108, v109
  v_cvt_pk_bf16_f32 v78, v106, v107
  v_cvt_pk_bf16_f32 v79, v110, v111
  s_mov_b32 exec_lo, 0
  ds_write_b128 v234, v[72:75] offset:1024
  s_mov_b32 exec_lo, -1
  s_mov_b32 exec_lo, 0
  ds_write_b128 v234, v[76:79] offset:1536
  s_mov_b32 exec_lo, -1
  v_pk_fma_f32 v[136:137], v[136:137], v[228:229], v[228:229] op_sel:[0,0,1] op_sel_hi:[1,0,1] neg_lo:[0,0,1] neg_hi:[0,0,1]
  v_pk_fma_f32 v[138:139], v[138:139], v[228:229], v[228:229] op_sel:[0,0,1] op_sel_hi:[1,0,1] neg_lo:[0,0,1] neg_hi:[0,0,1]
  v_pk_fma_f32 v[140:141], v[140:141], v[228:229], v[228:229] op_sel:[0,0,1] op_sel_hi:[1,0,1] neg_lo:[0,0,1] neg_hi:[0,0,1]
  v_pk_fma_f32 v[142:143], v[142:143], v[228:229], v[228:229] op_sel:[0,0,1] op_sel_hi:[1,0,1] neg_lo:[0,0,1] neg_hi:[0,0,1]
  v_pk_fma_f32 v[168:169], v[168:169], v[228:229], v[228:229] op_sel:[0,0,1] op_sel_hi:[1,0,1] neg_lo:[0,0,1] neg_hi:[0,0,1]
  v_pk_fma_f32 v[170:171], v[170:171], v[228:229], v[228:229] op_sel:[0,0,1] op_sel_hi:[1,0,1] neg_lo:[0,0,1] neg_hi:[0,0,1]
  v_pk_fma_f32 v[172:173], v[172:173], v[228:229], v[228:229] op_sel:[0,0,1] op_sel_hi:[1,0,1] neg_lo:[0,0,1] neg_hi:[0,0,1]
  v_pk_fma_f32 v[174:175], v[174:175], v[228:229], v[228:229] op_sel:[0,0,1] op_sel_hi:[1,0,1] neg_lo:[0,0,1] neg_hi:[0,0,1]
  v_cvt_pk_bf16_f32 v136, v136, v137
  v_cvt_pk_bf16_f32 v137, v140, v141
  v_cvt_pk_bf16_f32 v140, v138, v139
  v_cvt_pk_bf16_f32 v141, v142, v143
  v_cvt_pk_bf16_f32 v138, v168, v169
  v_cvt_pk_bf16_f32 v139, v172, v173
  v_cvt_pk_bf16_f32 v142, v170, v171
  v_cvt_pk_bf16_f32 v143, v174, v175
  s_mov_b32 exec_lo, 0
  ds_write_b128 v234, v[136:139] offset:2048
  s_mov_b32 exec_lo, -1
  s_mov_b32 exec_lo, 0
  ds_write_b128 v234, v[140:143] offset:2560
  s_mov_b32 exec_lo, -1
  s_waitcnt vmcnt(8)
  s_barrier
  v_add_u32 v208, 78336, v208
  v_add_u32 v209, 78336, v209
  v_add_u32 v210, 78336, v210
  v_add_u32 v211, 78336, v211
  v_add_u32 v212, 78336, v212
  v_add_u32 v213, 78336, v213
  v_add_u32 v214, 78336, v214
  v_add_u32 v215, 78336, v215
  v_add_u32 v216, 78336, v216
  v_add_u32 v217, 78336, v217
  v_add_u32 v218, 78336, v218
  v_add_u32 v219, 78336, v219
  v_add_u32 v220, 78336, v220
  v_add_u32 v221, 78336, v221
  v_add_u32 v222, 78336, v222
  v_add_u32 v223, 78336, v223
  v_add_u32 v224, 78336, v224
  v_add_u32 v225, 78336, v225
  ds_read_b128 a[24:27], v208 offset:0
  ds_read_b128 a[28:31], v209 offset:0
  ds_read_b128 a[32:35], v210 offset:0
  ds_read_b128 a[36:39], v211 offset:0
  ds_read_b128 a[40:43], v212 offset:0
  ds_read_b128 a[44:47], v213 offset:0
  ds_read_b128 a[0:3], v214 offset:0
  ds_read_b128 a[4:7], v215 offset:0
  v_pk_add_f32 v[236:237], v[16:17], v[18:19]
  v_pk_mul_f32 v[240:241], v[16:17], v[16:17]
  v_pk_add_f32 v[238:239], v[20:21], v[22:23]
  v_pk_mul_f32 v[254:255], v[18:19], v[18:19]
  v_pk_fma_f32 v[240:241], v[20:21], v[20:21], v[240:241]
  v_pk_fma_f32 v[254:255], v[22:23], v[22:23], v[254:255]
  v_pk_add_f32 v[236:237], v[236:237], v[48:49]
  v_pk_fma_f32 v[240:241], v[48:49], v[48:49], v[240:241]
  v_pk_add_f32 v[238:239], v[238:239], v[50:51]
  v_pk_fma_f32 v[254:255], v[50:51], v[50:51], v[254:255]
  v_pk_add_f32 v[236:237], v[236:237], v[52:53]
  v_pk_fma_f32 v[240:241], v[52:53], v[52:53], v[240:241]
  v_pk_add_f32 v[238:239], v[238:239], v[54:55]
  v_pk_fma_f32 v[254:255], v[54:55], v[54:55], v[254:255]
  v_pk_add_f32 v[236:237], v[236:237], v[80:81]
  v_pk_fma_f32 v[240:241], v[80:81], v[80:81], v[240:241]
  v_pk_add_f32 v[238:239], v[238:239], v[82:83]
  v_pk_fma_f32 v[254:255], v[82:83], v[82:83], v[254:255]
  v_pk_add_f32 v[236:237], v[236:237], v[84:85]
  v_pk_fma_f32 v[240:241], v[84:85], v[84:85], v[240:241]
  v_pk_add_f32 v[238:239], v[238:239], v[86:87]
  v_pk_fma_f32 v[254:255], v[86:87], v[86:87], v[254:255]
  v_pk_add_f32 v[236:237], v[236:237], v[112:113]
  v_pk_fma_f32 v[240:241], v[112:113], v[112:113], v[240:241]
  v_pk_add_f32 v[238:239], v[238:239], v[114:115]
  v_pk_fma_f32 v[254:255], v[114:115], v[114:115], v[254:255]
  v_pk_add_f32 v[236:237], v[236:237], v[116:117]
  v_pk_fma_f32 v[240:241], v[116:117], v[116:117], v[240:241]
  v_pk_add_f32 v[238:239], v[238:239], v[118:119]
  v_pk_fma_f32 v[254:255], v[118:119], v[118:119], v[254:255]
  v_pk_add_f32 v[236:237], v[236:237], v[144:145]
  v_pk_fma_f32 v[240:241], v[144:145], v[144:145], v[240:241]
  v_pk_add_f32 v[238:239], v[238:239], v[146:147]
  v_pk_fma_f32 v[254:255], v[146:147], v[146:147], v[254:255]
  v_pk_add_f32 v[236:237], v[236:237], v[148:149]
  v_pk_fma_f32 v[240:241], v[148:149], v[148:149], v[240:241]
  v_pk_add_f32 v[238:239], v[238:239], v[150:151]
  v_pk_fma_f32 v[254:255], v[150:151], v[150:151], v[254:255]
  v_pk_add_f32 v[236:237], v[236:237], v[176:177]
  v_pk_fma_f32 v[240:241], v[176:177], v[176:177], v[240:241]
  v_pk_add_f32 v[238:239], v[238:239], v[178:179]
  v_pk_fma_f32 v[254:255], v[178:179], v[178:179], v[254:255]
  v_pk_add_f32 v[236:237], v[236:237], v[180:181]
  v_pk_fma_f32 v[240:241], v[180:181], v[180:181], v[240:241]
  v_pk_add_f32 v[238:239], v[238:239], v[182:183]
  v_pk_fma_f32 v[254:255], v[182:183], v[182:183], v[254:255]
  v_pk_add_f32 v[236:237], v[236:237], v[238:239]
  v_pk_add_f32 v[240:241], v[240:241], v[254:255]
  v_add_f32 v254, v236, v237
  v_add_f32 v255, v240, v241
  ds_write_b64 v247, v[254:255] offset:2048
  s_waitcnt vmcnt(0)
  v_readfirstlane_b32 s4, v253
  s_cmp_lt_u32 s4, 0x800
  s_cbranch_scc1 L_slow0
L_back0:
  s_waitcnt lgkmcnt(8)
  v_mfma_f32_32x32x16_bf16 v[24:39], a[144:147], a[24:27], v[24:39]
  ds_read_b128 a[8:11], v216 offset:0
  s_waitcnt lgkmcnt(1)
  v_mfma_f32_32x32x16_bf16 v[24:39], a[148:151], a[28:31], v[24:39]
  s_barrier
  ds_read_b128 v[226:229], v248 offset:2048
  ds_read_b128 v[230:233], v248 offset:3072
  ds_read_b128 a[12:15], v217 offset:0
  v_mfma_f32_32x32x16_bf16 v[24:39], a[152:155], a[32:35], v[24:39]
  ds_read_b128 a[16:19], v218 offset:0
  s_add_u32 s58, s78, 12288
  buffer_load_dwordx4 a[96:99], v248, s[20:23], s58 offen offset:0 sc1
  v_mfma_f32_32x32x16_bf16 v[56:71], a[156:159], a[36:39], v[56:71]
  ds_read_b128 a[20:23], v219 offset:0
  v_mfma_f32_32x32x16_bf16 v[56:71], a[160:163], a[40:43], v[56:71]
  ds_read_b128 a[24:27], v220 offset:0
  s_waitcnt lgkmcnt(5)
  v_add_f32 v226, v226, v228
  v_add_f32 v227, v227, v229
  s_waitcnt lgkmcnt(4)
  v_add_f32 v230, v230, v232
  v_add_f32 v231, v231, v233
  v_add_f32 v226, v226, v230
  v_mfma_f32_32x32x16_bf16 v[56:71], a[164:167], a[44:47], v[56:71]
  ds_read_b128 a[28:31], v221 offset:0
  buffer_load_dwordx4 a[100:103], v248, s[20:23], s58 offen offset:1024 sc1
  v_add_f32 v227, v227, v231
  v_mul_f32 v226, s59, v226
  v_mul_f32 v228, v226, v226
  v_mfma_f32_32x32x16_bf16 v[88:103], a[168:171], a[0:3], v[88:103]
  ds_read_b128 a[32:35], v222 offset:0
  v_fma_f32 v227, v227, s59, -v228
  v_max_f32 v227, 0, v227
  v_add_f32 v227, 0x3727c5ac, v227
  v_rsq_f32 v227, v227
  s_nop 0
  v_mul_f32 v228, 0x3eeff558, v227
  v_mfma_f32_32x32x16_bf16 v[88:103], a[172:175], a[4:7], v[88:103]
  ds_read_b128 a[36:39], v223 offset:0
  v_mul_f32 v229, v226, v228
  v_fma_f32 v16, v16, v228, -v229
  v_fma_f32 v17, v17, v228, -v229
  v_fma_f32 v18, v18, v228, -v229
  v_fma_f32 v19, v19, v228, -v229
  v_mfma_f32_32x32x16_bf16 v[88:103], a[176:179], a[8:11], v[88:103]
  ds_read_b128 a[40:43], v224 offset:0
  buffer_load_dwordx4 a[104:107], v248, s[20:23], s58 offen offset:2048 sc1
  v_fma_f32 v20, v20, v228, -v229
  v_fma_f32 v21, v21, v228, -v229
  s_waitcnt lgkmcnt(7)
  v_mfma_f32_32x32x16_bf16 v[120:135], a[180:183], a[12:15], v[120:135]
  ds_read_b128 a[44:47], v225 offset:0
  v_fma_f32 v22, v22, v228, -v229
  v_fma_f32 v23, v23, v228, -v229
  v_fma_f32 v48, v48, v228, -v229
  v_fma_f32 v49, v49, v228, -v229
  s_waitcnt lgkmcnt(7)
  v_mfma_f32_32x32x16_bf16 v[120:135], a[184:187], a[16:19], v[120:135]
  v_fma_f32 v50, v50, v228, -v229
  v_fma_f32 v51, v51, v228, -v229
  v_fma_f32 v52, v52, v228, -v229
  v_fma_f32 v53, v53, v228, -v229
  v_fma_f32 v54, v54, v228, -v229
  v_fma_f32 v55, v55, v228, -v229
  s_waitcnt lgkmcnt(6)
  v_mfma_f32_32x32x16_bf16 v[120:135], a[188:191], a[20:23], v[120:135]
  buffer_load_dwordx4 a[108:111], v248, s[20:23], s58 offen offset:3072 sc1
  v_cvt_pk_bf16_f32 v16, v16, v17
  v_cvt_pk_bf16_f32 v17, v20, v21
  v_cvt_pk_bf16_f32 v20, v18, v19
  v_cvt_pk_bf16_f32 v21, v22, v23
  s_waitcnt lgkmcnt(5)
  v_mfma_f32_32x32x16_bf16 v[152:167], a[192:195], a[24:27], v[152:167]
  v_cvt_pk_bf16_f32 v18, v48, v49
  v_cvt_pk_bf16_f32 v19, v52, v53
  v_cvt_pk_bf16_f32 v22, v50, v51
  v_cvt_pk_bf16_f32 v23, v54, v55
  s_waitcnt lgkmcnt(4)
  v_mfma_f32_32x32x16_bf16 v[152:167], a[196:199], a[28:31], v[152:167]
  ds_write_b128 v246, v[16:19] offset:13056
  s_waitcnt lgkmcnt(4)
  v_mfma_f32_32x32x16_bf16 v[152:167], a[200:203], a[32:35], v[152:167]
  s_add_u32 s58, s78, 16384
  buffer_load_dwordx4 a[112:115], v248, s[20:23], s58 offen offset:0 sc1
  s_waitcnt lgkmcnt(3)
  v_mfma_f32_32x32x16_bf16 v[184:199], a[204:207], a[36:39], v[184:199]
  ds_write_b128 v246, v[20:23] offset:13568
  s_waitcnt lgkmcnt(3)
  v_mfma_f32_32x32x16_bf16 v[184:199], a[208:211], a[40:43], v[184:199]
  v_fma_f32 v80, v80, v228, -v229
  v_fma_f32 v81, v81, v228, -v229
  v_fma_f32 v82, v82, v228, -v229
  v_fma_f32 v83, v83, v228, -v229
  v_fma_f32 v84, v84, v228, -v229
  v_fma_f32 v85, v85, v228, -v229
  s_waitcnt lgkmcnt(2)
  v_mfma_f32_32x32x16_bf16 v[184:199], a[212:215], a[44:47], v[184:199]
  buffer_load_dwordx4 a[116:119], v248, s[20:23], s58 offen offset:1024 sc1
  v_fma_f32 v86, v86, v228, -v229
  v_fma_f32 v87, v87, v228, -v229
  v_fma_f32 v112, v112, v228, -v229
  v_fma_f32 v113, v113, v228, -v229
  v_pk_fma_f32 v[114:115], v[114:115], v[228:229], v[228:229] op_sel:[0,0,1] op_sel_hi:[1,0,1] neg_lo:[0,0,1] neg_hi:[0,0,1]
  v_pk_fma_f32 v[116:117], v[116:117], v[228:229], v[228:229] op_sel:[0,0,1] op_sel_hi:[1,0,1] neg_lo:[0,0,1] neg_hi:[0,0,1]
  v_pk_fma_f32 v[118:119], v[118:119], v[228:229], v[228:229] op_sel:[0,0,1] op_sel_hi:[1,0,1] neg_lo:[0,0,1] neg_hi:[0,0,1]
  v_cvt_pk_bf16_f32 v80, v80, v81
  buffer_load_dwordx4 a[120:123], v248, s[20:23], s58 offen offset:2048 sc1
  v_cvt_pk_bf16_f32 v81, v84, v85
  v_cvt_pk_bf16_f32 v84, v82, v83
  v_cvt_pk_bf16_f32 v85, v86, v87
  v_cvt_pk_bf16_f32 v82, v112, v113
  buffer_load_dwordx4 a[124:127], v248, s[20:23], s58 offen offset:3072 sc1
  v_cvt_pk_bf16_f32 v83, v116, v117
  v_cvt_pk_bf16_f32 v86, v114, v115
  v_cvt_pk_bf16_f32 v87, v118, v119
  ds_write_b128 v246, v[80:83] offset:14080
  s_add_u32 s58, s78, 20480
  buffer_load_dwordx4 a[128:131], v248, s[20:23], s58 offen offset:0 sc1
  ds_write_b128 v246, v[84:87] offset:14592
  v_pk_fma_f32 v[144:145], v[144:145], v[228:229], v[228:229] op_sel:[0,0,1] op_sel_hi:[1,0,1] neg_lo:[0,0,1] neg_hi:[0,0,1]
  v_pk_fma_f32 v[146:147], v[146:147], v[228:229], v[228:229] op_sel:[0,0,1] op_sel_hi:[1,0,1] neg_lo:[0,0,1] neg_hi:[0,0,1]
  v_pk_fma_f32 v[148:149], v[148:149], v[228:229], v[228:229] op_sel:[0,0,1] op_sel_hi:[1,0,1] neg_lo:[0,0,1] neg_hi:[0,0,1]
  buffer_load_dwordx4 a[132:135], v248, s[20:23], s58 offen offset:1024 sc1
  v_pk_fma_f32 v[150:151], v[150:151], v[228:229], v[228:229] op_sel:[0,0,1] op_sel_hi:[1,0,1] neg_lo:[0,0,1] neg_hi:[0,0,1]
  v_pk_fma_f32 v[176:177], v[176:177], v[228:229], v[228:229] op_sel:[0,0,1] op_sel_hi:[1,0,1] neg_lo:[0,0,1] neg_hi:[0,0,1]
  v_pk_fma_f32 v[178:179], v[178:179], v[228:229], v[228:229] op_sel:[0,0,1] op_sel_hi:[1,0,1] neg_lo:[0,0,1] neg_hi:[0,0,1]
  v_pk_fma_f32 v[180:181], v[180:181], v[228:229], v[228:229] op_sel:[0,0,1] op_sel_hi:[1,0,1] neg_lo:[0,0,1] neg_hi:[0,0,1]
  buffer_load_dwordx4 a[136:139], v248, s[20:23], s58 offen offset:2048 sc1
  v_pk_fma_f32 v[182:183], v[182:183], v[228:229], v[228:229] op_sel:[0,0,1] op_sel_hi:[1,0,1] neg_lo:[0,0,1] neg_hi:[0,0,1]
  v_cvt_pk_bf16_f32 v144, v144, v145
  v_cvt_pk_bf16_f32 v145, v148, v149
  v_cvt_pk_bf16_f32 v148, v146, v147
  buffer_load_dwordx4 a[140:143], v248, s[20:23], s58 offen offset:3072 sc1
  v_cvt_pk_bf16_f32 v149, v150, v151
  v_cvt_pk_bf16_f32 v146, v176, v177
  v_cvt_pk_bf16_f32 v147, v180, v181
  v_cvt_pk_bf16_f32 v150, v178, v179
  v_cvt_pk_bf16_f32 v151, v182, v183
  ds_write_b128 v246, v[144:147] offset:15104
  ds_write_b128 v246, v[148:151] offset:15616
  s_barrier
  ds_read_b128 a[24:27], v208 offset:26112
  ds_read_b128 a[28:31], v209 offset:26112
  ds_read_b128 a[32:35], v210 offset:26112
  ds_read_b128 a[36:39], v211 offset:26112
  ds_read_b128 a[40:43], v212 offset:26112
  ds_read_b128 a[44:47], v213 offset:26112
  ds_read_b128 a[0:3], v214 offset:26112
  ds_read_b128 a[4:7], v215 offset:26112
  v_pk_add_f32 v[236:237], v[24:25], v[26:27]
  v_pk_mul_f32 v[240:241], v[24:25], v[24:25]
  v_pk_add_f32 v[238:239], v[28:29], v[30:31]
  v_pk_mul_f32 v[254:255], v[26:27], v[26:27]
  v_pk_fma_f32 v[240:241], v[28:29], v[28:29], v[240:241]
  v_pk_fma_f32 v[254:255], v[30:31], v[30:31], v[254:255]
  v_pk_add_f32 v[236:237], v[236:237], v[56:57]
  v_pk_fma_f32 v[240:241], v[56:57], v[56:57], v[240:241]
  v_pk_add_f32 v[238:239], v[238:239], v[58:59]
  v_pk_fma_f32 v[254:255], v[58:59], v[58:59], v[254:255]
  v_pk_add_f32 v[236:237], v[236:237], v[60:61]
  v_pk_fma_f32 v[240:241], v[60:61], v[60:61], v[240:241]
  v_pk_add_f32 v[238:239], v[238:239], v[62:63]
  v_pk_fma_f32 v[254:255], v[62:63], v[62:63], v[254:255]
  v_pk_add_f32 v[236:237], v[236:237], v[88:89]
  v_pk_fma_f32 v[240:241], v[88:89], v[88:89], v[240:241]
  v_pk_add_f32 v[238:239], v[238:239], v[90:91]
  v_pk_fma_f32 v[254:255], v[90:91], v[90:91], v[254:255]
  v_pk_add_f32 v[236:237], v[236:237], v[92:93]
  v_pk_fma_f32 v[240:241], v[92:93], v[92:93], v[240:241]
  v_pk_add_f32 v[238:239], v[238:239], v[94:95]
  v_pk_fma_f32 v[254:255], v[94:95], v[94:95], v[254:255]
  v_pk_add_f32 v[236:237], v[236:237], v[120:121]
  v_pk_fma_f32 v[240:241], v[120:121], v[120:121], v[240:241]
  v_pk_add_f32 v[238:239], v[238:239], v[122:123]
  v_pk_fma_f32 v[254:255], v[122:123], v[122:123], v[254:255]
  v_pk_add_f32 v[236:237], v[236:237], v[124:125]
  v_pk_fma_f32 v[240:241], v[124:125], v[124:125], v[240:241]
  v_pk_add_f32 v[238:239], v[238:239], v[126:127]
  v_pk_fma_f32 v[254:255], v[126:127], v[126:127], v[254:255]
  v_pk_add_f32 v[236:237], v[236:237], v[152:153]
  v_pk_fma_f32 v[240:241], v[152:153], v[152:153], v[240:241]
  v_pk_add_f32 v[238:239], v[238:239], v[154:155]
  v_pk_fma_f32 v[254:255], v[154:155], v[154:155], v[254:255]
  v_pk_add_f32 v[236:237], v[236:237], v[156:157]
  v_pk_fma_f32 v[240:241], v[156:157], v[156:157], v[240:241]
  v_pk_add_f32 v[238:239], v[238:239], v[158:159]
  v_pk_fma_f32 v[254:255], v[158:159], v[158:159], v[254:255]
  v_pk_add_f32 v[236:237], v[236:237], v[184:185]
  v_pk_fma_f32 v[240:241], v[184:185], v[184:185], v[240:241]
  v_pk_add_f32 v[238:239], v[238:239], v[186:187]
  v_pk_fma_f32 v[254:255], v[186:187], v[186:187], v[254:255]
  v_pk_add_f32 v[236:237], v[236:237], v[188:189]
  v_pk_fma_f32 v[240:241], v[188:189], v[188:189], v[240:241]
  v_pk_add_f32 v[238:239], v[238:239], v[190:191]
  v_pk_fma_f32 v[254:255], v[190:191], v[190:191], v[254:255]
  v_pk_add_f32 v[236:237], v[236:237], v[238:239]
  v_pk_add_f32 v[240:241], v[240:241], v[254:255]
  v_add_f32 v254, v236, v237
  v_add_f32 v255, v240, v241
  ds_write_b64 v247, v[254:255] offset:0
  s_waitcnt lgkmcnt(8)
  v_mfma_f32_32x32x16_bf16 v[32:47], a[144:147], a[24:27], v[32:47]
  ds_read_b128 a[8:11], v216 offset:26112
  s_waitcnt lgkmcnt(1)
  v_mfma_f32_32x32x16_bf16 v[32:47], a[148:151], a[28:31], v[32:47]
  s_barrier
  ds_read_b128 v[226:229], v248 offset:0
  ds_read_b128 v[230:233], v248 offset:1024
  ds_read_b128 a[12:15], v217 offset:26112
  v_mfma_f32_32x32x16_bf16 v[32:47], a[152:155], a[32:35], v[32:47]
  ds_read_b128 a[16:19], v218 offset:26112
  s_add_u32 s58, s78, 0
  buffer_load_dwordx4 a[48:51], v248, s[20:23], s58 offen offset:0 sc1
  v_mfma_f32_32x32x16_bf16 v[64:79], a[156:159], a[36:39], v[64:79]
  ds_read_b128 a[20:23], v219 offset:26112
  v_mfma_f32_32x32x16_bf16 v[64:79], a[160:163], a[40:43], v[64:79]
  ds_read_b128 a[24:27], v220 offset:26112
  s_waitcnt lgkmcnt(5)
  v_add_f32 v226, v226, v228
  v_add_f32 v227, v227, v229
  s_waitcnt lgkmcnt(4)
  v_add_f32 v230, v230, v232
  v_add_f32 v231, v231, v233
  v_add_f32 v226, v226, v230
  v_mfma_f32_32x32x16_bf16 v[64:79], a[164:167], a[44:47], v[64:79]
  ds_read_b128 a[28:31], v221 offset:26112
  buffer_load_dwordx4 a[52:55], v248, s[20:23], s58 offen offset:1024 sc1
  v_add_f32 v227, v227, v231
  v_mul_f32 v226, s59, v226
  v_mul_f32 v228, v226, v226
  v_mfma_f32_32x32x16_bf16 v[96:111], a[168:171], a[0:3], v[96:111]
  ds_read_b128 a[32:35], v222 offset:26112
  v_fma_f32 v227, v227, s59, -v228
  v_max_f32 v227, 0, v227
  v_add_f32 v227, 0x3727c5ac, v227
  v_rsq_f32 v227, v227
  s_nop 0
  v_mul_f32 v228, 0x3eeff558, v227
  v_mfma_f32_32x32x16_bf16 v[96:111], a[172:175], a[4:7], v[96:111]
  ds_read_b128 a[36:39], v223 offset:26112
  v_mul_f32_e64 v229, v226, v228
  v_fma_f32 v24, v24, v228, -v229
  v_fma_f32 v25, v25, v228, -v229
  v_fma_f32 v26, v26, v228, -v229
  v_fma_f32 v27, v27, v228, -v229
  v_mfma_f32_32x32x16_bf16 v[96:111], a[176:179], a[8:11], v[96:111]
  ds_read_b128 a[40:43], v224 offset:26112
  buffer_load_dwordx4 a[56:59], v248, s[20:23], s58 offen offset:2048 sc1
  v_fma_f32 v28, v28, v228, -v229
  v_fma_f32 v29, v29, v228, -v229
  s_waitcnt lgkmcnt(7)
  v_mfma_f32_32x32x16_bf16 v[128:143], a[180:183], a[12:15], v[128:143]
  ds_read_b128 a[44:47], v225 offset:26112
  v_fma_f32 v30, v30, v228, -v229
  v_fma_f32 v31, v31, v228, -v229
  v_fma_f32 v56, v56, v228, -v229
  v_fma_f32 v57, v57, v228, -v229
  s_waitcnt lgkmcnt(7)
  v_mfma_f32_32x32x16_bf16 v[128:143], a[184:187], a[16:19], v[128:143]
  ds_read_b128 a[0:3], v249 offset:0
  v_fma_f32 v58, v58, v228, -v229
  v_fma_f32 v59, v59, v228, -v229
  v_fma_f32 v60, v60, v228, -v229
  v_fma_f32 v61, v61, v228, -v229
  s_waitcnt lgkmcnt(7)
  v_mfma_f32_32x32x16_bf16 v[128:143], a[188:191], a[20:23], v[128:143]
  ds_read_b128 a[4:7], v249 offset:1024
  buffer_load_dwordx4 a[60:63], v248, s[20:23], s58 offen offset:3072 sc1
  v_fma_f32 v62, v62, v228, -v229
  v_fma_f32 v63, v63, v228, -v229
  v_cvt_pk_bf16_f32 v24, v24, v25
  s_waitcnt lgkmcnt(7)
  v_mfma_f32_32x32x16_bf16 v[160:175], a[192:195], a[24:27], v[160:175]
  ds_read_b128 a[8:11], v249 offset:2048
  ds_read_b128 a[12:15], v249 offset:3072
  v_cvt_pk_bf16_f32 v25, v28, v29
  v_cvt_pk_bf16_f32 v28, v26, v27
  v_cvt_pk_bf16_f32 v29, v30, v31
  v_cvt_pk_bf16_f32 v26, v56, v57
  s_waitcnt lgkmcnt(8)
  v_mfma_f32_32x32x16_bf16 v[160:175], a[196:199], a[28:31], v[160:175]
  ds_read_b128 a[16:19], v249 offset:4096
  ds_read_b128 a[20:23], v249 offset:5120
  v_cvt_pk_bf16_f32 v27, v60, v61
  v_cvt_pk_bf16_f32 v30, v58, v59
  v_cvt_pk_bf16_f32 v31, v62, v63
  s_waitcnt lgkmcnt(9)
  v_mfma_f32_32x32x16_bf16 v[160:175], a[200:203], a[32:35], v[160:175]
  ds_read_b128 a[24:27], v249 offset:6144
  ds_read_b128 a[28:31], v249 offset:7168
  s_add_u32 s58, s78, 4096
  buffer_load_dwordx4 a[64:67], v248, s[20:23], s58 offen offset:0 sc1
  s_waitcnt lgkmcnt(10)
  v_mfma_f32_32x32x16_bf16 v[192:207], a[204:207], a[36:39], v[192:207]
  ds_read_b128 a[32:35], v249 offset:8192
  ds_write_b128 v246, v[24:27] offset:39168
  s_waitcnt lgkmcnt(11)
  v_mfma_f32_32x32x16_bf16 v[192:207], a[208:211], a[40:43], v[192:207]
  ds_read_b128 a[36:39], v249 offset:9216
  ds_write_b128 v246, v[28:31] offset:39680
  s_waitcnt lgkmcnt(12)
  v_mfma_f32_32x32x16_bf16 v[192:207], a[212:215], a[44:47], v[192:207]
  ds_read_b128 a[40:43], v249 offset:10240
  buffer_load_dwordx4 a[68:71], v248, s[20:23], s58 offen offset:1024 sc1
  v_fma_f32 v88, v88, v228, -v229
  v_fma_f32 v89, v89, v228, -v229
  ds_read_b128 a[44:47], v249 offset:11264
  v_pk_fma_f32 v[90:91], v[90:91], v[228:229], v[228:229] op_sel:[0,0,1] op_sel_hi:[1,0,1] neg_lo:[0,0,1] neg_hi:[0,0,1]
  v_pk_fma_f32 v[92:93], v[92:93], v[228:229], v[228:229] op_sel:[0,0,1] op_sel_hi:[1,0,1] neg_lo:[0,0,1] neg_hi:[0,0,1]
  v_pk_fma_f32 v[94:95], v[94:95], v[228:229], v[228:229] op_sel:[0,0,1] op_sel_hi:[1,0,1] neg_lo:[0,0,1] neg_hi:[0,0,1]
  v_pk_fma_f32 v[120:121], v[120:121], v[228:229], v[228:229] op_sel:[0,0,1] op_sel_hi:[1,0,1] neg_lo:[0,0,1] neg_hi:[0,0,1]
  buffer_load_dwordx4 a[72:75], v248, s[20:23], s58 offen offset:2048 sc1
  v_pk_fma_f32 v[122:123], v[122:123], v[228:229], v[228:229] op_sel:[0,0,1] op_sel_hi:[1,0,1] neg_lo:[0,0,1] neg_hi:[0,0,1]
  v_pk_fma_f32 v[124:125], v[124:125], v[228:229], v[228:229] op_sel:[0,0,1] op_sel_hi:[1,0,1] neg_lo:[0,0,1] neg_hi:[0,0,1]
  v_pk_fma_f32 v[126:127], v[126:127], v[228:229], v[228:229] op_sel:[0,0,1] op_sel_hi:[1,0,1] neg_lo:[0,0,1] neg_hi:[0,0,1]
  v_cvt_pk_bf16_f32 v88, v88, v89
  buffer_load_dwordx4 a[76:79], v248, s[20:23], s58 offen offset:3072 sc1
  v_cvt_pk_bf16_f32 v89, v92, v93
  v_cvt_pk_bf16_f32 v92, v90, v91
  v_cvt_pk_bf16_f32 v93, v94, v95
  v_cvt_pk_bf16_f32 v90, v120, v121
  s_add_u32 s58, s78, 8192
  buffer_load_dwordx4 a[80:83], v248, s[20:23], s58 offen offset:0 sc1
  v_cvt_pk_bf16_f32 v91, v124, v125
  v_cvt_pk_bf16_f32 v94, v122, v123
  v_cvt_pk_bf16_f32 v95, v126, v127
  ds_write_b128 v246, v[88:91] offset:40192
  buffer_load_dwordx4 a[84:87], v248, s[20:23], s58 offen offset:1024 sc1
  ds_write_b128 v246, v[92:95] offset:40704
  v_pk_fma_f32 v[152:153], v[152:153], v[228:229], v[228:229] op_sel:[0,0,1] op_sel_hi:[1,0,1] neg_lo:[0,0,1] neg_hi:[0,0,1]
  v_pk_fma_f32 v[154:155], v[154:155], v[228:229], v[228:229] op_sel:[0,0,1] op_sel_hi:[1,0,1] neg_lo:[0,0,1] neg_hi:[0,0,1]
  v_pk_fma_f32 v[156:157], v[156:157], v[228:229], v[228:229] op_sel:[0,0,1] op_sel_hi:[1,0,1] neg_lo:[0,0,1] neg_hi:[0,0,1]
  buffer_load_dwordx4 a[88:91], v248, s[20:23], s58 offen offset:2048 sc1
  v_pk_fma_f32 v[158:159], v[158:159], v[228:229], v[228:229] op_sel:[0,0,1] op_sel_hi:[1,0,1] neg_lo:[0,0,1] neg_hi:[0,0,1]
  v_pk_fma_f32 v[184:185], v[184:185], v[228:229], v[228:229] op_sel:[0,0,1] op_sel_hi:[1,0,1] neg_lo:[0,0,1] neg_hi:[0,0,1]
  v_pk_fma_f32 v[186:187], v[186:187], v[228:229], v[228:229] op_sel:[0,0,1] op_sel_hi:[1,0,1] neg_lo:[0,0,1] neg_hi:[0,0,1]
  v_pk_fma_f32 v[188:189], v[188:189], v[228:229], v[228:229] op_sel:[0,0,1] op_sel_hi:[1,0,1] neg_lo:[0,0,1] neg_hi:[0,0,1]
  buffer_load_dwordx4 a[92:95], v248, s[20:23], s58 offen offset:3072 sc1
  v_pk_fma_f32 v[190:191], v[190:191], v[228:229], v[228:229] op_sel:[0,0,1] op_sel_hi:[1,0,1] neg_lo:[0,0,1] neg_hi:[0,0,1]
  v_cvt_pk_bf16_f32 v152, v152, v153
  v_cvt_pk_bf16_f32 v153, v156, v157
  v_cvt_pk_bf16_f32 v156, v154, v155
  v_cvt_pk_bf16_f32 v157, v158, v159
  v_cvt_pk_bf16_f32 v154, v184, v185
  v_cvt_pk_bf16_f32 v155, v188, v189
  v_cvt_pk_bf16_f32 v158, v186, v187
  v_cvt_pk_bf16_f32 v159, v190, v191
  ds_write_b128 v246, v[152:155] offset:41216
  ds_write_b128 v246, v[156:159] offset:41728
  v_pk_add_f32 v[236:237], v[32:33], v[34:35]
  v_pk_mul_f32 v[240:241], v[32:33], v[32:33]
  v_pk_add_f32 v[238:239], v[36:37], v[38:39]
  v_pk_mul_f32 v[254:255], v[34:35], v[34:35]
  v_pk_fma_f32 v[240:241], v[36:37], v[36:37], v[240:241]
  v_pk_fma_f32 v[254:255], v[38:39], v[38:39], v[254:255]
  v_pk_add_f32 v[236:237], v[236:237], v[64:65]
  v_pk_fma_f32 v[240:241], v[64:65], v[64:65], v[240:241]
  v_pk_add_f32 v[238:239], v[238:239], v[66:67]
  v_pk_fma_f32 v[254:255], v[66:67], v[66:67], v[254:255]
  v_pk_add_f32 v[236:237], v[236:237], v[68:69]
  v_pk_fma_f32 v[240:241], v[68:69], v[68:69], v[240:241]
  v_pk_add_f32 v[238:239], v[238:239], v[70:71]
  v_pk_fma_f32 v[254:255], v[70:71], v[70:71], v[254:255]
  v_pk_add_f32 v[236:237], v[236:237], v[96:97]
  v_pk_fma_f32 v[240:241], v[96:97], v[96:97], v[240:241]
  v_pk_add_f32 v[238:239], v[238:239], v[98:99]
  v_pk_fma_f32 v[254:255], v[98:99], v[98:99], v[254:255]
  v_pk_add_f32 v[236:237], v[236:237], v[100:101]
  v_pk_fma_f32 v[240:241], v[100:101], v[100:101], v[240:241]
  v_pk_add_f32 v[238:239], v[238:239], v[102:103]
  v_pk_fma_f32 v[254:255], v[102:103], v[102:103], v[254:255]
  v_pk_add_f32 v[236:237], v[236:237], v[128:129]
  v_pk_fma_f32 v[240:241], v[128:129], v[128:129], v[240:241]
  v_pk_add_f32 v[238:239], v[238:239], v[130:131]
  v_pk_fma_f32 v[254:255], v[130:131], v[130:131], v[254:255]
  v_pk_add_f32 v[236:237], v[236:237], v[132:133]
  v_pk_fma_f32 v[240:241], v[132:133], v[132:133], v[240:241]
  v_pk_add_f32 v[238:239], v[238:239], v[134:135]
  v_pk_fma_f32 v[254:255], v[134:135], v[134:135], v[254:255]
  v_pk_add_f32 v[236:237], v[236:237], v[160:161]
  v_pk_fma_f32 v[240:241], v[160:161], v[160:161], v[240:241]
  v_pk_add_f32 v[238:239], v[238:239], v[162:163]
  v_pk_fma_f32 v[254:255], v[162:163], v[162:163], v[254:255]
  v_pk_add_f32 v[236:237], v[236:237], v[164:165]
  v_pk_fma_f32 v[240:241], v[164:165], v[164:165], v[240:241]
  v_pk_add_f32 v[238:239], v[238:239], v[166:167]
  v_pk_fma_f32 v[254:255], v[166:167], v[166:167], v[254:255]
  v_pk_add_f32 v[236:237], v[236:237], v[192:193]
  v_pk_fma_f32 v[240:241], v[192:193], v[192:193], v[240:241]
  v_pk_add_f32 v[238:239], v[238:239], v[194:195]
  v_pk_fma_f32 v[254:255], v[194:195], v[194:195], v[254:255]
  v_pk_add_f32 v[236:237], v[236:237], v[196:197]
  v_pk_fma_f32 v[240:241], v[196:197], v[196:197], v[240:241]
  v_pk_add_f32 v[238:239], v[238:239], v[198:199]
  v_pk_fma_f32 v[254:255], v[198:199], v[198:199], v[254:255]
  v_pk_add_f32 v[236:237], v[236:237], v[238:239]
  v_pk_add_f32 v[240:241], v[240:241], v[254:255]
  v_add_f32 v254, v236, v237
  v_add_f32 v255, v240, v241
  ds_write_b64 v247, v[254:255] offset:2048
  s_waitcnt lgkmcnt(0)
  s_barrier
  ds_read_b128 v[226:229], v248 offset:2048
  ds_read_b128 v[230:233], v248 offset:3072
  s_waitcnt vmcnt(23)
  v_mfma_f32_32x32x16_bf16 v[0:15], a[96:99], a[0:3], 0
  s_waitcnt vmcnt(22)
  v_mfma_f32_32x32x16_bf16 v[0:15], a[100:103], a[4:7], v[0:15]
  s_waitcnt vmcnt(21)
  v_mfma_f32_32x32x16_bf16 v[0:15], a[104:107], a[8:11], v[0:15]
  s_waitcnt lgkmcnt(1)
  v_add_f32 v226, v226, v228
  v_add_f32 v227, v227, v229
  s_waitcnt lgkmcnt(0)
  v_add_f32 v230, v230, v232
  v_add_f32 v231, v231, v233
  v_add_f32 v226, v226, v230
  v_add_f32 v227, v227, v231
  s_waitcnt vmcnt(20)
  v_mfma_f32_32x32x16_bf16 v[0:15], a[108:111], a[12:15], v[0:15]
  v_mul_f32 v226, s59, v226
  v_mul_f32 v228, v226, v226
  v_fma_f32 v227, v227, s59, -v228
  v_max_f32 v227, 0, v227
  v_add_f32 v227, 0x3727c5ac, v227
  v_rsq_f32 v227, v227
  s_waitcnt vmcnt(19)
  v_mfma_f32_32x32x16_bf16 v[0:15], a[112:115], a[16:19], v[0:15]
  v_add_u32 v246, 65280, v246
  v_mul_f32 v228, 0x3eeff558, v227
  v_mul_f32_e64 v229, v226, v228
  v_fma_f32 v32, v32, v228, -v229
  v_fma_f32 v33, v33, v228, -v229
  s_waitcnt vmcnt(18)
  v_mfma_f32_32x32x16_bf16 v[0:15], a[116:119], a[20:23], v[0:15]
  v_fma_f32 v34, v34, v228, -v229
  v_fma_f32 v35, v35, v228, -v229
  v_fma_f32 v36, v36, v228, -v229
  v_fma_f32 v37, v37, v228, -v229
  v_fma_f32 v38, v38, v228, -v229
  v_fma_f32 v39, v39, v228, -v229
  s_waitcnt vmcnt(17)
  v_mfma_f32_32x32x16_bf16 v[0:15], a[120:123], a[24:27], v[0:15]
  v_fma_f32 v64, v64, v228, -v229
  v_fma_f32 v65, v65, v228, -v229
  v_fma_f32 v66, v66, v228, -v229
  v_fma_f32 v67, v67, v228, -v229
  v_fma_f32 v68, v68, v228, -v229
  v_fma_f32 v69, v69, v228, -v229
  s_waitcnt vmcnt(16)
  v_mfma_f32_32x32x16_bf16 v[0:15], a[124:127], a[28:31], v[0:15]
  v_fma_f32 v70, v70, v228, -v229
  v_fma_f32 v71, v71, v228, -v229
  v_cvt_pk_bf16_f32 v32, v32, v33
  v_cvt_pk_bf16_f32 v33, v36, v37
  v_cvt_pk_bf16_f32 v36, v34, v35
  v_cvt_pk_bf16_f32 v37, v38, v39
  s_waitcnt vmcnt(15)
  v_mfma_f32_32x32x16_bf16 v[0:15], a[128:131], a[32:35], v[0:15]
  v_cvt_pk_bf16_f32 v34, v64, v65
  v_cvt_pk_bf16_f32 v35, v68, v69
  v_cvt_pk_bf16_f32 v38, v66, v67
  v_cvt_pk_bf16_f32 v39, v70, v71
  s_waitcnt vmcnt(14)
  v_mfma_f32_32x32x16_bf16 v[0:15], a[132:135], a[36:39], v[0:15]
  ds_write_b128 v246, v[32:35] offset:0
  s_waitcnt vmcnt(13)
  v_mfma_f32_32x32x16_bf16 v[0:15], a[136:139], a[40:43], v[0:15]
  ds_write_b128 v246, v[36:39] offset:512
  s_waitcnt vmcnt(12)
  v_mfma_f32_32x32x16_bf16 v[0:15], a[140:143], a[44:47], v[0:15]
  v_fma_f32 v96, v96, v228, -v229
  v_fma_f32 v97, v97, v228, -v229
  s_nop 9
  v_pk_fma_f32 v[48:49], v[0:1], v[0:1], s[62:63]
  v_pk_fma_f32 v[50:51], v[2:3], v[2:3], s[62:63]
  v_pk_fma_f32 v[52:53], v[4:5], v[4:5], s[62:63]
  v_pk_fma_f32 v[54:55], v[6:7], v[6:7], s[62:63]
  v_pk_fma_f32 v[56:57], v[8:9], v[8:9], s[62:63]
  v_pk_fma_f32 v[58:59], v[10:11], v[10:11], s[62:63]
  v_pk_fma_f32 v[60:61], v[12:13], v[12:13], s[62:63]
  v_pk_fma_f32 v[62:63], v[14:15], v[14:15], s[62:63]
  v_pk_mul_f32 v[48:49], v[0:1], v[48:49] neg_lo:[1,0] neg_hi:[1,0]
  v_pk_mul_f32 v[50:51], v[2:3], v[50:51] neg_lo:[1,0] neg_hi:[1,0]
  v_pk_mul_f32 v[52:53], v[4:5], v[52:53] neg_lo:[1,0] neg_hi:[1,0]
  v_pk_mul_f32 v[54:55], v[6:7], v[54:55] neg_lo:[1,0] neg_hi:[1,0]
  v_pk_mul_f32 v[56:57], v[8:9], v[56:57] neg_lo:[1,0] neg_hi:[1,0]
  v_pk_mul_f32 v[58:59], v[10:11], v[58:59] neg_lo:[1,0] neg_hi:[1,0]
  v_pk_mul_f32 v[60:61], v[12:13], v[60:61] neg_lo:[1,0] neg_hi:[1,0]
  v_pk_mul_f32 v[62:63], v[14:15], v[62:63] neg_lo:[1,0] neg_hi:[1,0]
  s_waitcnt vmcnt(11)
  v_mfma_f32_32x32x16_bf16 v[16:31], a[48:51], a[0:3], 0
  v_fma_f32 v98, v98, v228, -v229
  v_fma_f32 v99, v99, v228, -v229
  v_fma_f32 v100, v100, v228, -v229
  v_fma_f32 v101, v101, v228, -v229
  v_fma_f32 v102, v102, v228, -v229
  v_fma_f32 v103, v103, v228, -v229
  s_waitcnt vmcnt(10)
  v_mfma_f32_32x32x16_bf16 v[16:31], a[52:55], a[4:7], v[16:31]
  ds_read_b128 a[0:3], v249 offset:13056
  v_exp_f32 v48, v48
  v_exp_f32 v49, v49
  s_waitcnt vmcnt(9)
  v_mfma_f32_32x32x16_bf16 v[16:31], a[56:59], a[8:11], v[16:31]
  ds_read_b128 a[4:7], v249 offset:14080
  v_fma_f32 v128, v128, v228, -v229
  v_fma_f32 v129, v129, v228, -v229
  v_fma_f32 v130, v130, v228, -v229
  v_fma_f32 v131, v131, v228, -v229
  s_waitcnt vmcnt(8)
  v_mfma_f32_32x32x16_bf16 v[16:31], a[60:63], a[12:15], v[16:31]
  ds_read_b128 a[8:11], v249 offset:15104
  v_exp_f32 v50, v50
  v_exp_f32 v51, v51
  s_waitcnt vmcnt(7)
  v_mfma_f32_32x32x16_bf16 v[16:31], a[64:67], a[16:19], v[16:31]
  ds_read_b128 a[12:15], v249 offset:16128
  v_fma_f32 v132, v132, v228, -v229
  v_fma_f32 v133, v133, v228, -v229
  v_fma_f32 v134, v134, v228, -v229
  v_fma_f32 v135, v135, v228, -v229
  v_cvt_pk_bf16_f32 v96, v96, v97
  s_waitcnt vmcnt(6)
  v_mfma_f32_32x32x16_bf16 v[16:31], a[68:71], a[20:23], v[16:31]
  ds_read_b128 a[16:19], v249 offset:17152
  v_exp_f32 v52, v52
  v_exp_f32 v53, v53
  s_waitcnt vmcnt(5)
  v_mfma_f32_32x32x16_bf16 v[16:31], a[72:75], a[24:27], v[16:31]
  ds_read_b128 a[20:23], v249 offset:18176
  v_cvt_pk_bf16_f32 v97, v100, v101
  v_cvt_pk_bf16_f32 v100, v98, v99
  v_cvt_pk_bf16_f32 v101, v102, v103
  v_cvt_pk_bf16_f32 v98, v128, v129
  v_cvt_pk_bf16_f32 v99, v132, v133
  s_waitcnt vmcnt(4)
  v_mfma_f32_32x32x16_bf16 v[16:31], a[76:79], a[28:31], v[16:31]
  ds_read_b128 a[24:27], v249 offset:19200
  v_exp_f32 v54, v54
  v_exp_f32 v55, v55
  s_waitcnt vmcnt(3)
  v_mfma_f32_32x32x16_bf16 v[16:31], a[80:83], a[32:35], v[16:31]
  ds_read_b128 a[28:31], v249 offset:20224
  v_cvt_pk_bf16_f32 v102, v130, v131
  v_cvt_pk_bf16_f32 v103, v134, v135
  v_exp_f32 v56, v56
  s_waitcnt vmcnt(2)
  v_mfma_f32_32x32x16_bf16 v[16:31], a[84:87], a[36:39], v[16:31]
  ds_read_b128 a[32:35], v249 offset:21248
  v_exp_f32 v57, v57
  v_exp_f32 v58, v58
  s_waitcnt vmcnt(1)
  v_mfma_f32_32x32x16_bf16 v[16:31], a[88:91], a[40:43], v[16:31]
  ds_read_b128 a[36:39], v249 offset:22272
  ds_write_b128 v246, v[96:99] offset:1024
  s_waitcnt vmcnt(0)
  v_mfma_f32_32x32x16_bf16 v[16:31], a[92:95], a[44:47], v[16:31]
  ds_read_b128 a[40:43], v249 offset:23296
  ds_read_b128 a[44:47], v249 offset:24320
  ds_write_b128 v246, v[100:103] offset:1536
  v_fma_f32 v160, v160, v228, -v229
  v_fma_f32 v161, v161, v228, -v229
  v_fma_f32 v162, v162, v228, -v229
  v_fma_f32 v163, v163, v228, -v229
  v_fma_f32 v164, v164, v228, -v229
  v_fma_f32 v165, v165, v228, -v229
  v_fma_f32 v166, v166, v228, -v229
  v_fma_f32 v167, v167, v228, -v229
  v_fma_f32 v192, v192, v228, -v229
  v_fma_f32 v193, v193, v228, -v229
  v_fma_f32 v194, v194, v228, -v229
  v_fma_f32 v195, v195, v228, -v229
  v_fma_f32 v196, v196, v228, -v229
  v_fma_f32 v197, v197, v228, -v229
  v_fma_f32 v198, v198, v228, -v229
  v_fma_f32 v199, v199, v228, -v229
  v_cvt_pk_bf16_f32 v160, v160, v161
  v_cvt_pk_bf16_f32 v161, v164, v165
  v_cvt_pk_bf16_f32 v164, v162, v163
  v_cvt_pk_bf16_f32 v165, v166, v167
  v_cvt_pk_bf16_f32 v162, v192, v193
  v_cvt_pk_bf16_f32 v163, v196, v197
  v_cvt_pk_bf16_f32 v166, v194, v195
  v_cvt_pk_bf16_f32 v167, v198, v199
  ds_write_b128 v246, v[160:163] offset:2048
  ds_write_b128 v246, v[164:167] offset:2560
  v_exp_f32 v59, v59
  v_exp_f32 v60, v60
  v_exp_f32 v61, v61
  v_exp_f32 v62, v62
  v_exp_f32 v63, v63
  s_waitcnt lgkmcnt(0)
  v_pk_fma_f32 v[48:49], v[48:49], s[60:61], s[60:61] clamp
  v_pk_fma_f32 v[50:51], v[50:51], s[60:61], s[60:61] clamp
  v_pk_fma_f32 v[52:53], v[52:53], s[60:61], s[60:61] clamp
  v_pk_fma_f32 v[54:55], v[54:55], s[60:61], s[60:61] clamp
  v_pk_fma_f32 v[56:57], v[56:57], s[60:61], s[60:61] clamp
  v_pk_fma_f32 v[58:59], v[58:59], s[60:61], s[60:61] clamp
  v_pk_fma_f32 v[60:61], v[60:61], s[60:61], s[60:61] clamp
  v_pk_fma_f32 v[62:63], v[62:63], s[60:61], s[60:61] clamp
  v_pk_fma_f32 v[64:65], v[16:17], v[16:17], s[62:63]
  v_pk_fma_f32 v[66:67], v[18:19], v[18:19], s[62:63]
  v_pk_fma_f32 v[68:69], v[20:21], v[20:21], s[62:63]
  v_pk_fma_f32 v[70:71], v[22:23], v[22:23], s[62:63]
  v_pk_fma_f32 v[72:73], v[24:25], v[24:25], s[62:63]
  v_pk_fma_f32 v[74:75], v[26:27], v[26:27], s[62:63]
  v_pk_fma_f32 v[76:77], v[28:29], v[28:29], s[62:63]
  v_pk_fma_f32 v[78:79], v[30:31], v[30:31], s[62:63]
  v_pk_mul_f32 v[64:65], v[16:17], v[64:65] neg_lo:[1,0] neg_hi:[1,0]
  v_pk_mul_f32 v[66:67], v[18:19], v[66:67] neg_lo:[1,0] neg_hi:[1,0]
  v_pk_mul_f32 v[68:69], v[20:21], v[68:69] neg_lo:[1,0] neg_hi:[1,0]
  v_pk_mul_f32 v[70:71], v[22:23], v[70:71] neg_lo:[1,0] neg_hi:[1,0]
  v_pk_mul_f32 v[72:73], v[24:25], v[72:73] neg_lo:[1,0] neg_hi:[1,0]
  v_pk_mul_f32 v[74:75], v[26:27], v[74:75] neg_lo:[1,0] neg_hi:[1,0]
  v_pk_mul_f32 v[76:77], v[28:29], v[76:77] neg_lo:[1,0] neg_hi:[1,0]
  v_pk_mul_f32 v[78:79], v[30:31], v[78:79] neg_lo:[1,0] neg_hi:[1,0]
  v_pk_mul_f32 v[0:1], v[0:1], v[56:57]
  v_pk_mul_f32 v[2:3], v[2:3], v[58:59]
  v_pk_mul_f32 v[4:5], v[4:5], v[60:61]
  v_pk_mul_f32 v[6:7], v[6:7], v[62:63]
  v_pk_mul_f32 v[8:9], v[8:9], v[48:49]
  v_pk_mul_f32 v[10:11], v[10:11], v[50:51]
  v_pk_mul_f32 v[12:13], v[12:13], v[52:53]
  v_pk_mul_f32 v[14:15], v[14:15], v[54:55]
  v_pk_mul_f32 v[48:49], v[48:49], v[56:57]
  v_pk_mul_f32 v[50:51], v[50:51], v[58:59]
  v_pk_mul_f32 v[52:53], v[52:53], v[60:61]
  v_pk_mul_f32 v[54:55], v[54:55], v[62:63]
  v_mfma_f32_32x32x16_bf16 v[32:47], a[96:99], a[0:3], 0
  s_barrier
  v_exp_f32 v64, v64
  v_exp_f32 v65, v65
  v_fma_f32 v64, v64, s60, s60 clamp
  v_mfma_f32_32x32x16_bf16 v[32:47], a[100:103], a[4:7], v[32:47]
  v_exp_f32 v66, v66
  v_exp_f32 v67, v67
  v_fma_f32 v65, v65, s60, s60 clamp
  v_fma_f32 v66, v66, s60, s60 clamp
  v_mfma_f32_32x32x16_bf16 v[32:47], a[104:107], a[8:11], v[32:47]
  v_exp_f32 v68, v68
  v_exp_f32 v69, v69
  v_fma_f32 v67, v67, s60, s60 clamp
  v_fma_f32 v68, v68, s60, s60 clamp
  v_mfma_f32_32x32x16_bf16 v[32:47], a[108:111], a[12:15], v[32:47]
  v_exp_f32 v70, v70
  v_exp_f32 v71, v71
  v_fma_f32 v69, v69, s60, s60 clamp
  v_fma_f32 v70, v70, s60, s60 clamp
  v_mfma_f32_32x32x16_bf16 v[32:47], a[112:115], a[16:19], v[32:47]
  buffer_load_dword v253, off, s[32:35], 0 offset:128 sc1
  v_exp_f32 v72, v72
  v_exp_f32 v73, v73
  v_mfma_f32_32x32x16_bf16 v[32:47], a[116:119], a[20:23], v[32:47]
  v_exp_f32 v74, v74
  v_exp_f32 v75, v75
  v_fma_f32 v71, v71, s60, s60 clamp
  v_fma_f32 v72, v72, s60, s60 clamp
  v_mfma_f32_32x32x16_bf16 v[32:47], a[120:123], a[24:27], v[32:47]
  v_exp_f32 v76, v76
  v_exp_f32 v77, v77
  v_fma_f32 v73, v73, s60, s60 clamp
  v_fma_f32 v74, v74, s60, s60 clamp
  v_mfma_f32_32x32x16_bf16 v[32:47], a[124:127], a[28:31], v[32:47]
  v_exp_f32 v78, v78
  v_exp_f32 v79, v79
  v_fma_f32 v75, v75, s60, s60 clamp
  v_fma_f32 v76, v76, s60, s60 clamp
  v_mfma_f32_32x32x16_bf16 v[32:47], a[128:131], a[32:35], v[32:47]
  v_rcp_f32 v48, v48
  v_rcp_f32 v49, v49
  v_fma_f32 v77, v77, s60, s60 clamp
  v_fma_f32 v78, v78, s60, s60 clamp
  v_mfma_f32_32x32x16_bf16 v[32:47], a[132:135], a[36:39], v[32:47]
  v_rcp_f32 v50, v50
  v_rcp_f32 v51, v51
  v_fma_f32 v79, v79, s60, s60 clamp
  v_mfma_f32_32x32x16_bf16 v[32:47], a[136:139], a[40:43], v[32:47]
  v_rcp_f32 v52, v52
  v_rcp_f32 v53, v53
  v_mfma_f32_32x32x16_bf16 v[32:47], a[140:143], a[44:47], v[32:47]
  v_rcp_f32 v54, v54
  v_rcp_f32_e64 v55, v55
  v_pk_mul_f32 v[0:1], v[0:1], v[48:49]
  v_pk_mul_f32 v[2:3], v[2:3], v[50:51]
  v_pk_mul_f32 v[4:5], v[4:5], v[52:53]
  v_pk_mul_f32 v[6:7], v[6:7], v[54:55]
  v_pk_mul_f32 v[8:9], v[8:9], v[48:49]
  v_pk_mul_f32 v[10:11], v[10:11], v[50:51]
  v_pk_mul_f32 v[12:13], v[12:13], v[52:53]
  v_pk_mul_f32 v[14:15], v[14:15], v[54:55]
  v_pk_mul_f32 v[80:81], v[0:1], v[0:1]
  v_pk_mul_f32 v[82:83], v[2:3], v[2:3]
  v_pk_mul_f32 v[84:85], v[4:5], v[4:5]
  v_pk_mul_f32 v[86:87], v[6:7], v[6:7]
  v_pk_mul_f32 v[88:89], v[8:9], v[8:9]
  v_pk_mul_f32 v[90:91], v[10:11], v[10:11]
  v_pk_mul_f32 v[92:93], v[12:13], v[12:13]
  v_pk_mul_f32 v[94:95], v[14:15], v[14:15]
  v_pk_fma_f32 v[48:49], v[32:33], v[32:33], s[62:63]
  v_pk_fma_f32 v[50:51], v[34:35], v[34:35], s[62:63]
  v_pk_fma_f32 v[52:53], v[36:37], v[36:37], s[62:63]
  v_pk_fma_f32 v[54:55], v[38:39], v[38:39], s[62:63]
  v_pk_fma_f32 v[56:57], v[40:41], v[40:41], s[62:63]
  v_pk_fma_f32 v[58:59], v[42:43], v[42:43], s[62:63]
  v_pk_fma_f32 v[60:61], v[44:45], v[44:45], s[62:63]
  v_pk_fma_f32 v[62:63], v[46:47], v[46:47], s[62:63]
  v_pk_mul_f32 v[48:49], v[32:33], v[48:49] neg_lo:[1,0] neg_hi:[1,0]
  v_pk_mul_f32 v[50:51], v[34:35], v[50:51] neg_lo:[1,0] neg_hi:[1,0]
  v_pk_mul_f32 v[52:53], v[36:37], v[52:53] neg_lo:[1,0] neg_hi:[1,0]
  v_pk_mul_f32 v[54:55], v[38:39], v[54:55] neg_lo:[1,0] neg_hi:[1,0]
  v_pk_mul_f32 v[56:57], v[40:41], v[56:57] neg_lo:[1,0] neg_hi:[1,0]
  v_pk_mul_f32 v[58:59], v[42:43], v[58:59] neg_lo:[1,0] neg_hi:[1,0]
  v_pk_mul_f32 v[60:61], v[44:45], v[60:61] neg_lo:[1,0] neg_hi:[1,0]
  v_pk_mul_f32 v[62:63], v[46:47], v[62:63] neg_lo:[1,0] neg_hi:[1,0]
  v_pk_mul_f32 v[16:17], v[16:17], v[72:73]
  v_pk_mul_f32 v[18:19], v[18:19], v[74:75]
  v_pk_mul_f32 v[20:21], v[20:21], v[76:77]
  v_pk_mul_f32 v[22:23], v[22:23], v[78:79]
  v_pk_mul_f32 v[24:25], v[24:25], v[64:65]
  v_pk_mul_f32 v[26:27], v[26:27], v[66:67]
  v_pk_mul_f32 v[28:29], v[28:29], v[68:69]
  v_pk_mul_f32 v[30:31], v[30:31], v[70:71]
  v_pk_mul_f32 v[64:65], v[64:65], v[72:73]
  v_pk_mul_f32 v[66:67], v[66:67], v[74:75]
  v_pk_mul_f32 v[68:69], v[68:69], v[76:77]
  v_pk_mul_f32 v[70:71], v[70:71], v[78:79]
  v_mfma_f32_32x32x16_bf16 v[232:247], a[48:51], a[0:3], 0
  v_exp_f32 v48, v48
  v_exp_f32 v49, v49
  v_cvt_pk_bf16_f32 v112, v0, v1
  v_cvt_pk_bf16_f32 v113, v2, v3
  v_mfma_f32_32x32x16_bf16 v[232:247], a[52:55], a[4:7], v[232:247]
  ds_read_b128 a[0:3], v249 offset:26112
  v_exp_f32 v50, v50
  v_exp_f32 v51, v51
  v_cvt_pk_bf16_f32 v114, v4, v5
  v_mfma_f32_32x32x16_bf16 v[232:247], a[56:59], a[8:11], v[232:247]
  ds_read_b128 a[4:7], v249 offset:27136
  v_exp_f32 v52, v52
  v_exp_f32 v53, v53
  v_cvt_pk_bf16_f32 v115, v6, v7
  v_mfma_f32_32x32x16_bf16 v[232:247], a[60:63], a[12:15], v[232:247]
  ds_read_b128 a[8:11], v249 offset:28160
  v_exp_f32 v54, v54
  v_exp_f32 v55, v55
  v_cvt_pk_bf16_f32 v116, v8, v9
  v_mfma_f32_32x32x16_bf16 v[232:247], a[64:67], a[16:19], v[232:247]
  ds_read_b128 a[12:15], v249 offset:29184
  v_exp_f32 v56, v56
  v_exp_f32 v57, v57
  v_cvt_pk_bf16_f32 v117, v10, v11
  v_mfma_f32_32x32x16_bf16 v[232:247], a[68:71], a[20:23], v[232:247]
  ds_read_b128 a[16:19], v249 offset:30208
  ds_write_b128 v252, v[112:115] offset:14336
  v_mfma_f32_32x32x16_bf16 v[232:247], a[72:75], a[24:27], v[232:247]
  ds_read_b128 a[20:23], v249 offset:31232
  v_exp_f32 v58, v58
  v_exp_f32 v59, v59
  v_cvt_pk_bf16_f32 v118, v12, v13
  v_mfma_f32_32x32x16_bf16 v[232:247], a[76:79], a[28:31], v[232:247]
  ds_read_b128 a[24:27], v249 offset:32256
  v_exp_f32 v60, v60
  v_exp_f32 v61, v61
  v_cvt_pk_bf16_f32 v119, v14, v15
  v_mfma_f32_32x32x16_bf16 v[232:247], a[80:83], a[32:35], v[232:247]
  ds_read_b128 a[28:31], v249 offset:33280
  v_exp_f32 v62, v62
  v_exp_f32 v63, v63
  v_fma_f32 v48, v48, s60, s60 clamp
  v_mfma_f32_32x32x16_bf16 v[232:247], a[84:87], a[36:39], v[232:247]
  ds_read_b128 a[32:35], v249 offset:34304
  v_rcp_f32 v64, v64
  v_rcp_f32 v65, v65
  v_fma_f32 v49, v49, s60, s60 clamp
  v_mfma_f32_32x32x16_bf16 v[232:247], a[88:91], a[40:43], v[232:247]
  ds_read_b128 a[36:39], v249 offset:35328
  v_rcp_f32 v66, v66
  v_rcp_f32 v67, v67
  v_fma_f32 v50, v50, s60, s60 clamp
  v_mfma_f32_32x32x16_bf16 v[232:247], a[92:95], a[44:47], v[232:247]
  ds_read_b128 a[40:43], v249 offset:36352
  ds_read_b128 a[44:47], v249 offset:37376
  ds_write_b128 v252, v[116:119] offset:15360
  v_rcp_f32 v68, v68
  v_rcp_f32 v69, v69
  v_rcp_f32 v70, v70
  v_rcp_f32_e64 v71, v71
  v_fma_f32 v51, v51, s60, s60 clamp
  s_waitcnt vmcnt(0)
  v_readfirstlane_b32 s4, v253
  s_cmp_lt_u32 s4, 0x818
  s_cbranch_scc1 L_slow9
L_back9:
  v_pk_fma_f32 v[52:53], v[52:53], s[60:61], s[60:61] clamp
  v_pk_fma_f32 v[54:55], v[54:55], s[60:61], s[60:61] clamp
  v_pk_fma_f32 v[56:57], v[56:57], s[60:61], s[60:61] clamp
  v_pk_fma_f32 v[58:59], v[58:59], s[60:61], s[60:61] clamp
  v_pk_fma_f32 v[60:61], v[60:61], s[60:61], s[60:61] clamp
  v_pk_fma_f32 v[62:63], v[62:63], s[60:61], s[60:61] clamp
  v_pk_mul_f32 v[16:17], v[16:17], v[64:65]
  v_pk_mul_f32 v[18:19], v[18:19], v[66:67]
  v_pk_mul_f32 v[20:21], v[20:21], v[68:69]
  v_pk_mul_f32 v[22:23], v[22:23], v[70:71]
  v_pk_mul_f32 v[24:25], v[24:25], v[64:65]
  v_pk_mul_f32 v[26:27], v[26:27], v[66:67]
  v_pk_mul_f32 v[28:29], v[28:29], v[68:69]
  v_pk_mul_f32 v[30:31], v[30:31], v[70:71]
  v_pk_mul_f32 v[96:97], v[16:17], v[16:17]
  v_pk_mul_f32 v[98:99], v[18:19], v[18:19]
  v_pk_mul_f32 v[100:101], v[20:21], v[20:21]
  v_pk_mul_f32 v[102:103], v[22:23], v[22:23]
  v_pk_mul_f32 v[104:105], v[24:25], v[24:25]
  v_pk_mul_f32 v[106:107], v[26:27], v[26:27]
  v_pk_mul_f32 v[108:109], v[28:29], v[28:29]
  v_pk_mul_f32 v[110:111], v[30:31], v[30:31]
  v_pk_fma_f32 v[64:65], v[232:233], v[232:233], s[62:63]
  v_pk_fma_f32 v[66:67], v[234:235], v[234:235], s[62:63]
  v_pk_fma_f32 v[68:69], v[236:237], v[236:237], s[62:63]
  v_pk_fma_f32 v[70:71], v[238:239], v[238:239], s[62:63]
  v_pk_fma_f32 v[72:73], v[240:241], v[240:241], s[62:63]
  v_pk_fma_f32 v[74:75], v[242:243], v[242:243], s[62:63]
  v_pk_fma_f32 v[76:77], v[244:245], v[244:245], s[62:63]
  v_pk_fma_f32 v[78:79], v[246:247], v[246:247], s[62:63]
  v_pk_mul_f32 v[64:65], v[232:233], v[64:65] neg_lo:[1,0] neg_hi:[1,0]
  v_pk_mul_f32 v[66:67], v[234:235], v[66:67] neg_lo:[1,0] neg_hi:[1,0]
  v_pk_mul_f32 v[68:69], v[236:237], v[68:69] neg_lo:[1,0] neg_hi:[1,0]
  v_pk_mul_f32 v[70:71], v[238:239], v[70:71] neg_lo:[1,0] neg_hi:[1,0]
  v_pk_mul_f32 v[72:73], v[240:241], v[72:73] neg_lo:[1,0] neg_hi:[1,0]
  v_pk_mul_f32 v[74:75], v[242:243], v[74:75] neg_lo:[1,0] neg_hi:[1,0]
  v_pk_mul_f32 v[76:77], v[244:245], v[76:77] neg_lo:[1,0] neg_hi:[1,0]
  v_pk_mul_f32 v[78:79], v[246:247], v[78:79] neg_lo:[1,0] neg_hi:[1,0]
  v_pk_mul_f32 v[32:33], v[32:33], v[56:57]
  v_pk_mul_f32 v[34:35], v[34:35], v[58:59]
  v_pk_mul_f32 v[36:37], v[36:37], v[60:61]
  v_pk_mul_f32 v[38:39], v[38:39], v[62:63]
  v_pk_mul_f32 v[40:41], v[40:41], v[48:49]
  v_pk_mul_f32 v[42:43], v[42:43], v[50:51]
  v_pk_mul_f32 v[44:45], v[44:45], v[52:53]
  v_pk_mul_f32 v[46:47], v[46:47], v[54:55]
  v_pk_mul_f32 v[48:49], v[48:49], v[56:57]
  v_pk_mul_f32 v[50:51], v[50:51], v[58:59]
  v_pk_mul_f32 v[52:53], v[52:53], v[60:61]
  v_pk_mul_f32 v[54:55], v[54:55], v[62:63]
  s_waitcnt lgkmcnt(1)
  v_mfma_f32_32x32x16_bf16 v[0:15], a[96:99], a[0:3], 0
  v_exp_f32 v64, v64
  v_exp_f32 v65, v65
  v_cvt_pk_bf16_f32 v112, v16, v17
  v_cvt_pk_bf16_f32 v113, v18, v19
  v_mfma_f32_32x32x16_bf16 v[0:15], a[100:103], a[4:7], v[0:15]
  v_exp_f32 v66, v66
  v_exp_f32 v67, v67
  v_cvt_pk_bf16_f32 v114, v20, v21
  v_cvt_pk_bf16_f32 v115, v22, v23
  v_mfma_f32_32x32x16_bf16 v[0:15], a[104:107], a[8:11], v[0:15]
  buffer_load_dwordx4 v[120:123], v248, s[20:23], s36 offen offset:0 sc1
  v_exp_f32 v68, v68
  v_exp_f32 v69, v69
  v_cvt_pk_bf16_f32 v116, v24, v25
  v_mfma_f32_32x32x16_bf16 v[0:15], a[108:111], a[12:15], v[0:15]
  buffer_load_dwordx4 v[124:127], v248, s[20:23], s36 offen offset:1024 sc1
  v_exp_f32 v70, v70
  v_exp_f32 v71, v71
  v_cvt_pk_bf16_f32 v117, v26, v27
  v_mfma_f32_32x32x16_bf16 v[0:15], a[112:115], a[16:19], v[0:15]
  v_exp_f32 v72, v72
  v_exp_f32 v73, v73
  v_cvt_pk_bf16_f32 v118, v28, v29
  v_cvt_pk_bf16_f32 v119, v30, v31
  v_mfma_f32_32x32x16_bf16 v[0:15], a[116:119], a[20:23], v[0:15]
  ds_write_b128 v252, v[112:115] offset:0
  v_fma_f32 v64, v64, s60, s60 clamp
  v_mfma_f32_32x32x16_bf16 v[0:15], a[120:123], a[24:27], v[0:15]
  v_exp_f32 v74, v74
  v_exp_f32 v75, v75
  v_exp_f32 v76, v76
  v_mfma_f32_32x32x16_bf16 v[0:15], a[124:127], a[28:31], v[0:15]
  buffer_load_dwordx4 v[128:131], v248, s[20:23], s36 offen offset:2048 sc1
  v_exp_f32 v77, v77
  v_exp_f32 v78, v78
  v_fma_f32 v65, v65, s60, s60 clamp
  v_mfma_f32_32x32x16_bf16 v[0:15], a[128:131], a[32:35], v[0:15]
  buffer_load_dwordx4 v[132:135], v248, s[20:23], s36 offen offset:3072 sc1
  v_exp_f32 v79, v79
  v_rcp_f32 v48, v48
  v_fma_f32 v66, v66, s60, s60 clamp
  v_mfma_f32_32x32x16_bf16 v[0:15], a[132:135], a[36:39], v[0:15]
  v_rcp_f32 v49, v49
  v_rcp_f32 v50, v50
  v_rcp_f32 v51, v51
  v_mfma_f32_32x32x16_bf16 v[0:15], a[136:139], a[40:43], v[0:15]
  buffer_load_dwordx4 v[136:139], v248, s[20:23], s37 offen offset:0 sc1
  v_rcp_f32 v52, v52
  v_rcp_f32 v53, v53
  v_fma_f32 v67, v67, s60, s60 clamp
  v_mfma_f32_32x32x16_bf16 v[0:15], a[140:143], a[44:47], v[0:15]
  ds_write_b128 v252, v[116:119] offset:1024
  v_rcp_f32 v54, v54
  v_rcp_f32_e64 v55, v55
  v_pk_fma_f32 v[68:69], v[68:69], s[60:61], s[60:61] clamp
  v_pk_fma_f32 v[70:71], v[70:71], s[60:61], s[60:61] clamp
  v_pk_fma_f32 v[72:73], v[72:73], s[60:61], s[60:61] clamp
  v_pk_fma_f32 v[74:75], v[74:75], s[60:61], s[60:61] clamp
  v_pk_fma_f32 v[76:77], v[76:77], s[60:61], s[60:61] clamp
  v_pk_fma_f32 v[78:79], v[78:79], s[60:61], s[60:61] clamp
  v_pk_mul_f32 v[32:33], v[32:33], v[48:49]
  v_pk_mul_f32 v[34:35], v[34:35], v[50:51]
  v_pk_mul_f32 v[36:37], v[36:37], v[52:53]
  v_pk_mul_f32 v[38:39], v[38:39], v[54:55]
  v_pk_mul_f32 v[40:41], v[40:41], v[48:49]
  v_pk_mul_f32 v[42:43], v[42:43], v[50:51]
  v_pk_mul_f32 v[44:45], v[44:45], v[52:53]
  v_pk_mul_f32 v[46:47], v[46:47], v[54:55]
  v_pk_fma_f32 v[80:81], v[32:33], v[32:33], v[80:81]
  v_pk_fma_f32 v[82:83], v[34:35], v[34:35], v[82:83]
  v_pk_fma_f32 v[84:85], v[36:37], v[36:37], v[84:85]
  v_pk_fma_f32 v[86:87], v[38:39], v[38:39], v[86:87]
  v_pk_fma_f32 v[88:89], v[40:41], v[40:41], v[88:89]
  v_pk_fma_f32 v[90:91], v[42:43], v[42:43], v[90:91]
  v_pk_fma_f32 v[92:93], v[44:45], v[44:45], v[92:93]
  v_pk_fma_f32 v[94:95], v[46:47], v[46:47], v[94:95]
  v_pk_fma_f32 v[48:49], v[0:1], v[0:1], s[62:63]
  v_pk_fma_f32 v[50:51], v[2:3], v[2:3], s[62:63]
  v_pk_fma_f32 v[52:53], v[4:5], v[4:5], s[62:63]
  v_pk_fma_f32 v[54:55], v[6:7], v[6:7], s[62:63]
  v_pk_fma_f32 v[56:57], v[8:9], v[8:9], s[62:63]
  v_pk_fma_f32 v[58:59], v[10:11], v[10:11], s[62:63]
  v_pk_fma_f32 v[60:61], v[12:13], v[12:13], s[62:63]
  v_pk_fma_f32 v[62:63], v[14:15], v[14:15], s[62:63]
  v_pk_mul_f32 v[48:49], v[0:1], v[48:49] neg_lo:[1,0] neg_hi:[1,0]
  v_pk_mul_f32 v[50:51], v[2:3], v[50:51] neg_lo:[1,0] neg_hi:[1,0]
  v_pk_mul_f32 v[52:53], v[4:5], v[52:53] neg_lo:[1,0] neg_hi:[1,0]
  v_pk_mul_f32 v[54:55], v[6:7], v[54:55] neg_lo:[1,0] neg_hi:[1,0]
  v_pk_mul_f32 v[56:57], v[8:9], v[56:57] neg_lo:[1,0] neg_hi:[1,0]
  v_pk_mul_f32 v[58:59], v[10:11], v[58:59] neg_lo:[1,0] neg_hi:[1,0]
  v_pk_mul_f32 v[60:61], v[12:13], v[60:61] neg_lo:[1,0] neg_hi:[1,0]
  v_pk_mul_f32 v[62:63], v[14:15], v[62:63] neg_lo:[1,0] neg_hi:[1,0]
  v_pk_mul_f32 v[232:233], v[232:233], v[72:73]
  v_pk_mul_f32 v[234:235], v[234:235], v[74:75]
  v_pk_mul_f32 v[236:237], v[236:237], v[76:77]
  v_pk_mul_f32 v[238:239], v[238:239], v[78:79]
  v_pk_mul_f32 v[240:241], v[240:241], v[64:65]
  v_pk_mul_f32 v[242:243], v[242:243], v[66:67]
  v_pk_mul_f32 v[244:245], v[244:245], v[68:69]
  v_pk_mul_f32 v[246:247], v[246:247], v[70:71]
  v_pk_mul_f32 v[64:65], v[64:65], v[72:73]
  v_pk_mul_f32 v[66:67], v[66:67], v[74:75]
  v_pk_mul_f32 v[68:69], v[68:69], v[76:77]
  v_pk_mul_f32 v[70:71], v[70:71], v[78:79]
  v_mfma_f32_32x32x16_bf16 v[16:31], a[48:51], a[0:3], 0
  v_exp_f32 v48, v48
  v_exp_f32 v49, v49
  v_cvt_pk_bf16_f32 v112, v32, v33
  v_cvt_pk_bf16_f32 v113, v34, v35
  v_mfma_f32_32x32x16_bf16 v[16:31], a[52:55], a[4:7], v[16:31]
  ds_read_b128 a[0:3], v249 offset:39168
  v_exp_f32 v50, v50
  v_exp_f32 v51, v51
  v_cvt_pk_bf16_f32 v114, v36, v37
  v_mfma_f32_32x32x16_bf16 v[16:31], a[56:59], a[8:11], v[16:31]
  ds_read_b128 a[4:7], v249 offset:40192
  v_exp_f32 v52, v52
  v_exp_f32 v53, v53
  v_cvt_pk_bf16_f32 v115, v38, v39
  v_mfma_f32_32x32x16_bf16 v[16:31], a[60:63], a[12:15], v[16:31]
  ds_read_b128 a[8:11], v249 offset:41216
  v_exp_f32 v54, v54
  v_exp_f32 v55, v55
  v_accvgpr_write_b32 a144, v112
  v_mfma_f32_32x32x16_bf16 v[16:31], a[64:67], a[16:19], v[16:31]
  ds_read_b128 a[12:15], v249 offset:42240
  v_exp_f32 v56, v56
  v_exp_f32 v57, v57
  v_accvgpr_write_b32 a145, v113
  v_mfma_f32_32x32x16_bf16 v[16:31], a[68:71], a[20:23], v[16:31]
  ds_read_b128 a[16:19], v249 offset:43264
  v_exp_f32 v58, v58
  v_exp_f32 v59, v59
  v_accvgpr_write_b32 a146, v114
  v_mfma_f32_32x32x16_bf16 v[16:31], a[72:75], a[24:27], v[16:31]
  ds_read_b128 a[20:23], v249 offset:44288
  v_exp_f32 v60, v60
  v_exp_f32 v61, v61
  v_accvgpr_write_b32 a147, v115
  v_mfma_f32_32x32x16_bf16 v[16:31], a[76:79], a[28:31], v[16:31]
  ds_read_b128 a[24:27], v249 offset:45312
  v_exp_f32 v62, v62
  v_exp_f32 v63, v63
  v_cvt_pk_bf16_f32 v116, v40, v41
  v_mfma_f32_32x32x16_bf16 v[16:31], a[80:83], a[32:35], v[16:31]
  ds_read_b128 a[28:31], v249 offset:46336
  v_rcp_f32 v64, v64
  v_rcp_f32 v65, v65
  v_cvt_pk_bf16_f32 v117, v42, v43
  v_mfma_f32_32x32x16_bf16 v[16:31], a[84:87], a[36:39], v[16:31]
  ds_read_b128 a[32:35], v249 offset:47360
  v_rcp_f32 v66, v66
  v_rcp_f32 v67, v67
  v_cvt_pk_bf16_f32 v118, v44, v45
  v_mfma_f32_32x32x16_bf16 v[16:31], a[88:91], a[40:43], v[16:31]
  ds_read_b128 a[36:39], v249 offset:48384
  v_rcp_f32 v68, v68
  v_rcp_f32 v69, v69
  v_cvt_pk_bf16_f32 v119, v46, v47
  v_mfma_f32_32x32x16_bf16 v[16:31], a[92:95], a[44:47], v[16:31]
  ds_read_b128 a[40:43], v249 offset:49408
  ds_read_b128 a[44:47], v249 offset:50432
  v_rcp_f32 v70, v70
  v_rcp_f32 v71, v71
  v_accvgpr_write_b32 a148, v116
  v_accvgpr_write_b32 a149, v117
  v_accvgpr_write_b32 a150, v118
  v_accvgpr_write_b32 a151, v119
  v_pk_fma_f32 v[48:49], v[48:49], s[60:61], s[60:61] clamp
  v_pk_fma_f32 v[50:51], v[50:51], s[60:61], s[60:61] clamp
  v_pk_fma_f32 v[52:53], v[52:53], s[60:61], s[60:61] clamp
  v_pk_fma_f32 v[54:55], v[54:55], s[60:61], s[60:61] clamp
  v_pk_fma_f32 v[56:57], v[56:57], s[60:61], s[60:61] clamp
  v_pk_fma_f32 v[58:59], v[58:59], s[60:61], s[60:61] clamp
  v_pk_fma_f32 v[60:61], v[60:61], s[60:61], s[60:61] clamp
  v_pk_fma_f32 v[62:63], v[62:63], s[60:61], s[60:61] clamp
  v_pk_mul_f32 v[232:233], v[232:233], v[64:65]
  v_pk_mul_f32 v[234:235], v[234:235], v[66:67]
  v_pk_mul_f32 v[236:237], v[236:237], v[68:69]
  v_pk_mul_f32 v[238:239], v[238:239], v[70:71]
  v_pk_mul_f32 v[240:241], v[240:241], v[64:65]
  v_pk_mul_f32 v[242:243], v[242:243], v[66:67]
  v_pk_mul_f32 v[244:245], v[244:245], v[68:69]
  v_pk_mul_f32 v[246:247], v[246:247], v[70:71]
  v_pk_fma_f32 v[96:97], v[232:233], v[232:233], v[96:97]
  v_pk_fma_f32 v[98:99], v[234:235], v[234:235], v[98:99]
  v_pk_fma_f32 v[100:101], v[236:237], v[236:237], v[100:101]
  v_pk_fma_f32 v[102:103], v[238:239], v[238:239], v[102:103]
  v_pk_fma_f32 v[104:105], v[240:241], v[240:241], v[104:105]
  v_pk_fma_f32 v[106:107], v[242:243], v[242:243], v[106:107]
  v_pk_fma_f32 v[108:109], v[244:245], v[244:245], v[108:109]
  v_pk_fma_f32 v[110:111], v[246:247], v[246:247], v[110:111]
  v_pk_fma_f32 v[64:65], v[16:17], v[16:17], s[62:63]
  v_pk_fma_f32 v[66:67], v[18:19], v[18:19], s[62:63]
  v_pk_fma_f32 v[68:69], v[20:21], v[20:21], s[62:63]
  v_pk_fma_f32 v[70:71], v[22:23], v[22:23], s[62:63]
  v_pk_fma_f32 v[72:73], v[24:25], v[24:25], s[62:63]
  v_pk_fma_f32 v[74:75], v[26:27], v[26:27], s[62:63]
  v_pk_fma_f32 v[76:77], v[28:29], v[28:29], s[62:63]
  v_pk_fma_f32 v[78:79], v[30:31], v[30:31], s[62:63]
  v_pk_mul_f32 v[64:65], v[16:17], v[64:65] neg_lo:[1,0] neg_hi:[1,0]
  v_pk_mul_f32 v[66:67], v[18:19], v[66:67] neg_lo:[1,0] neg_hi:[1,0]
  v_pk_mul_f32 v[68:69], v[20:21], v[68:69] neg_lo:[1,0] neg_hi:[1,0]
  v_pk_mul_f32 v[70:71], v[22:23], v[70:71] neg_lo:[1,0] neg_hi:[1,0]
  v_pk_mul_f32 v[72:73], v[24:25], v[72:73] neg_lo:[1,0] neg_hi:[1,0]
  v_pk_mul_f32 v[74:75], v[26:27], v[74:75] neg_lo:[1,0] neg_hi:[1,0]
  v_pk_mul_f32 v[76:77], v[28:29], v[76:77] neg_lo:[1,0] neg_hi:[1,0]
  v_pk_mul_f32 v[78:79], v[30:31], v[78:79] neg_lo:[1,0] neg_hi:[1,0]
  v_pk_mul_f32 v[0:1], v[0:1], v[56:57]
  v_pk_mul_f32 v[2:3], v[2:3], v[58:59]
  v_pk_mul_f32 v[4:5], v[4:5], v[60:61]
  v_pk_mul_f32 v[6:7], v[6:7], v[62:63]
  v_pk_mul_f32 v[8:9], v[8:9], v[48:49]
  v_pk_mul_f32 v[10:11], v[10:11], v[50:51]
  v_pk_mul_f32 v[12:13], v[12:13], v[52:53]
  v_pk_mul_f32 v[14:15], v[14:15], v[54:55]
  v_pk_mul_f32 v[48:49], v[48:49], v[56:57]
  v_pk_mul_f32 v[50:51], v[50:51], v[58:59]
  v_pk_mul_f32 v[52:53], v[52:53], v[60:61]
  v_pk_mul_f32 v[54:55], v[54:55], v[62:63]
  s_waitcnt lgkmcnt(0)
  v_mfma_f32_32x32x16_bf16 v[32:47], a[96:99], a[0:3], 0
  v_exp_f32 v64, v64
  v_exp_f32 v65, v65
  v_cvt_pk_bf16_f32 v112, v232, v233
  v_cvt_pk_bf16_f32 v113, v234, v235
  v_mfma_f32_32x32x16_bf16 v[32:47], a[100:103], a[4:7], v[32:47]
  v_exp_f32 v66, v66
  v_exp_f32 v67, v67
  v_cvt_pk_bf16_f32 v114, v236, v237
  v_cvt_pk_bf16_f32 v115, v238, v239
  v_mfma_f32_32x32x16_bf16 v[32:47], a[104:107], a[8:11], v[32:47]
  buffer_load_dwordx4 v[140:143], v248, s[20:23], s37 offen offset:1024 sc1
  v_exp_f32 v68, v68
  v_exp_f32 v69, v69
  v_cvt_pk_bf16_f32 v116, v240, v241
  v_mfma_f32_32x32x16_bf16 v[32:47], a[108:111], a[12:15], v[32:47]
  buffer_load_dwordx4 v[144:147], v248, s[20:23], s37 offen offset:2048 sc1
  v_exp_f32 v70, v70
  v_exp_f32 v71, v71
  v_cvt_pk_bf16_f32 v117, v242, v243
  v_mfma_f32_32x32x16_bf16 v[32:47], a[112:115], a[16:19], v[32:47]
  buffer_load_dword v253, off, s[32:35], 0 sc1
  v_exp_f32 v72, v72
  v_exp_f32 v73, v73
  v_mfma_f32_32x32x16_bf16 v[32:47], a[116:119], a[20:23], v[32:47]
  ds_write_b128 v252, v[112:115] offset:2048
  v_cvt_pk_bf16_f32 v118, v244, v245
  v_mfma_f32_32x32x16_bf16 v[32:47], a[120:123], a[24:27], v[32:47]
  v_exp_f32 v74, v74
  v_exp_f32 v75, v75
  v_exp_f32 v76, v76
  v_mfma_f32_32x32x16_bf16 v[32:47], a[124:127], a[28:31], v[32:47]
  buffer_load_dwordx4 v[148:151], v248, s[20:23], s37 offen offset:3072 sc1
  v_exp_f32 v77, v77
  v_exp_f32 v78, v78
  v_cvt_pk_bf16_f32 v119, v246, v247
  v_mfma_f32_32x32x16_bf16 v[32:47], a[128:131], a[32:35], v[32:47]
  buffer_load_dwordx4 v[152:155], v248, s[20:23], s38 offen offset:0 sc1
  v_exp_f32 v79, v79
  v_rcp_f32 v48, v48
  v_fma_f32 v64, v64, s60, s60 clamp
  v_mfma_f32_32x32x16_bf16 v[32:47], a[132:135], a[36:39], v[32:47]
  v_rcp_f32 v49, v49
  v_rcp_f32 v50, v50
  v_rcp_f32 v51, v51
  v_mfma_f32_32x32x16_bf16 v[32:47], a[136:139], a[40:43], v[32:47]
  buffer_load_dwordx4 v[156:159], v248, s[20:23], s38 offen offset:1024 sc1
  v_rcp_f32 v52, v52
  v_rcp_f32 v53, v53
  v_fma_f32 v65, v65, s60, s60 clamp
  v_mfma_f32_32x32x16_bf16 v[32:47], a[140:143], a[44:47], v[32:47]
  ds_write_b128 v252, v[116:119] offset:3072
  v_rcp_f32 v54, v54
  v_rcp_f32_e64 v55, v55
  v_pk_fma_f32 v[66:67], v[66:67], s[60:61], s[60:61] clamp
  v_pk_fma_f32 v[68:69], v[68:69], s[60:61], s[60:61] clamp
  v_pk_fma_f32 v[70:71], v[70:71], s[60:61], s[60:61] clamp
  v_pk_fma_f32 v[72:73], v[72:73], s[60:61], s[60:61] clamp
  v_pk_fma_f32 v[74:75], v[74:75], s[60:61], s[60:61] clamp
  v_pk_fma_f32 v[76:77], v[76:77], s[60:61], s[60:61] clamp
  v_pk_fma_f32 v[78:79], v[78:79], s[60:61], s[60:61] clamp
  v_pk_mul_f32 v[0:1], v[0:1], v[48:49]
  v_pk_mul_f32 v[2:3], v[2:3], v[50:51]
  v_pk_mul_f32 v[4:5], v[4:5], v[52:53]
  v_pk_mul_f32 v[6:7], v[6:7], v[54:55]
  v_pk_mul_f32 v[8:9], v[8:9], v[48:49]
  v_pk_mul_f32 v[10:11], v[10:11], v[50:51]
  v_pk_mul_f32 v[12:13], v[12:13], v[52:53]
  v_pk_mul_f32 v[14:15], v[14:15], v[54:55]
  v_pk_fma_f32 v[80:81], v[0:1], v[0:1], v[80:81]
  v_pk_fma_f32 v[82:83], v[2:3], v[2:3], v[82:83]
  v_pk_fma_f32 v[84:85], v[4:5], v[4:5], v[84:85]
  v_pk_fma_f32 v[86:87], v[6:7], v[6:7], v[86:87]
  v_pk_fma_f32 v[88:89], v[8:9], v[8:9], v[88:89]
  v_pk_fma_f32 v[90:91], v[10:11], v[10:11], v[90:91]
  v_pk_fma_f32 v[92:93], v[12:13], v[12:13], v[92:93]
  v_pk_fma_f32 v[94:95], v[14:15], v[14:15], v[94:95]
  v_pk_fma_f32 v[48:49], v[32:33], v[32:33], s[62:63]
  v_pk_fma_f32 v[50:51], v[34:35], v[34:35], s[62:63]
  v_pk_fma_f32 v[52:53], v[36:37], v[36:37], s[62:63]
  v_pk_fma_f32 v[54:55], v[38:39], v[38:39], s[62:63]
  v_pk_fma_f32 v[56:57], v[40:41], v[40:41], s[62:63]
  v_pk_fma_f32 v[58:59], v[42:43], v[42:43], s[62:63]
  v_pk_fma_f32 v[60:61], v[44:45], v[44:45], s[62:63]
  v_pk_fma_f32 v[62:63], v[46:47], v[46:47], s[62:63]
  v_pk_mul_f32 v[48:49], v[32:33], v[48:49] neg_lo:[1,0] neg_hi:[1,0]
  v_pk_mul_f32 v[50:51], v[34:35], v[50:51] neg_lo:[1,0] neg_hi:[1,0]
  v_pk_mul_f32 v[52:53], v[36:37], v[52:53] neg_lo:[1,0] neg_hi:[1,0]
  v_pk_mul_f32 v[54:55], v[38:39], v[54:55] neg_lo:[1,0] neg_hi:[1,0]
  v_pk_mul_f32 v[56:57], v[40:41], v[56:57] neg_lo:[1,0] neg_hi:[1,0]
  v_pk_mul_f32 v[58:59], v[42:43], v[58:59] neg_lo:[1,0] neg_hi:[1,0]
  v_pk_mul_f32 v[60:61], v[44:45], v[60:61] neg_lo:[1,0] neg_hi:[1,0]
  v_pk_mul_f32 v[62:63], v[46:47], v[62:63] neg_lo:[1,0] neg_hi:[1,0]
  v_pk_mul_f32 v[16:17], v[16:17], v[72:73]
  v_pk_mul_f32 v[18:19], v[18:19], v[74:75]
  v_pk_mul_f32 v[20:21], v[20:21], v[76:77]
  v_pk_mul_f32 v[22:23], v[22:23], v[78:79]
  v_pk_mul_f32 v[24:25], v[24:25], v[64:65]
  v_pk_mul_f32 v[26:27], v[26:27], v[66:67]
  v_pk_mul_f32 v[28:29], v[28:29], v[68:69]
  v_pk_mul_f32 v[30:31], v[30:31], v[70:71]
  v_pk_mul_f32 v[64:65], v[64:65], v[72:73]
  v_pk_mul_f32 v[66:67], v[66:67], v[74:75]
  v_pk_mul_f32 v[68:69], v[68:69], v[76:77]
  v_pk_mul_f32 v[70:71], v[70:71], v[78:79]
  v_mfma_f32_32x32x16_bf16 v[232:247], a[48:51], a[0:3], 0
  v_exp_f32 v48, v48
  v_exp_f32 v49, v49
  v_cvt_pk_bf16_f32 v112, v0, v1
  v_cvt_pk_bf16_f32 v113, v2, v3
  v_mfma_f32_32x32x16_bf16 v[232:247], a[52:55], a[4:7], v[232:247]
  ds_read_b128 a[0:3], v250 offset:0
  v_exp_f32 v50, v50
  v_exp_f32 v51, v51
  v_cvt_pk_bf16_f32 v114, v4, v5
  v_mfma_f32_32x32x16_bf16 v[232:247], a[56:59], a[8:11], v[232:247]
  ds_read_b128 a[4:7], v250 offset:1024
  v_exp_f32 v52, v52
  v_exp_f32 v53, v53
  v_cvt_pk_bf16_f32 v115, v6, v7
  v_mfma_f32_32x32x16_bf16 v[232:247], a[60:63], a[12:15], v[232:247]
  ds_read_b128 a[8:11], v250 offset:2048
  v_exp_f32 v54, v54
  v_exp_f32 v55, v55
  v_accvgpr_write_b32 a152, v112
  v_mfma_f32_32x32x16_bf16 v[232:247], a[64:67], a[16:19], v[232:247]
  ds_read_b128 a[12:15], v250 offset:3072
  v_exp_f32 v56, v56
  v_exp_f32 v57, v57
  v_accvgpr_write_b32 a153, v113
  v_mfma_f32_32x32x16_bf16 v[232:247], a[68:71], a[20:23], v[232:247]
  ds_read_b128 a[16:19], v250 offset:4096
  v_exp_f32 v58, v58
  v_exp_f32 v59, v59
  v_accvgpr_write_b32 a154, v114
  v_mfma_f32_32x32x16_bf16 v[232:247], a[72:75], a[24:27], v[232:247]
  ds_read_b128 a[20:23], v250 offset:5120
  v_exp_f32 v60, v60
  v_exp_f32 v61, v61
  v_accvgpr_write_b32 a155, v115
  v_mfma_f32_32x32x16_bf16 v[232:247], a[76:79], a[28:31], v[232:247]
  ds_read_b128 a[24:27], v250 offset:6144
  v_exp_f32 v62, v62
  v_exp_f32 v63, v63
  v_cvt_pk_bf16_f32 v116, v8, v9
  v_mfma_f32_32x32x16_bf16 v[232:247], a[80:83], a[32:35], v[232:247]
  ds_read_b128 a[28:31], v250 offset:7168
  v_rcp_f32 v64, v64
  v_rcp_f32 v65, v65
  v_cvt_pk_bf16_f32 v117, v10, v11
  v_mfma_f32_32x32x16_bf16 v[232:247], a[84:87], a[36:39], v[232:247]
  ds_read_b128 a[32:35], v250 offset:8192
  v_rcp_f32 v66, v66
  v_rcp_f32 v67, v67
  v_cvt_pk_bf16_f32 v118, v12, v13
  v_mfma_f32_32x32x16_bf16 v[232:247], a[88:91], a[40:43], v[232:247]
  ds_read_b128 a[36:39], v250 offset:9216
  v_rcp_f32 v68, v68
  v_rcp_f32 v69, v69
  v_cvt_pk_bf16_f32 v119, v14, v15
  v_mfma_f32_32x32x16_bf16 v[232:247], a[92:95], a[44:47], v[232:247]
  ds_read_b128 a[40:43], v250 offset:10240
  ds_read_b128 a[44:47], v250 offset:11264
  v_rcp_f32 v70, v70
  v_rcp_f32 v71, v71
  v_accvgpr_write_b32 a156, v116
  v_accvgpr_write_b32 a157, v117
  v_accvgpr_write_b32 a158, v118
  v_accvgpr_write_b32 a159, v119
  v_pk_fma_f32 v[48:49], v[48:49], s[60:61], s[60:61] clamp
  v_pk_fma_f32 v[50:51], v[50:51], s[60:61], s[60:61] clamp
  v_pk_fma_f32 v[52:53], v[52:53], s[60:61], s[60:61] clamp
  v_pk_fma_f32 v[54:55], v[54:55], s[60:61], s[60:61] clamp
  v_pk_fma_f32 v[56:57], v[56:57], s[60:61], s[60:61] clamp
  v_pk_fma_f32 v[58:59], v[58:59], s[60:61], s[60:61] clamp
  v_pk_fma_f32 v[60:61], v[60:61], s[60:61], s[60:61] clamp
  v_pk_fma_f32 v[62:63], v[62:63], s[60:61], s[60:61] clamp
  v_pk_mul_f32 v[16:17], v[16:17], v[64:65]
  v_pk_mul_f32 v[18:19], v[18:19], v[66:67]
  v_pk_mul_f32 v[20:21], v[20:21], v[68:69]
  v_pk_mul_f32 v[22:23], v[22:23], v[70:71]
  v_pk_mul_f32 v[24:25], v[24:25], v[64:65]
  v_pk_mul_f32 v[26:27], v[26:27], v[66:67]
  v_pk_mul_f32 v[28:29], v[28:29], v[68:69]
  v_pk_mul_f32 v[30:31], v[30:31], v[70:71]
  v_pk_fma_f32 v[96:97], v[16:17], v[16:17], v[96:97]
  v_pk_fma_f32 v[98:99], v[18:19], v[18:19], v[98:99]
  v_pk_fma_f32 v[100:101], v[20:21], v[20:21], v[100:101]
  v_pk_fma_f32 v[102:103], v[22:23], v[22:23], v[102:103]
  v_pk_fma_f32 v[104:105], v[24:25], v[24:25], v[104:105]
  v_pk_fma_f32 v[106:107], v[26:27], v[26:27], v[106:107]
  v_pk_fma_f32 v[108:109], v[28:29], v[28:29], v[108:109]
  v_pk_fma_f32 v[110:111], v[30:31], v[30:31], v[110:111]
  v_pk_fma_f32 v[64:65], v[232:233], v[232:233], s[62:63]
  v_pk_fma_f32 v[66:67], v[234:235], v[234:235], s[62:63]
  v_pk_fma_f32 v[68:69], v[236:237], v[236:237], s[62:63]
  v_pk_fma_f32 v[70:71], v[238:239], v[238:239], s[62:63]
  v_pk_fma_f32 v[72:73], v[240:241], v[240:241], s[62:63]
  v_pk_fma_f32 v[74:75], v[242:243], v[242:243], s[62:63]
  v_pk_fma_f32 v[76:77], v[244:245], v[244:245], s[62:63]
  v_pk_fma_f32 v[78:79], v[246:247], v[246:247], s[62:63]
  v_pk_mul_f32 v[64:65], v[232:233], v[64:65] neg_lo:[1,0] neg_hi:[1,0]
  v_pk_mul_f32 v[66:67], v[234:235], v[66:67] neg_lo:[1,0] neg_hi:[1,0]
  v_pk_mul_f32 v[68:69], v[236:237], v[68:69] neg_lo:[1,0] neg_hi:[1,0]
  v_pk_mul_f32 v[70:71], v[238:239], v[70:71] neg_lo:[1,0] neg_hi:[1,0]
  v_pk_mul_f32 v[72:73], v[240:241], v[72:73] neg_lo:[1,0] neg_hi:[1,0]
  v_pk_mul_f32 v[74:75], v[242:243], v[74:75] neg_lo:[1,0] neg_hi:[1,0]
  v_pk_mul_f32 v[76:77], v[244:245], v[76:77] neg_lo:[1,0] neg_hi:[1,0]
  v_pk_mul_f32 v[78:79], v[246:247], v[78:79] neg_lo:[1,0] neg_hi:[1,0]
  v_pk_mul_f32 v[32:33], v[32:33], v[56:57]
  v_pk_mul_f32 v[34:35], v[34:35], v[58:59]
  v_pk_mul_f32 v[36:37], v[36:37], v[60:61]
  v_pk_mul_f32 v[38:39], v[38:39], v[62:63]
  v_pk_mul_f32 v[40:41], v[40:41], v[48:49]
  v_pk_mul_f32 v[42:43], v[42:43], v[50:51]
  v_pk_mul_f32 v[44:45], v[44:45], v[52:53]
  v_pk_mul_f32 v[46:47], v[46:47], v[54:55]
  v_pk_mul_f32 v[48:49], v[48:49], v[56:57]
  v_pk_mul_f32 v[50:51], v[50:51], v[58:59]
  v_pk_mul_f32 v[52:53], v[52:53], v[60:61]
  v_pk_mul_f32 v[54:55], v[54:55], v[62:63]
  s_waitcnt lgkmcnt(0)
  v_mfma_f32_32x32x16_bf16 v[0:15], a[96:99], a[0:3], 0
  v_exp_f32 v64, v64
  v_exp_f32 v65, v65
  v_cvt_pk_bf16_f32 v112, v16, v17
  v_cvt_pk_bf16_f32 v113, v18, v19
  v_mfma_f32_32x32x16_bf16 v[0:15], a[100:103], a[4:7], v[0:15]
  v_exp_f32 v66, v66
  v_exp_f32 v67, v67
  v_cvt_pk_bf16_f32 v114, v20, v21
  v_cvt_pk_bf16_f32 v115, v22, v23
  v_mfma_f32_32x32x16_bf16 v[0:15], a[104:107], a[8:11], v[0:15]
  buffer_load_dwordx4 v[160:163], v248, s[20:23], s38 offen offset:2048 sc1
  v_exp_f32 v68, v68
  v_exp_f32 v69, v69
  v_cvt_pk_bf16_f32 v116, v24, v25
  v_mfma_f32_32x32x16_bf16 v[0:15], a[108:111], a[12:15], v[0:15]
  buffer_load_dwordx4 v[164:167], v248, s[20:23], s38 offen offset:3072 sc1
  v_exp_f32 v70, v70
  v_exp_f32 v71, v71
  v_cvt_pk_bf16_f32 v117, v26, v27
  v_mfma_f32_32x32x16_bf16 v[0:15], a[112:115], a[16:19], v[0:15]
  v_exp_f32 v72, v72
  v_exp_f32 v73, v73
  v_cvt_pk_bf16_f32 v118, v28, v29
  v_cvt_pk_bf16_f32 v119, v30, v31
  v_mfma_f32_32x32x16_bf16 v[0:15], a[116:119], a[20:23], v[0:15]
  ds_write_b128 v252, v[112:115] offset:4096
  v_fma_f32 v64, v64, s60, s60 clamp
  v_mfma_f32_32x32x16_bf16 v[0:15], a[120:123], a[24:27], v[0:15]
  v_exp_f32 v74, v74
  v_exp_f32 v75, v75
  v_exp_f32 v76, v76
  v_mfma_f32_32x32x16_bf16 v[0:15], a[124:127], a[28:31], v[0:15]
  buffer_load_dwordx4 v[168:171], v248, s[20:23], s43 offen offset:0 sc1
  v_exp_f32 v77, v77
  v_exp_f32 v78, v78
  v_fma_f32 v65, v65, s60, s60 clamp
  v_mfma_f32_32x32x16_bf16 v[0:15], a[128:131], a[32:35], v[0:15]
  buffer_load_dwordx4 v[172:175], v248, s[20:23], s43 offen offset:1024 sc1
  v_exp_f32 v79, v79
  v_rcp_f32 v48, v48
  v_fma_f32 v66, v66, s60, s60 clamp
  v_mfma_f32_32x32x16_bf16 v[0:15], a[132:135], a[36:39], v[0:15]
  v_rcp_f32 v49, v49
  v_rcp_f32 v50, v50
  v_rcp_f32 v51, v51
  v_mfma_f32_32x32x16_bf16 v[0:15], a[136:139], a[40:43], v[0:15]
  buffer_load_dwordx4 v[176:179], v248, s[20:23], s43 offen offset:2048 sc1
  v_rcp_f32 v52, v52
  v_rcp_f32 v53, v53
  v_fma_f32 v67, v67, s60, s60 clamp
  v_mfma_f32_32x32x16_bf16 v[0:15], a[140:143], a[44:47], v[0:15]
  ds_write_b128 v252, v[116:119] offset:5120
  v_rcp_f32 v54, v54
  v_rcp_f32_e64 v55, v55
  s_waitcnt vmcnt(8)
  v_readfirstlane_b32 s4, v253
  s_cmp_lt_u32 s4, 29
  s_cbranch_scc1 L_slow1
L_back1:
  v_pk_fma_f32 v[68:69], v[68:69], s[60:61], s[60:61] clamp
  v_pk_fma_f32 v[70:71], v[70:71], s[60:61], s[60:61] clamp
  v_pk_fma_f32 v[72:73], v[72:73], s[60:61], s[60:61] clamp
  v_pk_fma_f32 v[74:75], v[74:75], s[60:61], s[60:61] clamp
  v_pk_fma_f32 v[76:77], v[76:77], s[60:61], s[60:61] clamp
  v_pk_fma_f32 v[78:79], v[78:79], s[60:61], s[60:61] clamp
  v_pk_mul_f32 v[32:33], v[32:33], v[48:49]
  v_pk_mul_f32 v[34:35], v[34:35], v[50:51]
  v_pk_mul_f32 v[36:37], v[36:37], v[52:53]
  v_pk_mul_f32 v[38:39], v[38:39], v[54:55]
  v_pk_mul_f32 v[40:41], v[40:41], v[48:49]
  v_pk_mul_f32 v[42:43], v[42:43], v[50:51]
  v_pk_mul_f32 v[44:45], v[44:45], v[52:53]
  v_pk_mul_f32 v[46:47], v[46:47], v[54:55]
  v_pk_fma_f32 v[80:81], v[32:33], v[32:33], v[80:81]
  v_pk_fma_f32 v[82:83], v[34:35], v[34:35], v[82:83]
  v_pk_fma_f32 v[84:85], v[36:37], v[36:37], v[84:85]
  v_pk_fma_f32 v[86:87], v[38:39], v[38:39], v[86:87]
  v_pk_fma_f32 v[88:89], v[40:41], v[40:41], v[88:89]
  v_pk_fma_f32 v[90:91], v[42:43], v[42:43], v[90:91]
  v_pk_fma_f32 v[92:93], v[44:45], v[44:45], v[92:93]
  v_pk_fma_f32 v[94:95], v[46:47], v[46:47], v[94:95]
  v_pk_fma_f32 v[48:49], v[0:1], v[0:1], s[62:63]
  v_pk_fma_f32 v[50:51], v[2:3], v[2:3], s[62:63]
  v_pk_fma_f32 v[52:53], v[4:5], v[4:5], s[62:63]
  v_pk_fma_f32 v[54:55], v[6:7], v[6:7], s[62:63]
  v_pk_fma_f32 v[56:57], v[8:9], v[8:9], s[62:63]
  v_pk_fma_f32 v[58:59], v[10:11], v[10:11], s[62:63]
  v_pk_fma_f32 v[60:61], v[12:13], v[12:13], s[62:63]
  v_pk_fma_f32 v[62:63], v[14:15], v[14:15], s[62:63]
  v_pk_mul_f32 v[48:49], v[0:1], v[48:49] neg_lo:[1,0] neg_hi:[1,0]
  v_pk_mul_f32 v[50:51], v[2:3], v[50:51] neg_lo:[1,0] neg_hi:[1,0]
  v_pk_mul_f32 v[52:53], v[4:5], v[52:53] neg_lo:[1,0] neg_hi:[1,0]
  v_pk_mul_f32 v[54:55], v[6:7], v[54:55] neg_lo:[1,0] neg_hi:[1,0]
  v_pk_mul_f32 v[56:57], v[8:9], v[56:57] neg_lo:[1,0] neg_hi:[1,0]
  v_pk_mul_f32 v[58:59], v[10:11], v[58:59] neg_lo:[1,0] neg_hi:[1,0]
  v_pk_mul_f32 v[60:61], v[12:13], v[60:61] neg_lo:[1,0] neg_hi:[1,0]
  v_pk_mul_f32 v[62:63], v[14:15], v[62:63] neg_lo:[1,0] neg_hi:[1,0]
  v_pk_mul_f32 v[232:233], v[232:233], v[72:73]
  v_pk_mul_f32 v[234:235], v[234:235], v[74:75]
  v_pk_mul_f32 v[236:237], v[236:237], v[76:77]
  v_pk_mul_f32 v[238:239], v[238:239], v[78:79]
  v_pk_mul_f32 v[240:241], v[240:241], v[64:65]
  v_pk_mul_f32 v[242:243], v[242:243], v[66:67]
  v_pk_mul_f32 v[244:245], v[244:245], v[68:69]
  v_pk_mul_f32 v[246:247], v[246:247], v[70:71]
  v_pk_mul_f32 v[64:65], v[64:65], v[72:73]
  v_pk_mul_f32 v[66:67], v[66:67], v[74:75]
  v_pk_mul_f32 v[68:69], v[68:69], v[76:77]
  v_pk_mul_f32 v[70:71], v[70:71], v[78:79]
  v_mfma_f32_32x32x16_bf16 v[16:31], a[48:51], a[0:3], 0
  v_exp_f32 v48, v48
  v_exp_f32 v49, v49
  v_cvt_pk_bf16_f32 v112, v32, v33
  v_cvt_pk_bf16_f32 v113, v34, v35
  v_mfma_f32_32x32x16_bf16 v[16:31], a[52:55], a[4:7], v[16:31]
  ds_read_b128 a[0:3], v250 offset:13056
  v_exp_f32 v50, v50
  v_exp_f32 v51, v51
  v_cvt_pk_bf16_f32 v114, v36, v37
  v_mfma_f32_32x32x16_bf16 v[16:31], a[56:59], a[8:11], v[16:31]
  ds_read_b128 a[4:7], v250 offset:14080
  v_exp_f32 v52, v52
  v_exp_f32 v53, v53
  v_cvt_pk_bf16_f32 v115, v38, v39
  v_mfma_f32_32x32x16_bf16 v[16:31], a[60:63], a[12:15], v[16:31]
  ds_read_b128 a[8:11], v250 offset:15104
  v_exp_f32 v54, v54
  v_exp_f32 v55, v55
  v_accvgpr_write_b32 a160, v112
  v_mfma_f32_32x32x16_bf16 v[16:31], a[64:67], a[16:19], v[16:31]
  ds_read_b128 a[12:15], v250 offset:16128
  v_exp_f32 v56, v56
  v_exp_f32 v57, v57
  v_accvgpr_write_b32 a161, v113
  v_mfma_f32_32x32x16_bf16 v[16:31], a[68:71], a[20:23], v[16:31]
  ds_read_b128 a[16:19], v250 offset:17152
  v_exp_f32 v58, v58
  v_exp_f32 v59, v59
  v_accvgpr_write_b32 a162, v114
  v_mfma_f32_32x32x16_bf16 v[16:31], a[72:75], a[24:27], v[16:31]
  ds_read_b128 a[20:23], v250 offset:18176
  v_exp_f32 v60, v60
  v_exp_f32 v61, v61
  v_accvgpr_write_b32 a163, v115
  v_mfma_f32_32x32x16_bf16 v[16:31], a[76:79], a[28:31], v[16:31]
  ds_read_b128 a[24:27], v250 offset:19200
  v_exp_f32 v62, v62
  v_exp_f32 v63, v63
  v_cvt_pk_bf16_f32 v116, v40, v41
  v_mfma_f32_32x32x16_bf16 v[16:31], a[80:83], a[32:35], v[16:31]
  ds_read_b128 a[28:31], v250 offset:20224
  v_rcp_f32 v64, v64
  v_rcp_f32 v65, v65
  v_cvt_pk_bf16_f32 v117, v42, v43
  v_mfma_f32_32x32x16_bf16 v[16:31], a[84:87], a[36:39], v[16:31]
  ds_read_b128 a[32:35], v250 offset:21248
  v_rcp_f32 v66, v66
  v_rcp_f32 v67, v67
  v_cvt_pk_bf16_f32 v118, v44, v45
  v_mfma_f32_32x32x16_bf16 v[16:31], a[88:91], a[40:43], v[16:31]
  ds_read_b128 a[36:39], v250 offset:22272
  v_rcp_f32 v68, v68
  v_rcp_f32 v69, v69
  v_cvt_pk_bf16_f32 v119, v46, v47
  v_mfma_f32_32x32x16_bf16 v[16:31], a[92:95], a[44:47], v[16:31]
  ds_read_b128 a[40:43], v250 offset:23296
  ds_read_b128 a[44:47], v250 offset:24320
  v_rcp_f32 v70, v70
  v_rcp_f32 v71, v71
  v_accvgpr_write_b32 a164, v116
  v_accvgpr_write_b32 a165, v117
  v_accvgpr_write_b32 a166, v118
  v_accvgpr_write_b32 a167, v119
  v_pk_fma_f32 v[48:49], v[48:49], s[60:61], s[60:61] clamp
  v_pk_fma_f32 v[50:51], v[50:51], s[60:61], s[60:61] clamp
  v_pk_fma_f32 v[52:53], v[52:53], s[60:61], s[60:61] clamp
  v_pk_fma_f32 v[54:55], v[54:55], s[60:61], s[60:61] clamp
  v_pk_fma_f32 v[56:57], v[56:57], s[60:61], s[60:61] clamp
  v_pk_fma_f32 v[58:59], v[58:59], s[60:61], s[60:61] clamp
  v_pk_fma_f32 v[60:61], v[60:61], s[60:61], s[60:61] clamp
  v_pk_fma_f32 v[62:63], v[62:63], s[60:61], s[60:61] clamp
  v_pk_mul_f32 v[232:233], v[232:233], v[64:65]
  v_pk_mul_f32 v[234:235], v[234:235], v[66:67]
  v_pk_mul_f32 v[236:237], v[236:237], v[68:69]
  v_pk_mul_f32 v[238:239], v[238:239], v[70:71]
  v_pk_mul_f32 v[240:241], v[240:241], v[64:65]
  v_pk_mul_f32 v[242:243], v[242:243], v[66:67]
  v_pk_mul_f32 v[244:245], v[244:245], v[68:69]
  v_pk_mul_f32 v[246:247], v[246:247], v[70:71]
  v_pk_fma_f32 v[96:97], v[232:233], v[232:233], v[96:97]
  v_pk_fma_f32 v[98:99], v[234:235], v[234:235], v[98:99]
  v_pk_fma_f32 v[100:101], v[236:237], v[236:237], v[100:101]
  v_pk_fma_f32 v[102:103], v[238:239], v[238:239], v[102:103]
  v_pk_fma_f32 v[104:105], v[240:241], v[240:241], v[104:105]
  v_pk_fma_f32 v[106:107], v[242:243], v[242:243], v[106:107]
  v_pk_fma_f32 v[108:109], v[244:245], v[244:245], v[108:109]
  v_pk_fma_f32 v[110:111], v[246:247], v[246:247], v[110:111]
  v_pk_fma_f32 v[64:65], v[16:17], v[16:17], s[62:63]
  v_pk_fma_f32 v[66:67], v[18:19], v[18:19], s[62:63]
  v_pk_fma_f32 v[68:69], v[20:21], v[20:21], s[62:63]
  v_pk_fma_f32 v[70:71], v[22:23], v[22:23], s[62:63]
  v_pk_fma_f32 v[72:73], v[24:25], v[24:25], s[62:63]
  v_pk_fma_f32 v[74:75], v[26:27], v[26:27], s[62:63]
  v_pk_fma_f32 v[76:77], v[28:29], v[28:29], s[62:63]
  v_pk_fma_f32 v[78:79], v[30:31], v[30:31], s[62:63]
  v_pk_mul_f32 v[64:65], v[16:17], v[64:65] neg_lo:[1,0] neg_hi:[1,0]
  v_pk_mul_f32 v[66:67], v[18:19], v[66:67] neg_lo:[1,0] neg_hi:[1,0]
  v_pk_mul_f32 v[68:69], v[20:21], v[68:69] neg_lo:[1,0] neg_hi:[1,0]
  v_pk_mul_f32 v[70:71], v[22:23], v[70:71] neg_lo:[1,0] neg_hi:[1,0]
  v_pk_mul_f32 v[72:73], v[24:25], v[72:73] neg_lo:[1,0] neg_hi:[1,0]
  v_pk_mul_f32 v[74:75], v[26:27], v[74:75] neg_lo:[1,0] neg_hi:[1,0]
  v_pk_mul_f32 v[76:77], v[28:29], v[76:77] neg_lo:[1,0] neg_hi:[1,0]
  v_pk_mul_f32 v[78:79], v[30:31], v[78:79] neg_lo:[1,0] neg_hi:[1,0]
  v_pk_mul_f32 v[0:1], v[0:1], v[56:57]
  v_pk_mul_f32 v[2:3], v[2:3], v[58:59]
  v_pk_mul_f32 v[4:5], v[4:5], v[60:61]
  v_pk_mul_f32 v[6:7], v[6:7], v[62:63]
  v_pk_mul_f32 v[8:9], v[8:9], v[48:49]
  v_pk_mul_f32 v[10:11], v[10:11], v[50:51]
  v_pk_mul_f32 v[12:13], v[12:13], v[52:53]
  v_pk_mul_f32 v[14:15], v[14:15], v[54:55]
  v_pk_mul_f32 v[48:49], v[48:49], v[56:57]
  v_pk_mul_f32 v[50:51], v[50:51], v[58:59]
  v_pk_mul_f32 v[52:53], v[52:53], v[60:61]
  v_pk_mul_f32 v[54:55], v[54:55], v[62:63]
  s_waitcnt lgkmcnt(0)
  v_mfma_f32_32x32x16_bf16 v[32:47], a[96:99], a[0:3], 0
  v_exp_f32 v64, v64
  v_exp_f32 v65, v65
  v_cvt_pk_bf16_f32 v112, v232, v233
  v_cvt_pk_bf16_f32 v113, v234, v235
  v_mfma_f32_32x32x16_bf16 v[32:47], a[100:103], a[4:7], v[32:47]
  v_exp_f32 v66, v66
  v_exp_f32 v67, v67
  v_cvt_pk_bf16_f32 v114, v236, v237
  v_cvt_pk_bf16_f32 v115, v238, v239
  v_mfma_f32_32x32x16_bf16 v[32:47], a[104:107], a[8:11], v[32:47]
  buffer_load_dwordx4 v[180:183], v248, s[20:23], s43 offen offset:3072 sc1
  v_exp_f32 v68, v68
  v_exp_f32 v69, v69
  v_cvt_pk_bf16_f32 v116, v240, v241
  v_mfma_f32_32x32x16_bf16 v[32:47], a[108:111], a[12:15], v[32:47]
  buffer_load_dwordx4 v[184:187], v248, s[20:23], s47 offen offset:0 sc1
  v_exp_f32 v70, v70
  v_exp_f32 v71, v71
  v_cvt_pk_bf16_f32 v117, v242, v243
  v_mfma_f32_32x32x16_bf16 v[32:47], a[112:115], a[16:19], v[32:47]
  v_exp_f32 v72, v72
  v_exp_f32 v73, v73
  v_cvt_pk_bf16_f32 v118, v244, v245
  v_cvt_pk_bf16_f32 v119, v246, v247
  v_mfma_f32_32x32x16_bf16 v[32:47], a[116:119], a[20:23], v[32:47]
  ds_write_b128 v252, v[112:115] offset:6144
  v_fma_f32 v64, v64, s60, s60 clamp
  v_mfma_f32_32x32x16_bf16 v[32:47], a[120:123], a[24:27], v[32:47]
  v_exp_f32 v74, v74
  v_exp_f32 v75, v75
  v_exp_f32 v76, v76
  v_mfma_f32_32x32x16_bf16 v[32:47], a[124:127], a[28:31], v[32:47]
  buffer_load_dwordx4 v[188:191], v248, s[20:23], s47 offen offset:1024 sc1
  v_exp_f32 v77, v77
  v_exp_f32 v78, v78
  v_fma_f32 v65, v65, s60, s60 clamp
  v_mfma_f32_32x32x16_bf16 v[32:47], a[128:131], a[32:35], v[32:47]
  buffer_load_dwordx4 v[192:195], v248, s[20:23], s47 offen offset:2048 sc1
  v_exp_f32 v79, v79
  v_rcp_f32 v48, v48
  v_fma_f32 v66, v66, s60, s60 clamp
  v_mfma_f32_32x32x16_bf16 v[32:47], a[132:135], a[36:39], v[32:47]
  v_rcp_f32 v49, v49
  v_rcp_f32 v50, v50
  v_rcp_f32 v51, v51
  v_mfma_f32_32x32x16_bf16 v[32:47], a[136:139], a[40:43], v[32:47]
  buffer_load_dwordx4 v[196:199], v248, s[20:23], s47 offen offset:3072 sc1
  v_rcp_f32 v52, v52
  v_rcp_f32 v53, v53
  v_fma_f32 v67, v67, s60, s60 clamp
  v_mfma_f32_32x32x16_bf16 v[32:47], a[140:143], a[44:47], v[32:47]
  ds_write_b128 v252, v[116:119] offset:7168
  v_rcp_f32 v54, v54
  v_rcp_f32_e64 v55, v55
  v_pk_fma_f32 v[68:69], v[68:69], s[60:61], s[60:61] clamp
  v_pk_fma_f32 v[70:71], v[70:71], s[60:61], s[60:61] clamp
  v_pk_fma_f32 v[72:73], v[72:73], s[60:61], s[60:61] clamp
  v_pk_fma_f32 v[74:75], v[74:75], s[60:61], s[60:61] clamp
  v_pk_fma_f32 v[76:77], v[76:77], s[60:61], s[60:61] clamp
  v_pk_fma_f32 v[78:79], v[78:79], s[60:61], s[60:61] clamp
  v_pk_mul_f32 v[0:1], v[0:1], v[48:49]
  v_pk_mul_f32 v[2:3], v[2:3], v[50:51]
  v_pk_mul_f32 v[4:5], v[4:5], v[52:53]
  v_pk_mul_f32 v[6:7], v[6:7], v[54:55]
  v_pk_mul_f32 v[8:9], v[8:9], v[48:49]
  v_pk_mul_f32 v[10:11], v[10:11], v[50:51]
  v_pk_mul_f32 v[12:13], v[12:13], v[52:53]
  v_pk_mul_f32 v[14:15], v[14:15], v[54:55]
  v_pk_fma_f32 v[80:81], v[0:1], v[0:1], v[80:81]
  v_pk_fma_f32 v[82:83], v[2:3], v[2:3], v[82:83]
  v_pk_fma_f32 v[84:85], v[4:5], v[4:5], v[84:85]
  v_pk_fma_f32 v[86:87], v[6:7], v[6:7], v[86:87]
  v_pk_fma_f32 v[88:89], v[8:9], v[8:9], v[88:89]
  v_pk_fma_f32 v[90:91], v[10:11], v[10:11], v[90:91]
  v_pk_fma_f32 v[92:93], v[12:13], v[12:13], v[92:93]
  v_pk_fma_f32 v[94:95], v[14:15], v[14:15], v[94:95]
  v_pk_fma_f32 v[48:49], v[32:33], v[32:33], s[62:63]
  v_pk_fma_f32 v[50:51], v[34:35], v[34:35], s[62:63]
  v_pk_fma_f32 v[52:53], v[36:37], v[36:37], s[62:63]
  v_pk_fma_f32 v[54:55], v[38:39], v[38:39], s[62:63]
  v_pk_fma_f32 v[56:57], v[40:41], v[40:41], s[62:63]
  v_pk_fma_f32 v[58:59], v[42:43], v[42:43], s[62:63]
  v_pk_fma_f32 v[60:61], v[44:45], v[44:45], s[62:63]
  v_pk_fma_f32 v[62:63], v[46:47], v[46:47], s[62:63]
  v_pk_mul_f32 v[48:49], v[32:33], v[48:49] neg_lo:[1,0] neg_hi:[1,0]
  v_pk_mul_f32 v[50:51], v[34:35], v[50:51] neg_lo:[1,0] neg_hi:[1,0]
  v_pk_mul_f32 v[52:53], v[36:37], v[52:53] neg_lo:[1,0] neg_hi:[1,0]
  v_pk_mul_f32 v[54:55], v[38:39], v[54:55] neg_lo:[1,0] neg_hi:[1,0]
  v_pk_mul_f32 v[56:57], v[40:41], v[56:57] neg_lo:[1,0] neg_hi:[1,0]
  v_pk_mul_f32 v[58:59], v[42:43], v[58:59] neg_lo:[1,0] neg_hi:[1,0]
  v_pk_mul_f32 v[60:61], v[44:45], v[60:61] neg_lo:[1,0] neg_hi:[1,0]
  v_pk_mul_f32 v[62:63], v[46:47], v[62:63] neg_lo:[1,0] neg_hi:[1,0]
  v_pk_mul_f32 v[16:17], v[16:17], v[72:73]
  v_pk_mul_f32 v[18:19], v[18:19], v[74:75]
  v_pk_mul_f32 v[20:21], v[20:21], v[76:77]
  v_pk_mul_f32 v[22:23], v[22:23], v[78:79]
  v_pk_mul_f32 v[24:25], v[24:25], v[64:65]
  v_pk_mul_f32 v[26:27], v[26:27], v[66:67]
  v_pk_mul_f32 v[28:29], v[28:29], v[68:69]
  v_pk_mul_f32 v[30:31], v[30:31], v[70:71]
  v_pk_mul_f32 v[64:65], v[64:65], v[72:73]
  v_pk_mul_f32 v[66:67], v[66:67], v[74:75]
  v_pk_mul_f32 v[68:69], v[68:69], v[76:77]
  v_pk_mul_f32 v[70:71], v[70:71], v[78:79]
  v_mfma_f32_32x32x16_bf16 v[232:247], a[48:51], a[0:3], 0
  v_exp_f32 v48, v48
  v_exp_f32 v49, v49
  v_cvt_pk_bf16_f32 v112, v0, v1
  v_cvt_pk_bf16_f32 v113, v2, v3
  v_mfma_f32_32x32x16_bf16 v[232:247], a[52:55], a[4:7], v[232:247]
  ds_read_b128 a[0:3], v250 offset:26112
  v_exp_f32 v50, v50
  v_exp_f32 v51, v51
  v_cvt_pk_bf16_f32 v114, v4, v5
  v_mfma_f32_32x32x16_bf16 v[232:247], a[56:59], a[8:11], v[232:247]
  ds_read_b128 a[4:7], v250 offset:27136
  v_exp_f32 v52, v52
  v_exp_f32 v53, v53
  v_cvt_pk_bf16_f32 v115, v6, v7
  v_mfma_f32_32x32x16_bf16 v[232:247], a[60:63], a[12:15], v[232:247]
  ds_read_b128 a[8:11], v250 offset:28160
  v_exp_f32 v54, v54
  v_exp_f32 v55, v55
  v_accvgpr_write_b32 a168, v112
  v_mfma_f32_32x32x16_bf16 v[232:247], a[64:67], a[16:19], v[232:247]
  ds_read_b128 a[12:15], v250 offset:29184
  v_exp_f32 v56, v56
  v_exp_f32 v57, v57
  v_accvgpr_write_b32 a169, v113
  v_mfma_f32_32x32x16_bf16 v[232:247], a[68:71], a[20:23], v[232:247]
  ds_read_b128 a[16:19], v250 offset:30208
  v_exp_f32 v58, v58
  v_exp_f32 v59, v59
  v_accvgpr_write_b32 a170, v114
  v_mfma_f32_32x32x16_bf16 v[232:247], a[72:75], a[24:27], v[232:247]
  ds_read_b128 a[20:23], v250 offset:31232
  v_exp_f32 v60, v60
  v_exp_f32 v61, v61
  v_accvgpr_write_b32 a171, v115
  v_mfma_f32_32x32x16_bf16 v[232:247], a[76:79], a[28:31], v[232:247]
  ds_read_b128 a[24:27], v250 offset:32256
  v_exp_f32 v62, v62
  v_exp_f32 v63, v63
  v_cvt_pk_bf16_f32 v116, v8, v9
  v_mfma_f32_32x32x16_bf16 v[232:247], a[80:83], a[32:35], v[232:247]
  ds_read_b128 a[28:31], v250 offset:33280
  v_rcp_f32 v64, v64
  v_rcp_f32 v65, v65
  v_cvt_pk_bf16_f32 v117, v10, v11
  v_mfma_f32_32x32x16_bf16 v[232:247], a[84:87], a[36:39], v[232:247]
  ds_read_b128 a[32:35], v250 offset:34304
  v_rcp_f32 v66, v66
  v_rcp_f32 v67, v67
  v_cvt_pk_bf16_f32 v118, v12, v13
  v_mfma_f32_32x32x16_bf16 v[232:247], a[88:91], a[40:43], v[232:247]
  ds_read_b128 a[36:39], v250 offset:35328
  v_rcp_f32 v68, v68
  v_rcp_f32 v69, v69
  v_cvt_pk_bf16_f32 v119, v14, v15
  v_mfma_f32_32x32x16_bf16 v[232:247], a[92:95], a[44:47], v[232:247]
  ds_read_b128 a[40:43], v250 offset:36352
  ds_read_b128 a[44:47], v250 offset:37376
  v_rcp_f32 v70, v70
  v_rcp_f32 v71, v71
  v_accvgpr_write_b32 a172, v116
  v_accvgpr_write_b32 a173, v117
  v_accvgpr_write_b32 a174, v118
  v_accvgpr_write_b32 a175, v119
  v_pk_fma_f32 v[48:49], v[48:49], s[60:61], s[60:61] clamp
  v_pk_fma_f32 v[50:51], v[50:51], s[60:61], s[60:61] clamp
  v_pk_fma_f32 v[52:53], v[52:53], s[60:61], s[60:61] clamp
  v_pk_fma_f32 v[54:55], v[54:55], s[60:61], s[60:61] clamp
  v_pk_fma_f32 v[56:57], v[56:57], s[60:61], s[60:61] clamp
  v_pk_fma_f32 v[58:59], v[58:59], s[60:61], s[60:61] clamp
  v_pk_fma_f32 v[60:61], v[60:61], s[60:61], s[60:61] clamp
  v_pk_fma_f32 v[62:63], v[62:63], s[60:61], s[60:61] clamp
  v_pk_mul_f32 v[16:17], v[16:17], v[64:65]
  v_pk_mul_f32 v[18:19], v[18:19], v[66:67]
  v_pk_mul_f32 v[20:21], v[20:21], v[68:69]
  v_pk_mul_f32 v[22:23], v[22:23], v[70:71]
  v_pk_mul_f32 v[24:25], v[24:25], v[64:65]
  v_pk_mul_f32 v[26:27], v[26:27], v[66:67]
  v_pk_mul_f32 v[28:29], v[28:29], v[68:69]
  v_pk_mul_f32 v[30:31], v[30:31], v[70:71]
  v_pk_fma_f32 v[96:97], v[16:17], v[16:17], v[96:97]
  v_pk_fma_f32 v[98:99], v[18:19], v[18:19], v[98:99]
  v_pk_fma_f32 v[100:101], v[20:21], v[20:21], v[100:101]
  v_pk_fma_f32 v[102:103], v[22:23], v[22:23], v[102:103]
  v_pk_fma_f32 v[104:105], v[24:25], v[24:25], v[104:105]
  v_pk_fma_f32 v[106:107], v[26:27], v[26:27], v[106:107]
  v_pk_fma_f32 v[108:109], v[28:29], v[28:29], v[108:109]
  v_pk_fma_f32 v[110:111], v[30:31], v[30:31], v[110:111]
  v_pk_fma_f32 v[64:65], v[232:233], v[232:233], s[62:63]
  v_pk_fma_f32 v[66:67], v[234:235], v[234:235], s[62:63]
  v_pk_fma_f32 v[68:69], v[236:237], v[236:237], s[62:63]
  v_pk_fma_f32 v[70:71], v[238:239], v[238:239], s[62:63]
  v_pk_fma_f32 v[72:73], v[240:241], v[240:241], s[62:63]
  v_pk_fma_f32 v[74:75], v[242:243], v[242:243], s[62:63]
  v_pk_fma_f32 v[76:77], v[244:245], v[244:245], s[62:63]
  v_pk_fma_f32 v[78:79], v[246:247], v[246:247], s[62:63]
  v_pk_mul_f32 v[64:65], v[232:233], v[64:65] neg_lo:[1,0] neg_hi:[1,0]
  v_pk_mul_f32 v[66:67], v[234:235], v[66:67] neg_lo:[1,0] neg_hi:[1,0]
  v_pk_mul_f32 v[68:69], v[236:237], v[68:69] neg_lo:[1,0] neg_hi:[1,0]
  v_pk_mul_f32 v[70:71], v[238:239], v[70:71] neg_lo:[1,0] neg_hi:[1,0]
  v_pk_mul_f32 v[72:73], v[240:241], v[72:73] neg_lo:[1,0] neg_hi:[1,0]
  v_pk_mul_f32 v[74:75], v[242:243], v[74:75] neg_lo:[1,0] neg_hi:[1,0]
  v_pk_mul_f32 v[76:77], v[244:245], v[76:77] neg_lo:[1,0] neg_hi:[1,0]
  v_pk_mul_f32 v[78:79], v[246:247], v[78:79] neg_lo:[1,0] neg_hi:[1,0]
  v_pk_mul_f32 v[32:33], v[32:33], v[56:57]
  v_pk_mul_f32 v[34:35], v[34:35], v[58:59]
  v_pk_mul_f32 v[36:37], v[36:37], v[60:61]
  v_pk_mul_f32 v[38:39], v[38:39], v[62:63]
  v_pk_mul_f32 v[40:41], v[40:41], v[48:49]
  v_pk_mul_f32 v[42:43], v[42:43], v[50:51]
  v_pk_mul_f32 v[44:45], v[44:45], v[52:53]
  v_pk_mul_f32 v[46:47], v[46:47], v[54:55]
  v_pk_mul_f32 v[48:49], v[48:49], v[56:57]
  v_pk_mul_f32 v[50:51], v[50:51], v[58:59]
  v_pk_mul_f32 v[52:53], v[52:53], v[60:61]
  v_pk_mul_f32 v[54:55], v[54:55], v[62:63]
  s_waitcnt lgkmcnt(0)
  v_mfma_f32_32x32x16_bf16 v[0:15], a[96:99], a[0:3], 0
  v_exp_f32 v64, v64
  v_exp_f32 v65, v65
  v_cvt_pk_bf16_f32 v112, v16, v17
  v_cvt_pk_bf16_f32 v113, v18, v19
  v_mfma_f32_32x32x16_bf16 v[0:15], a[100:103], a[4:7], v[0:15]
  v_exp_f32 v66, v66
  v_exp_f32 v67, v67
  v_cvt_pk_bf16_f32 v114, v20, v21
  v_cvt_pk_bf16_f32 v115, v22, v23
  v_mfma_f32_32x32x16_bf16 v[0:15], a[104:107], a[8:11], v[0:15]
  v_exp_f32 v68, v68
  v_exp_f32 v69, v69
  v_cvt_pk_bf16_f32 v116, v24, v25
  v_cvt_pk_bf16_f32 v117, v26, v27
  v_mfma_f32_32x32x16_bf16 v[0:15], a[108:111], a[12:15], v[0:15]
  buffer_load_dwordx4 v[200:203], v248, s[20:23], s48 offen offset:0 sc1
  v_exp_f32 v70, v70
  v_exp_f32 v71, v71
  v_cvt_pk_bf16_f32 v118, v28, v29
  v_mfma_f32_32x32x16_bf16 v[0:15], a[112:115], a[16:19], v[0:15]
  v_exp_f32 v72, v72
  v_exp_f32 v73, v73
  v_cvt_pk_bf16_f32 v119, v30, v31
  v_fma_f32 v64, v64, s60, s60 clamp
  v_mfma_f32_32x32x16_bf16 v[0:15], a[116:119], a[20:23], v[0:15]
  ds_write_b128 v252, v[112:115] offset:8192
  v_fma_f32 v65, v65, s60, s60 clamp
  v_mfma_f32_32x32x16_bf16 v[0:15], a[120:123], a[24:27], v[0:15]
  v_exp_f32 v74, v74
  v_exp_f32 v75, v75
  v_exp_f32 v76, v76
  v_mfma_f32_32x32x16_bf16 v[0:15], a[124:127], a[28:31], v[0:15]
  buffer_load_dwordx4 v[204:207], v248, s[20:23], s48 offen offset:1024 sc1
  v_exp_f32 v77, v77
  v_exp_f32 v78, v78
  v_fma_f32 v66, v66, s60, s60 clamp
  v_mfma_f32_32x32x16_bf16 v[0:15], a[128:131], a[32:35], v[0:15]
  buffer_load_dwordx4 v[208:211], v248, s[20:23], s48 offen offset:2048 sc1
  v_exp_f32 v79, v79
  v_rcp_f32 v48, v48
  v_fma_f32 v67, v67, s60, s60 clamp
  v_mfma_f32_32x32x16_bf16 v[0:15], a[132:135], a[36:39], v[0:15]
  v_rcp_f32 v49, v49
  v_rcp_f32 v50, v50
  v_rcp_f32 v51, v51
  v_mfma_f32_32x32x16_bf16 v[0:15], a[136:139], a[40:43], v[0:15]
  buffer_load_dwordx4 v[212:215], v248, s[20:23], s48 offen offset:3072 sc1
  v_rcp_f32 v52, v52
  v_rcp_f32 v53, v53
  v_fma_f32 v68, v68, s60, s60 clamp
  v_mfma_f32_32x32x16_bf16 v[0:15], a[140:143], a[44:47], v[0:15]
  ds_write_b128 v252, v[116:119] offset:9216
  v_rcp_f32 v54, v54
  v_rcp_f32_e64 v55, v55
  v_fma_f32 v69, v69, s60, s60 clamp
  v_pk_fma_f32 v[70:71], v[70:71], s[60:61], s[60:61] clamp
  v_pk_fma_f32 v[72:73], v[72:73], s[60:61], s[60:61] clamp
  v_pk_fma_f32 v[74:75], v[74:75], s[60:61], s[60:61] clamp
  v_pk_fma_f32 v[76:77], v[76:77], s[60:61], s[60:61] clamp
  v_pk_fma_f32 v[78:79], v[78:79], s[60:61], s[60:61] clamp
  v_pk_mul_f32 v[32:33], v[32:33], v[48:49]
  v_pk_mul_f32 v[34:35], v[34:35], v[50:51]
  v_pk_mul_f32 v[36:37], v[36:37], v[52:53]
  v_pk_mul_f32 v[38:39], v[38:39], v[54:55]
  v_pk_mul_f32 v[40:41], v[40:41], v[48:49]
  v_pk_mul_f32 v[42:43], v[42:43], v[50:51]
  v_pk_mul_f32 v[44:45], v[44:45], v[52:53]
  v_pk_mul_f32 v[46:47], v[46:47], v[54:55]
  v_pk_fma_f32 v[80:81], v[32:33], v[32:33], v[80:81]
  v_pk_fma_f32 v[82:83], v[34:35], v[34:35], v[82:83]
  v_pk_fma_f32 v[84:85], v[36:37], v[36:37], v[84:85]
  v_pk_fma_f32 v[86:87], v[38:39], v[38:39], v[86:87]
  v_pk_fma_f32 v[88:89], v[40:41], v[40:41], v[88:89]
  v_pk_fma_f32 v[90:91], v[42:43], v[42:43], v[90:91]
  v_pk_fma_f32 v[92:93], v[44:45], v[44:45], v[92:93]
  v_pk_fma_f32 v[94:95], v[46:47], v[46:47], v[94:95]
  v_pk_fma_f32 v[48:49], v[0:1], v[0:1], s[62:63]
  v_pk_fma_f32 v[50:51], v[2:3], v[2:3], s[62:63]
  v_pk_fma_f32 v[52:53], v[4:5], v[4:5], s[62:63]
  v_pk_fma_f32 v[54:55], v[6:7], v[6:7], s[62:63]
  v_pk_fma_f32 v[56:57], v[8:9], v[8:9], s[62:63]
  v_pk_fma_f32 v[58:59], v[10:11], v[10:11], s[62:63]
  v_pk_fma_f32 v[60:61], v[12:13], v[12:13], s[62:63]
  v_pk_fma_f32 v[62:63], v[14:15], v[14:15], s[62:63]
  v_pk_mul_f32 v[48:49], v[0:1], v[48:49] neg_lo:[1,0] neg_hi:[1,0]
  v_pk_mul_f32 v[50:51], v[2:3], v[50:51] neg_lo:[1,0] neg_hi:[1,0]
  v_pk_mul_f32 v[52:53], v[4:5], v[52:53] neg_lo:[1,0] neg_hi:[1,0]
  v_pk_mul_f32 v[54:55], v[6:7], v[54:55] neg_lo:[1,0] neg_hi:[1,0]
  v_pk_mul_f32 v[56:57], v[8:9], v[56:57] neg_lo:[1,0] neg_hi:[1,0]
  v_pk_mul_f32 v[58:59], v[10:11], v[58:59] neg_lo:[1,0] neg_hi:[1,0]
  v_pk_mul_f32 v[60:61], v[12:13], v[60:61] neg_lo:[1,0] neg_hi:[1,0]
  v_pk_mul_f32 v[62:63], v[14:15], v[62:63] neg_lo:[1,0] neg_hi:[1,0]
  v_pk_mul_f32 v[232:233], v[232:233], v[72:73]
  v_pk_mul_f32 v[234:235], v[234:235], v[74:75]
  v_pk_mul_f32 v[236:237], v[236:237], v[76:77]
  v_pk_mul_f32 v[238:239], v[238:239], v[78:79]
  v_pk_mul_f32 v[240:241], v[240:241], v[64:65]
  v_pk_mul_f32 v[242:243], v[242:243], v[66:67]
  v_pk_mul_f32 v[244:245], v[244:245], v[68:69]
  v_pk_mul_f32 v[246:247], v[246:247], v[70:71]
  v_pk_mul_f32 v[64:65], v[64:65], v[72:73]
  v_pk_mul_f32 v[66:67], v[66:67], v[74:75]
  v_pk_mul_f32 v[68:69], v[68:69], v[76:77]
  v_pk_mul_f32 v[70:71], v[70:71], v[78:79]
  v_mfma_f32_32x32x16_bf16 v[16:31], a[48:51], a[0:3], 0
  v_exp_f32 v48, v48
  v_exp_f32 v49, v49
  v_cvt_pk_bf16_f32 v112, v32, v33
  v_cvt_pk_bf16_f32 v113, v34, v35
  v_mfma_f32_32x32x16_bf16 v[16:31], a[52:55], a[4:7], v[16:31]
  ds_read_b128 a[0:3], v249 offset:0
  v_exp_f32 v50, v50
  v_exp_f32 v51, v51
  v_cvt_pk_bf16_f32 v114, v36, v37
  v_mfma_f32_32x32x16_bf16 v[16:31], a[56:59], a[8:11], v[16:31]
  ds_read_b128 a[4:7], v249 offset:1024
  v_exp_f32 v52, v52
  v_exp_f32 v53, v53
  v_cvt_pk_bf16_f32 v115, v38, v39
  v_mfma_f32_32x32x16_bf16 v[16:31], a[60:63], a[12:15], v[16:31]
  ds_read_b128 a[8:11], v249 offset:2048
  v_exp_f32 v54, v54
  v_exp_f32 v55, v55
  v_accvgpr_write_b32 a176, v112
  v_mfma_f32_32x32x16_bf16 v[16:31], a[64:67], a[16:19], v[16:31]
  ds_read_b128 a[12:15], v249 offset:3072
  v_exp_f32 v56, v56
  v_exp_f32 v57, v57
  v_accvgpr_write_b32 a177, v113
  v_mfma_f32_32x32x16_bf16 v[16:31], a[68:71], a[20:23], v[16:31]
  ds_read_b128 a[16:19], v249 offset:4096
  v_exp_f32 v58, v58
  v_exp_f32 v59, v59
  v_accvgpr_write_b32 a178, v114
  v_mfma_f32_32x32x16_bf16 v[16:31], a[72:75], a[24:27], v[16:31]
  ds_read_b128 a[20:23], v249 offset:5120
  v_exp_f32 v60, v60
  v_exp_f32 v61, v61
  v_accvgpr_write_b32 a179, v115
  v_mfma_f32_32x32x16_bf16 v[16:31], a[76:79], a[28:31], v[16:31]
  ds_read_b128 a[24:27], v249 offset:6144
  v_exp_f32 v62, v62
  v_exp_f32 v63, v63
  v_cvt_pk_bf16_f32 v116, v40, v41
  v_mfma_f32_32x32x16_bf16 v[16:31], a[80:83], a[32:35], v[16:31]
  ds_read_b128 a[28:31], v249 offset:7168
  v_rcp_f32 v64, v64
  v_rcp_f32 v65, v65
  v_cvt_pk_bf16_f32 v117, v42, v43
  v_mfma_f32_32x32x16_bf16 v[16:31], a[84:87], a[36:39], v[16:31]
  ds_read_b128 a[32:35], v249 offset:8192
  v_rcp_f32 v66, v66
  v_rcp_f32 v67, v67
  v_cvt_pk_bf16_f32 v118, v44, v45
  v_mfma_f32_32x32x16_bf16 v[16:31], a[88:91], a[40:43], v[16:31]
  ds_read_b128 a[36:39], v249 offset:9216
  v_rcp_f32 v68, v68
  v_rcp_f32 v69, v69
  v_cvt_pk_bf16_f32 v119, v46, v47
  v_mfma_f32_32x32x16_bf16 v[16:31], a[92:95], a[44:47], v[16:31]
  ds_read_b128 a[40:43], v249 offset:10240
  ds_read_b128 a[44:47], v249 offset:11264
  v_rcp_f32 v70, v70
  v_rcp_f32 v71, v71
  v_accvgpr_write_b32 a180, v116
  v_accvgpr_write_b32 a181, v117
  v_accvgpr_write_b32 a182, v118
  v_accvgpr_write_b32 a183, v119
  v_pk_fma_f32 v[48:49], v[48:49], s[60:61], s[60:61] clamp
  v_pk_fma_f32 v[50:51], v[50:51], s[60:61], s[60:61] clamp
  v_pk_fma_f32 v[52:53], v[52:53], s[60:61], s[60:61] clamp
  v_pk_fma_f32 v[54:55], v[54:55], s[60:61], s[60:61] clamp
  v_pk_fma_f32 v[56:57], v[56:57], s[60:61], s[60:61] clamp
  v_pk_fma_f32 v[58:59], v[58:59], s[60:61], s[60:61] clamp
  v_pk_fma_f32 v[60:61], v[60:61], s[60:61], s[60:61] clamp
  v_pk_fma_f32 v[62:63], v[62:63], s[60:61], s[60:61] clamp
  v_pk_mul_f32 v[232:233], v[232:233], v[64:65]
  v_pk_mul_f32 v[234:235], v[234:235], v[66:67]
  v_pk_mul_f32 v[236:237], v[236:237], v[68:69]
  v_pk_mul_f32 v[238:239], v[238:239], v[70:71]
  v_pk_mul_f32 v[240:241], v[240:241], v[64:65]
  v_pk_mul_f32 v[242:243], v[242:243], v[66:67]
  v_pk_mul_f32 v[244:245], v[244:245], v[68:69]
  v_pk_mul_f32 v[246:247], v[246:247], v[70:71]
  v_pk_fma_f32 v[96:97], v[232:233], v[232:233], v[96:97]
  v_pk_fma_f32 v[98:99], v[234:235], v[234:235], v[98:99]
  v_pk_fma_f32 v[100:101], v[236:237], v[236:237], v[100:101]
  v_pk_fma_f32 v[102:103], v[238:239], v[238:239], v[102:103]
  v_pk_fma_f32 v[104:105], v[240:241], v[240:241], v[104:105]
  v_pk_fma_f32 v[106:107], v[242:243], v[242:243], v[106:107]
  v_pk_fma_f32 v[108:109], v[244:245], v[244:245], v[108:109]
  v_pk_fma_f32 v[110:111], v[246:247], v[246:247], v[110:111]
  v_pk_fma_f32 v[64:65], v[16:17], v[16:17], s[62:63]
  v_pk_fma_f32 v[66:67], v[18:19], v[18:19], s[62:63]
  v_pk_fma_f32 v[68:69], v[20:21], v[20:21], s[62:63]
  v_pk_fma_f32 v[70:71], v[22:23], v[22:23], s[62:63]
  v_pk_fma_f32 v[72:73], v[24:25], v[24:25], s[62:63]
  v_pk_fma_f32 v[74:75], v[26:27], v[26:27], s[62:63]
  v_pk_fma_f32 v[76:77], v[28:29], v[28:29], s[62:63]
  v_pk_fma_f32 v[78:79], v[30:31], v[30:31], s[62:63]
  v_pk_mul_f32 v[64:65], v[16:17], v[64:65] neg_lo:[1,0] neg_hi:[1,0]
  v_pk_mul_f32 v[66:67], v[18:19], v[66:67] neg_lo:[1,0] neg_hi:[1,0]
  v_pk_mul_f32 v[68:69], v[20:21], v[68:69] neg_lo:[1,0] neg_hi:[1,0]
  v_pk_mul_f32 v[70:71], v[22:23], v[70:71] neg_lo:[1,0] neg_hi:[1,0]
  v_pk_mul_f32 v[72:73], v[24:25], v[72:73] neg_lo:[1,0] neg_hi:[1,0]
  v_pk_mul_f32 v[74:75], v[26:27], v[74:75] neg_lo:[1,0] neg_hi:[1,0]
  v_pk_mul_f32 v[76:77], v[28:29], v[76:77] neg_lo:[1,0] neg_hi:[1,0]
  v_pk_mul_f32 v[78:79], v[30:31], v[78:79] neg_lo:[1,0] neg_hi:[1,0]
  v_pk_mul_f32 v[0:1], v[0:1], v[56:57]
  v_pk_mul_f32 v[2:3], v[2:3], v[58:59]
  v_pk_mul_f32 v[4:5], v[4:5], v[60:61]
  v_pk_mul_f32 v[6:7], v[6:7], v[62:63]
  v_pk_mul_f32 v[8:9], v[8:9], v[48:49]
  v_pk_mul_f32 v[10:11], v[10:11], v[50:51]
  v_pk_mul_f32 v[12:13], v[12:13], v[52:53]
  v_pk_mul_f32 v[14:15], v[14:15], v[54:55]
  v_pk_mul_f32 v[48:49], v[48:49], v[56:57]
  v_pk_mul_f32 v[50:51], v[50:51], v[58:59]
  v_pk_mul_f32 v[52:53], v[52:53], v[60:61]
  v_pk_mul_f32 v[54:55], v[54:55], v[62:63]
  s_waitcnt lgkmcnt(0)
  s_waitcnt vmcnt(12)
  v_mfma_f32_32x32x16_bf16 v[32:47], v[120:123], a[0:3], 0
  v_exp_f32 v64, v64
  v_exp_f32 v65, v65
  v_cvt_pk_bf16_f32 v112, v232, v233
  v_cvt_pk_bf16_f32 v113, v234, v235
  v_mfma_f32_32x32x16_bf16 v[32:47], v[124:127], a[4:7], v[32:47]
  v_exp_f32 v66, v66
  v_exp_f32 v67, v67
  v_cvt_pk_bf16_f32 v114, v236, v237
  v_cvt_pk_bf16_f32 v115, v238, v239
  v_mfma_f32_32x32x16_bf16 v[32:47], v[128:131], a[8:11], v[32:47]
  v_exp_f32 v68, v68
  v_exp_f32 v69, v69
  v_cvt_pk_bf16_f32 v116, v240, v241
  v_cvt_pk_bf16_f32 v117, v242, v243
  v_mfma_f32_32x32x16_bf16 v[32:47], v[132:135], a[12:15], v[32:47]
  buffer_load_dwordx4 a[48:51], v248, s[20:23], s49 offen offset:0 sc1
  v_exp_f32 v70, v70
  v_exp_f32 v71, v71
  v_cvt_pk_bf16_f32 v118, v244, v245
  v_mfma_f32_32x32x16_bf16 v[32:47], v[136:139], a[16:19], v[32:47]
  v_exp_f32 v72, v72
  v_exp_f32 v73, v73
  v_cvt_pk_bf16_f32 v119, v246, v247
  v_fma_f32 v64, v64, s60, s60 clamp
  v_mfma_f32_32x32x16_bf16 v[32:47], v[140:143], a[20:23], v[32:47]
  ds_write_b128 v252, v[112:115] offset:10240
  v_fma_f32 v65, v65, s60, s60 clamp
  v_mfma_f32_32x32x16_bf16 v[32:47], v[144:147], a[24:27], v[32:47]
  v_exp_f32 v74, v74
  v_exp_f32 v75, v75
  v_exp_f32 v76, v76
  v_mfma_f32_32x32x16_bf16 v[32:47], v[148:151], a[28:31], v[32:47]
  buffer_load_dwordx4 a[52:55], v248, s[20:23], s49 offen offset:1024 sc1
  v_exp_f32 v77, v77
  v_exp_f32 v78, v78
  v_fma_f32 v66, v66, s60, s60 clamp
  v_mfma_f32_32x32x16_bf16 v[32:47], v[152:155], a[32:35], v[32:47]
  buffer_load_dwordx4 a[56:59], v248, s[20:23], s49 offen offset:2048 sc1
  v_exp_f32 v79, v79
  v_rcp_f32 v48, v48
  v_fma_f32 v67, v67, s60, s60 clamp
  v_mfma_f32_32x32x16_bf16 v[32:47], v[156:159], a[36:39], v[32:47]
  v_rcp_f32 v49, v49
  v_rcp_f32 v50, v50
  v_rcp_f32 v51, v51
  v_mfma_f32_32x32x16_bf16 v[32:47], v[160:163], a[40:43], v[32:47]
  buffer_load_dwordx4 a[60:63], v248, s[20:23], s49 offen offset:3072 sc1
  v_rcp_f32 v52, v52
  v_rcp_f32 v53, v53
  v_fma_f32 v68, v68, s60, s60 clamp
  v_mfma_f32_32x32x16_bf16 v[32:47], v[164:167], a[44:47], v[32:47]
  ds_write_b128 v252, v[116:119] offset:11264
  v_rcp_f32 v54, v54
  v_rcp_f32 v55, v55
  v_fma_f32 v69, v69, s60, s60 clamp
  v_pk_fma_f32 v[70:71], v[70:71], s[60:61], s[60:61] clamp
  v_pk_fma_f32 v[72:73], v[72:73], s[60:61], s[60:61] clamp
  v_pk_fma_f32 v[74:75], v[74:75], s[60:61], s[60:61] clamp
  v_pk_fma_f32 v[76:77], v[76:77], s[60:61], s[60:61] clamp
  v_pk_fma_f32 v[78:79], v[78:79], s[60:61], s[60:61] clamp
  v_pk_mul_f32 v[0:1], v[0:1], v[48:49]
  v_pk_mul_f32 v[2:3], v[2:3], v[50:51]
  v_pk_mul_f32 v[4:5], v[4:5], v[52:53]
  v_pk_mul_f32 v[6:7], v[6:7], v[54:55]
  v_pk_mul_f32 v[8:9], v[8:9], v[48:49]
  v_pk_mul_f32 v[10:11], v[10:11], v[50:51]
  v_pk_mul_f32 v[12:13], v[12:13], v[52:53]
  v_pk_mul_f32 v[14:15], v[14:15], v[54:55]
  v_pk_fma_f32 v[80:81], v[0:1], v[0:1], v[80:81]
  v_pk_fma_f32 v[82:83], v[2:3], v[2:3], v[82:83]
  v_pk_fma_f32 v[84:85], v[4:5], v[4:5], v[84:85]
  v_pk_fma_f32 v[86:87], v[6:7], v[6:7], v[86:87]
  v_pk_fma_f32 v[88:89], v[8:9], v[8:9], v[88:89]
  v_pk_fma_f32 v[90:91], v[10:11], v[10:11], v[90:91]
  v_pk_fma_f32 v[92:93], v[12:13], v[12:13], v[92:93]
  v_pk_fma_f32 v[94:95], v[14:15], v[14:15], v[94:95]
  v_pk_fma_f32 v[48:49], v[32:33], v[32:33], s[62:63]
  v_pk_fma_f32 v[50:51], v[34:35], v[34:35], s[62:63]
  v_pk_fma_f32 v[52:53], v[36:37], v[36:37], s[62:63]
  v_pk_fma_f32 v[54:55], v[38:39], v[38:39], s[62:63]
  v_pk_fma_f32 v[56:57], v[40:41], v[40:41], s[62:63]
  v_pk_fma_f32 v[58:59], v[42:43], v[42:43], s[62:63]
  v_pk_fma_f32 v[60:61], v[44:45], v[44:45], s[62:63]
  v_pk_fma_f32 v[62:63], v[46:47], v[46:47], s[62:63]
  v_pk_mul_f32 v[48:49], v[32:33], v[48:49] neg_lo:[1,0] neg_hi:[1,0]
  v_pk_mul_f32 v[50:51], v[34:35], v[50:51] neg_lo:[1,0] neg_hi:[1,0]
  v_pk_mul_f32 v[52:53], v[36:37], v[52:53] neg_lo:[1,0] neg_hi:[1,0]
  v_pk_mul_f32 v[54:55], v[38:39], v[54:55] neg_lo:[1,0] neg_hi:[1,0]
  v_pk_mul_f32 v[56:57], v[40:41], v[56:57] neg_lo:[1,0] neg_hi:[1,0]
  v_pk_mul_f32 v[58:59], v[42:43], v[58:59] neg_lo:[1,0] neg_hi:[1,0]
  v_pk_mul_f32 v[60:61], v[44:45], v[60:61] neg_lo:[1,0] neg_hi:[1,0]
  v_pk_mul_f32 v[62:63], v[46:47], v[62:63] neg_lo:[1,0] neg_hi:[1,0]
  v_pk_mul_f32 v[16:17], v[16:17], v[72:73]
  v_pk_mul_f32 v[18:19], v[18:19], v[74:75]
  v_pk_mul_f32 v[20:21], v[20:21], v[76:77]
  v_pk_mul_f32 v[22:23], v[22:23], v[78:79]
  v_pk_mul_f32 v[24:25], v[24:25], v[64:65]
  v_pk_mul_f32 v[26:27], v[26:27], v[66:67]
  v_pk_mul_f32 v[28:29], v[28:29], v[68:69]
  v_pk_mul_f32 v[30:31], v[30:31], v[70:71]
  v_pk_mul_f32 v[64:65], v[64:65], v[72:73]
  v_pk_mul_f32 v[66:67], v[66:67], v[74:75]
  v_pk_mul_f32 v[68:69], v[68:69], v[76:77]
  v_pk_mul_f32 v[70:71], v[70:71], v[78:79]
  v_permlane16_swap_b32 v80, v88
  v_permlane16_swap_b32 v81, v89
  v_permlane16_swap_b32 v82, v90
  v_permlane16_swap_b32 v83, v91
  v_permlane16_swap_b32 v84, v92
  v_permlane16_swap_b32 v85, v93
  v_permlane16_swap_b32 v86, v94
  v_permlane16_swap_b32 v87, v95
  v_pk_add_f32 v[80:81], v[80:81], v[88:89]
  v_pk_add_f32 v[82:83], v[82:83], v[90:91]
  v_pk_add_f32 v[84:85], v[84:85], v[92:93]
  v_pk_add_f32 v[86:87], v[86:87], v[94:95]
  s_waitcnt vmcnt(4)
  v_mfma_f32_32x32x16_bf16 v[232:247], v[168:171], a[0:3], 0
  v_exp_f32 v48, v48
  v_exp_f32 v49, v49
  v_cvt_pk_bf16_f32 v112, v0, v1
  v_cvt_pk_bf16_f32 v113, v2, v3
  v_add_f32_dpp v80, v80, v80 row_ror:8 row_mask:0xf bank_mask:0x3
  v_mfma_f32_32x32x16_bf16 v[232:247], v[172:175], a[4:7], v[232:247]
  ds_read_b128 a[0:3], v249 offset:13056
  v_exp_f32 v50, v50
  v_exp_f32 v51, v51
  v_cvt_pk_bf16_f32 v114, v4, v5
  v_add_f32_dpp v81, v81, v81 row_ror:8 row_mask:0xf bank_mask:0x3
  v_mfma_f32_32x32x16_bf16 v[232:247], v[176:179], a[8:11], v[232:247]
  ds_read_b128 a[4:7], v249 offset:14080
  v_exp_f32 v52, v52
  v_exp_f32 v53, v53
  v_cvt_pk_bf16_f32 v115, v6, v7
  v_add_f32_dpp v82, v82, v82 row_ror:8 row_mask:0xf bank_mask:0x3
  v_mfma_f32_32x32x16_bf16 v[232:247], v[180:183], a[12:15], v[232:247]
  ds_read_b128 a[8:11], v249 offset:15104
  v_exp_f32 v54, v54
  v_exp_f32 v55, v55
  v_accvgpr_write_b32 a184, v112
  v_add_f32_dpp v83, v83, v83 row_ror:8 row_mask:0xf bank_mask:0x3
  v_mfma_f32_32x32x16_bf16 v[232:247], v[184:187], a[16:19], v[232:247]
  ds_read_b128 a[12:15], v249 offset:16128
  v_exp_f32 v56, v56
  v_exp_f32 v57, v57
  v_accvgpr_write_b32 a185, v113
  v_add_f32_dpp v80, v84, v84 row_ror:8 row_mask:0xf bank_mask:0xc
  v_mfma_f32_32x32x16_bf16 v[232:247], v[188:191], a[20:23], v[232:247]
  ds_read_b128 a[16:19], v249 offset:17152
  v_exp_f32 v58, v58
  v_exp_f32 v59, v59
  v_accvgpr_write_b32 a186, v114
  v_add_f32_dpp v81, v85, v85 row_ror:8 row_mask:0xf bank_mask:0xc
  v_mfma_f32_32x32x16_bf16 v[232:247], v[192:195], a[24:27], v[232:247]
  ds_read_b128 a[20:23], v249 offset:18176
  v_exp_f32 v60, v60
  v_exp_f32 v61, v61
  v_accvgpr_write_b32 a187, v115
  v_add_f32_dpp v82, v86, v86 row_ror:8 row_mask:0xf bank_mask:0xc
  v_mfma_f32_32x32x16_bf16 v[232:247], v[196:199], a[28:31], v[232:247]
  ds_read_b128 a[24:27], v249 offset:19200
  v_exp_f32 v62, v62
  v_exp_f32 v63, v63
  v_cvt_pk_bf16_f32 v116, v8, v9
  v_add_f32_dpp v83, v87, v87 row_ror:8 row_mask:0xf bank_mask:0xc
  v_mfma_f32_32x32x16_bf16 v[232:247], v[200:203], a[32:35], v[232:247]
  ds_read_b128 a[28:31], v249 offset:20224
  v_rcp_f32 v64, v64
  v_rcp_f32 v65, v65
  v_cvt_pk_bf16_f32 v117, v10, v11
  v_add_f32_dpp v80, v80, v80 row_half_mirror row_mask:0xf bank_mask:0x5
  v_mfma_f32_32x32x16_bf16 v[232:247], v[204:207], a[36:39], v[232:247]
  ds_read_b128 a[32:35], v249 offset:21248
  v_rcp_f32 v66, v66
  v_rcp_f32 v67, v67
  v_cvt_pk_bf16_f32 v118, v12, v13
  v_add_f32_dpp v81, v81, v81 row_half_mirror row_mask:0xf bank_mask:0x5
  v_mfma_f32_32x32x16_bf16 v[232:247], v[208:211], a[40:43], v[232:247]
  ds_read_b128 a[36:39], v249 offset:22272
  v_rcp_f32 v68, v68
  v_rcp_f32 v69, v69
  v_cvt_pk_bf16_f32 v119, v14, v15
  v_add_f32_dpp v80, v82, v82 row_half_mirror row_mask:0xf bank_mask:0xa
  v_mfma_f32_32x32x16_bf16 v[232:247], v[212:215], a[44:47], v[232:247]
  ds_read_b128 a[40:43], v249 offset:23296
  ds_read_b128 a[44:47], v249 offset:24320
  v_rcp_f32 v70, v70
  v_rcp_f32_e64 v71, v71
  v_accvgpr_write_b32 a188, v116
  v_accvgpr_write_b32 a189, v117
  v_accvgpr_write_b32 a190, v118
  v_accvgpr_write_b32 a191, v119
  v_add_f32_dpp v81, v83, v83 row_half_mirror row_mask:0xf bank_mask:0xa
  v_pk_fma_f32 v[48:49], v[48:49], s[60:61], s[60:61] clamp
  v_pk_fma_f32 v[50:51], v[50:51], s[60:61], s[60:61] clamp
  v_pk_fma_f32 v[52:53], v[52:53], s[60:61], s[60:61] clamp
  v_pk_fma_f32 v[54:55], v[54:55], s[60:61], s[60:61] clamp
  v_pk_fma_f32 v[56:57], v[56:57], s[60:61], s[60:61] clamp
  v_pk_fma_f32 v[58:59], v[58:59], s[60:61], s[60:61] clamp
  v_pk_fma_f32 v[60:61], v[60:61], s[60:61], s[60:61] clamp
  v_pk_fma_f32 v[62:63], v[62:63], s[60:61], s[60:61] clamp
  v_pk_mul_f32 v[16:17], v[16:17], v[64:65]
  v_pk_mul_f32 v[18:19], v[18:19], v[66:67]
  v_pk_mul_f32 v[20:21], v[20:21], v[68:69]
  v_pk_mul_f32 v[22:23], v[22:23], v[70:71]
  v_pk_mul_f32 v[24:25], v[24:25], v[64:65]
  v_pk_mul_f32 v[26:27], v[26:27], v[66:67]
  v_pk_mul_f32 v[28:29], v[28:29], v[68:69]
  v_pk_mul_f32 v[30:31], v[30:31], v[70:71]
  v_pk_fma_f32 v[96:97], v[16:17], v[16:17], v[96:97]
  v_pk_fma_f32 v[98:99], v[18:19], v[18:19], v[98:99]
  v_pk_fma_f32 v[100:101], v[20:21], v[20:21], v[100:101]
  v_pk_fma_f32 v[102:103], v[22:23], v[22:23], v[102:103]
  v_pk_fma_f32 v[104:105], v[24:25], v[24:25], v[104:105]
  v_pk_fma_f32 v[106:107], v[26:27], v[26:27], v[106:107]
  v_pk_fma_f32 v[108:109], v[28:29], v[28:29], v[108:109]
  v_pk_fma_f32 v[110:111], v[30:31], v[30:31], v[110:111]
  v_pk_fma_f32 v[64:65], v[232:233], v[232:233], s[62:63]
  v_pk_fma_f32 v[66:67], v[234:235], v[234:235], s[62:63]
  v_pk_fma_f32 v[68:69], v[236:237], v[236:237], s[62:63]
  v_pk_fma_f32 v[70:71], v[238:239], v[238:239], s[62:63]
  v_pk_fma_f32 v[72:73], v[240:241], v[240:241], s[62:63]
  v_pk_fma_f32 v[74:75], v[242:243], v[242:243], s[62:63]
  v_pk_fma_f32 v[76:77], v[244:245], v[244:245], s[62:63]
  v_pk_fma_f32 v[78:79], v[246:247], v[246:247], s[62:63]
  v_pk_mul_f32 v[64:65], v[232:233], v[64:65] neg_lo:[1,0] neg_hi:[1,0]
  v_pk_mul_f32 v[66:67], v[234:235], v[66:67] neg_lo:[1,0] neg_hi:[1,0]
  v_pk_mul_f32 v[68:69], v[236:237], v[68:69] neg_lo:[1,0] neg_hi:[1,0]
  v_pk_mul_f32 v[70:71], v[238:239], v[70:71] neg_lo:[1,0] neg_hi:[1,0]
  v_pk_mul_f32 v[72:73], v[240:241], v[72:73] neg_lo:[1,0] neg_hi:[1,0]
  v_pk_mul_f32 v[74:75], v[242:243], v[74:75] neg_lo:[1,0] neg_hi:[1,0]
  v_pk_mul_f32 v[76:77], v[244:245], v[76:77] neg_lo:[1,0] neg_hi:[1,0]
  v_pk_mul_f32 v[78:79], v[246:247], v[78:79] neg_lo:[1,0] neg_hi:[1,0]
  v_pk_mul_f32 v[32:33], v[32:33], v[56:57]
  v_pk_mul_f32 v[34:35], v[34:35], v[58:59]
  v_pk_mul_f32 v[36:37], v[36:37], v[60:61]
  v_pk_mul_f32 v[38:39], v[38:39], v[62:63]
  v_pk_mul_f32 v[40:41], v[40:41], v[48:49]
  v_pk_mul_f32 v[42:43], v[42:43], v[50:51]
  v_pk_mul_f32 v[44:45], v[44:45], v[52:53]
  v_pk_mul_f32 v[46:47], v[46:47], v[54:55]
  v_pk_mul_f32 v[48:49], v[48:49], v[56:57]
  v_pk_mul_f32 v[50:51], v[50:51], v[58:59]
  v_pk_mul_f32 v[52:53], v[52:53], v[60:61]
  v_pk_mul_f32 v[54:55], v[54:55], v[62:63]
  v_permlane16_swap_b32 v96, v104
  v_permlane16_swap_b32 v97, v105
  v_permlane16_swap_b32 v98, v106
  v_permlane16_swap_b32 v99, v107
  v_permlane16_swap_b32 v100, v108
  v_permlane16_swap_b32 v101, v109
  v_permlane16_swap_b32 v102, v110
  v_permlane16_swap_b32 v103, v111
  v_pk_add_f32 v[96:97], v[96:97], v[104:105]
  v_pk_add_f32 v[98:99], v[98:99], v[106:107]
  v_pk_add_f32 v[100:101], v[100:101], v[108:109]
  v_pk_add_f32 v[102:103], v[102:103], v[110:111]
  s_waitcnt lgkmcnt(0)
  v_mfma_f32_32x32x16_bf16 v[0:15], v[120:123], a[0:3], 0
  v_exp_f32 v64, v64
  v_exp_f32 v65, v65
  v_cvt_pk_bf16_f32 v112, v16, v17
  v_cvt_pk_bf16_f32 v113, v18, v19
  v_cndmask_b32 v82, v80, v81, s[6:7]
  v_mfma_f32_32x32x16_bf16 v[0:15], v[124:127], a[4:7], v[0:15]
  v_exp_f32 v66, v66
  v_exp_f32 v67, v67
  v_cvt_pk_bf16_f32 v114, v20, v21
  v_cvt_pk_bf16_f32 v115, v22, v23
  v_cndmask_b32 v83, v81, v80, s[6:7]
  v_mfma_f32_32x32x16_bf16 v[0:15], v[128:131], a[8:11], v[0:15]
  v_exp_f32 v68, v68
  v_exp_f32 v69, v69
  v_cvt_pk_bf16_f32 v116, v24, v25
  v_cvt_pk_bf16_f32 v117, v26, v27
  v_add_f32_dpp v82, v83, v82 quad_perm:[1,0,3,2] row_mask:0xf bank_mask:0xf
  v_mfma_f32_32x32x16_bf16 v[0:15], v[132:135], a[12:15], v[0:15]
  buffer_load_dwordx4 a[64:67], v248, s[20:23], s53 offen offset:0 sc1
  v_exp_f32 v70, v70
  v_exp_f32 v71, v71
  v_cvt_pk_bf16_f32 v118, v28, v29
  v_add_f32_dpp v84, v82, v82 quad_perm:[2,3,0,1] row_mask:0xf bank_mask:0xf
  v_mfma_f32_32x32x16_bf16 v[0:15], v[136:139], a[16:19], v[0:15]
  s_lshr_b32 s42, s2, 3
  s_lshl_b32 s42, s42, 2
  s_add_u32 s42, s42, s3
  s_mul_i32 s42, s42, 2048
  s_min_u32 s42, s42, 194560
  s_add_u32 s42, s42, 294912
  buffer_load_dwordx4 a[140:143], v248, s[20:23], s42 offen offset:0 sc1
  v_exp_f32 v72, v72
  v_exp_f32 v73, v73
  v_cndmask_b32 v84, v84, 1.0, s[64:65]
  v_mfma_f32_32x32x16_bf16 v[0:15], v[140:143], a[20:23], v[0:15]
  ds_write_b128 v252, v[112:115] offset:12288
  v_cvt_pk_bf16_f32 v119, v30, v31
  buffer_atomic_add_f32 v84, v251, s[20:23], s77 offen offset:256 sc1
  v_mfma_f32_32x32x16_bf16 v[0:15], v[144:147], a[24:27], v[0:15]
  v_exp_f32 v74, v74
  v_exp_f32 v75, v75
  v_exp_f32 v76, v76
  v_add_f32_dpp v96, v96, v96 row_ror:8 row_mask:0xf bank_mask:0x3
  v_mfma_f32_32x32x16_bf16 v[0:15], v[148:151], a[28:31], v[0:15]
  buffer_load_dwordx4 a[68:71], v248, s[20:23], s53 offen offset:1024 sc1
  v_exp_f32 v77, v77
  v_exp_f32 v78, v78
  v_add_f32_dpp v97, v97, v97 row_ror:8 row_mask:0xf bank_mask:0x3
  v_mfma_f32_32x32x16_bf16 v[0:15], v[152:155], a[32:35], v[0:15]
  buffer_load_dwordx4 a[72:75], v248, s[20:23], s53 offen offset:2048 sc1
  v_exp_f32 v79, v79
  v_rcp_f32 v48, v48
  v_add_f32_dpp v98, v98, v98 row_ror:8 row_mask:0xf bank_mask:0x3
  v_mfma_f32_32x32x16_bf16 v[0:15], v[156:159], a[36:39], v[0:15]
  v_rcp_f32 v49, v49
  v_rcp_f32 v50, v50
  v_rcp_f32 v51, v51
  v_add_f32_dpp v99, v99, v99 row_ror:8 row_mask:0xf bank_mask:0x3
  v_mfma_f32_32x32x16_bf16 v[0:15], v[160:163], a[40:43], v[0:15]
  buffer_load_dwordx4 a[76:79], v248, s[20:23], s53 offen offset:3072 sc1
  v_rcp_f32 v52, v52
  v_rcp_f32 v53, v53
  v_add_f32_dpp v96, v100, v100 row_ror:8 row_mask:0xf bank_mask:0xc
  v_mfma_f32_32x32x16_bf16 v[0:15], v[164:167], a[44:47], v[0:15]
  ds_write_b128 v252, v[116:119] offset:13312
  v_rcp_f32 v54, v54
  v_rcp_f32 v55, v55
  v_add_f32_dpp v97, v101, v101 row_ror:8 row_mask:0xf bank_mask:0xc
  v_pk_fma_f32 v[64:65], v[64:65], s[60:61], s[60:61] clamp
  v_pk_fma_f32 v[66:67], v[66:67], s[60:61], s[60:61] clamp
  v_pk_fma_f32 v[68:69], v[68:69], s[60:61], s[60:61] clamp
  v_pk_fma_f32 v[70:71], v[70:71], s[60:61], s[60:61] clamp
  v_pk_fma_f32 v[72:73], v[72:73], s[60:61], s[60:61] clamp
  v_pk_fma_f32 v[74:75], v[74:75], s[60:61], s[60:61] clamp
  v_pk_fma_f32 v[76:77], v[76:77], s[60:61], s[60:61] clamp
  v_pk_fma_f32 v[78:79], v[78:79], s[60:61], s[60:61] clamp
  v_pk_mul_f32 v[32:33], v[32:33], v[48:49]
  v_pk_mul_f32 v[34:35], v[34:35], v[50:51]
  v_pk_mul_f32 v[36:37], v[36:37], v[52:53]
  v_pk_mul_f32 v[38:39], v[38:39], v[54:55]
  v_pk_mul_f32 v[40:41], v[40:41], v[48:49]
  v_pk_mul_f32 v[42:43], v[42:43], v[50:51]
  v_pk_mul_f32 v[44:45], v[44:45], v[52:53]
  v_pk_mul_f32 v[46:47], v[46:47], v[54:55]
  v_pk_mul_f32 v[80:81], v[32:33], v[32:33]
  v_pk_mul_f32 v[82:83], v[34:35], v[34:35]
  v_pk_mul_f32 v[84:85], v[36:37], v[36:37]
  v_pk_mul_f32 v[86:87], v[38:39], v[38:39]
  v_pk_mul_f32 v[88:89], v[40:41], v[40:41]
  v_pk_mul_f32 v[90:91], v[42:43], v[42:43]
  v_pk_mul_f32 v[92:93], v[44:45], v[44:45]
  v_pk_mul_f32 v[94:95], v[46:47], v[46:47]
  v_pk_fma_f32 v[48:49], v[0:1], v[0:1], s[62:63]
  v_pk_fma_f32 v[50:51], v[2:3], v[2:3], s[62:63]
  v_pk_fma_f32 v[52:53], v[4:5], v[4:5], s[62:63]
  v_pk_fma_f32 v[54:55], v[6:7], v[6:7], s[62:63]
  v_pk_fma_f32 v[56:57], v[8:9], v[8:9], s[62:63]
  v_pk_fma_f32 v[58:59], v[10:11], v[10:11], s[62:63]
  v_pk_fma_f32 v[60:61], v[12:13], v[12:13], s[62:63]
  v_pk_fma_f32 v[62:63], v[14:15], v[14:15], s[62:63]
  v_pk_mul_f32 v[48:49], v[0:1], v[48:49] neg_lo:[1,0] neg_hi:[1,0]
  v_pk_mul_f32 v[50:51], v[2:3], v[50:51] neg_lo:[1,0] neg_hi:[1,0]
  v_pk_mul_f32 v[52:53], v[4:5], v[52:53] neg_lo:[1,0] neg_hi:[1,0]
  v_pk_mul_f32 v[54:55], v[6:7], v[54:55] neg_lo:[1,0] neg_hi:[1,0]
  v_pk_mul_f32 v[56:57], v[8:9], v[56:57] neg_lo:[1,0] neg_hi:[1,0]
  v_pk_mul_f32 v[58:59], v[10:11], v[58:59] neg_lo:[1,0] neg_hi:[1,0]
  v_pk_mul_f32 v[60:61], v[12:13], v[60:61] neg_lo:[1,0] neg_hi:[1,0]
  v_pk_mul_f32 v[62:63], v[14:15], v[62:63] neg_lo:[1,0] neg_hi:[1,0]
  v_pk_mul_f32 v[232:233], v[232:233], v[72:73]
  v_pk_mul_f32 v[234:235], v[234:235], v[74:75]
  v_pk_mul_f32 v[236:237], v[236:237], v[76:77]
  v_pk_mul_f32 v[238:239], v[238:239], v[78:79]
  v_pk_mul_f32 v[240:241], v[240:241], v[64:65]
  v_pk_mul_f32 v[242:243], v[242:243], v[66:67]
  v_pk_mul_f32 v[244:245], v[244:245], v[68:69]
  v_pk_mul_f32 v[246:247], v[246:247], v[70:71]
  v_pk_mul_f32 v[64:65], v[64:65], v[72:73]
  v_pk_mul_f32 v[66:67], v[66:67], v[74:75]
  v_pk_mul_f32 v[68:69], v[68:69], v[76:77]
  v_pk_mul_f32 v[70:71], v[70:71], v[78:79]
  v_mfma_f32_32x32x16_bf16 v[16:31], v[168:171], a[0:3], 0
  v_exp_f32 v48, v48
  v_exp_f32 v49, v49
  v_cvt_pk_bf16_f32 v112, v32, v33
  v_cvt_pk_bf16_f32 v113, v34, v35
  v_add_f32_dpp v98, v102, v102 row_ror:8 row_mask:0xf bank_mask:0xc
  v_mfma_f32_32x32x16_bf16 v[16:31], v[172:175], a[4:7], v[16:31]
  ds_read_b128 a[0:3], v249 offset:26112
  v_exp_f32 v50, v50
  v_exp_f32 v51, v51
  v_cvt_pk_bf16_f32 v114, v36, v37
  v_add_f32_dpp v99, v103, v103 row_ror:8 row_mask:0xf bank_mask:0xc
  v_mfma_f32_32x32x16_bf16 v[16:31], v[176:179], a[8:11], v[16:31]
  ds_read_b128 a[4:7], v249 offset:27136
  v_exp_f32 v52, v52
  v_exp_f32 v53, v53
  v_cvt_pk_bf16_f32 v115, v38, v39
  v_add_f32_dpp v96, v96, v96 row_half_mirror row_mask:0xf bank_mask:0x5
  v_mfma_f32_32x32x16_bf16 v[16:31], v[180:183], a[12:15], v[16:31]
  ds_read_b128 a[8:11], v249 offset:28160
  v_exp_f32 v54, v54
  v_exp_f32 v55, v55
  v_accvgpr_write_b32 a192, v112
  v_add_f32_dpp v97, v97, v97 row_half_mirror row_mask:0xf bank_mask:0x5
  v_mfma_f32_32x32x16_bf16 v[16:31], v[184:187], a[16:19], v[16:31]
  ds_read_b128 a[12:15], v249 offset:29184
  v_exp_f32 v56, v56
  v_exp_f32 v57, v57
  v_accvgpr_write_b32 a193, v113
  v_add_f32_dpp v96, v98, v98 row_half_mirror row_mask:0xf bank_mask:0xa
  v_mfma_f32_32x32x16_bf16 v[16:31], v[188:191], a[20:23], v[16:31]
  ds_read_b128 a[16:19], v249 offset:30208
  v_exp_f32 v58, v58
  v_exp_f32 v59, v59
  v_accvgpr_write_b32 a194, v114
  v_add_f32_dpp v97, v99, v99 row_half_mirror row_mask:0xf bank_mask:0xa
  v_mfma_f32_32x32x16_bf16 v[16:31], v[192:195], a[24:27], v[16:31]
  ds_read_b128 a[20:23], v249 offset:31232
  v_exp_f32 v60, v60
  v_exp_f32 v61, v61
  v_accvgpr_write_b32 a195, v115
  v_cndmask_b32 v98, v96, v97, s[6:7]
  v_mfma_f32_32x32x16_bf16 v[16:31], v[196:199], a[28:31], v[16:31]
  ds_read_b128 a[24:27], v249 offset:32256
  v_exp_f32 v62, v62
  v_exp_f32 v63, v63
  v_cvt_pk_bf16_f32 v116, v40, v41
  v_cndmask_b32 v99, v97, v96, s[6:7]
  v_mfma_f32_32x32x16_bf16 v[16:31], v[200:203], a[32:35], v[16:31]
  ds_read_b128 a[28:31], v249 offset:33280
  v_rcp_f32 v64, v64
  v_rcp_f32 v65, v65
  v_cvt_pk_bf16_f32 v117, v42, v43
  v_add_f32_dpp v98, v99, v98 quad_perm:[1,0,3,2] row_mask:0xf bank_mask:0xf
  v_mfma_f32_32x32x16_bf16 v[16:31], v[204:207], a[36:39], v[16:31]
  ds_read_b128 a[32:35], v249 offset:34304
  v_rcp_f32 v66, v66
  v_rcp_f32 v67, v67
  v_cvt_pk_bf16_f32 v118, v44, v45
  v_add_f32_dpp v100, v98, v98 quad_perm:[2,3,0,1] row_mask:0xf bank_mask:0xf
  v_mfma_f32_32x32x16_bf16 v[16:31], v[208:211], a[40:43], v[16:31]
  ds_read_b128 a[36:39], v249 offset:35328
  v_rcp_f32 v68, v68
  v_rcp_f32 v69, v69
  v_cvt_pk_bf16_f32 v119, v46, v47
  v_cndmask_b32 v100, v100, 1.0, s[64:65]
  v_mfma_f32_32x32x16_bf16 v[16:31], v[212:215], a[44:47], v[16:31]
  ds_read_b128 a[40:43], v249 offset:36352
  ds_read_b128 a[44:47], v249 offset:37376
  v_rcp_f32 v70, v70
  v_rcp_f32 v71, v71
  v_accvgpr_write_b32 a196, v116
  v_accvgpr_write_b32 a197, v117
  v_accvgpr_write_b32 a198, v118
  v_accvgpr_write_b32 a199, v119
  buffer_atomic_add_f32 v100, v251, s[20:23], s77 offen offset:0 sc1
  v_pk_fma_f32 v[48:49], v[48:49], s[60:61], s[60:61] clamp
  v_pk_fma_f32 v[50:51], v[50:51], s[60:61], s[60:61] clamp
  v_pk_fma_f32 v[52:53], v[52:53], s[60:61], s[60:61] clamp
  v_pk_fma_f32 v[54:55], v[54:55], s[60:61], s[60:61] clamp
  v_pk_fma_f32 v[56:57], v[56:57], s[60:61], s[60:61] clamp
  v_pk_fma_f32 v[58:59], v[58:59], s[60:61], s[60:61] clamp
  v_pk_fma_f32 v[60:61], v[60:61], s[60:61], s[60:61] clamp
  v_pk_fma_f32 v[62:63], v[62:63], s[60:61], s[60:61] clamp
  v_pk_mul_f32 v[232:233], v[232:233], v[64:65]
  v_pk_mul_f32 v[234:235], v[234:235], v[66:67]
  v_pk_mul_f32 v[236:237], v[236:237], v[68:69]
  v_pk_mul_f32 v[238:239], v[238:239], v[70:71]
  v_pk_mul_f32 v[240:241], v[240:241], v[64:65]
  v_pk_mul_f32 v[242:243], v[242:243], v[66:67]
  v_pk_mul_f32 v[244:245], v[244:245], v[68:69]
  v_pk_mul_f32 v[246:247], v[246:247], v[70:71]
  v_pk_mul_f32 v[96:97], v[232:233], v[232:233]
  v_pk_mul_f32 v[98:99], v[234:235], v[234:235]
  v_pk_mul_f32 v[100:101], v[236:237], v[236:237]
  v_pk_mul_f32 v[102:103], v[238:239], v[238:239]
  v_pk_mul_f32 v[104:105], v[240:241], v[240:241]
  v_pk_mul_f32 v[106:107], v[242:243], v[242:243]
  v_pk_mul_f32 v[108:109], v[244:245], v[244:245]
  v_pk_mul_f32 v[110:111], v[246:247], v[246:247]
  v_pk_fma_f32 v[64:65], v[16:17], v[16:17], s[62:63]
  v_pk_fma_f32 v[66:67], v[18:19], v[18:19], s[62:63]
  v_pk_fma_f32 v[68:69], v[20:21], v[20:21], s[62:63]
  v_pk_fma_f32 v[70:71], v[22:23], v[22:23], s[62:63]
  v_pk_fma_f32 v[72:73], v[24:25], v[24:25], s[62:63]
  v_pk_fma_f32 v[74:75], v[26:27], v[26:27], s[62:63]
  v_pk_fma_f32 v[76:77], v[28:29], v[28:29], s[62:63]
  v_pk_fma_f32 v[78:79], v[30:31], v[30:31], s[62:63]
  v_pk_mul_f32 v[64:65], v[16:17], v[64:65] neg_lo:[1,0] neg_hi:[1,0]
  v_pk_mul_f32 v[66:67], v[18:19], v[66:67] neg_lo:[1,0] neg_hi:[1,0]
  v_pk_mul_f32 v[68:69], v[20:21], v[68:69] neg_lo:[1,0] neg_hi:[1,0]
  v_pk_mul_f32 v[70:71], v[22:23], v[70:71] neg_lo:[1,0] neg_hi:[1,0]
  v_pk_mul_f32 v[72:73], v[24:25], v[72:73] neg_lo:[1,0] neg_hi:[1,0]
  v_pk_mul_f32 v[74:75], v[26:27], v[74:75] neg_lo:[1,0] neg_hi:[1,0]
  v_pk_mul_f32 v[76:77], v[28:29], v[76:77] neg_lo:[1,0] neg_hi:[1,0]
  v_pk_mul_f32 v[78:79], v[30:31], v[78:79] neg_lo:[1,0] neg_hi:[1,0]
  v_pk_mul_f32 v[0:1], v[0:1], v[56:57]
  v_pk_mul_f32 v[2:3], v[2:3], v[58:59]
  v_pk_mul_f32 v[4:5], v[4:5], v[60:61]
  v_pk_mul_f32 v[6:7], v[6:7], v[62:63]
  v_pk_mul_f32 v[8:9], v[8:9], v[48:49]
  v_pk_mul_f32 v[10:11], v[10:11], v[50:51]
  v_pk_mul_f32 v[12:13], v[12:13], v[52:53]
  v_pk_mul_f32 v[14:15], v[14:15], v[54:55]
  v_pk_mul_f32 v[48:49], v[48:49], v[56:57]
  v_pk_mul_f32 v[50:51], v[50:51], v[58:59]
  v_pk_mul_f32 v[52:53], v[52:53], v[60:61]
  v_pk_mul_f32 v[54:55], v[54:55], v[62:63]
  s_waitcnt lgkmcnt(0)
  v_mfma_f32_32x32x16_bf16 v[32:47], v[120:123], a[0:3], 0
  v_exp_f32 v64, v64
  v_exp_f32 v65, v65
  v_cvt_pk_bf16_f32 v112, v232, v233
  v_cvt_pk_bf16_f32 v113, v234, v235
  v_mfma_f32_32x32x16_bf16 v[32:47], v[124:127], a[4:7], v[32:47]
  v_exp_f32 v66, v66
  v_exp_f32 v67, v67
  v_cvt_pk_bf16_f32 v114, v236, v237
  v_cvt_pk_bf16_f32 v115, v238, v239
  v_mfma_f32_32x32x16_bf16 v[32:47], v[128:131], a[8:11], v[32:47]
  v_exp_f32 v68, v68
  v_exp_f32 v69, v69
  v_accvgpr_write_b32 a200, v112
  v_accvgpr_write_b32 a201, v113
  v_mfma_f32_32x32x16_bf16 v[32:47], v[132:135], a[12:15], v[32:47]
  v_exp_f32 v70, v70
  v_exp_f32 v71, v71
  v_accvgpr_write_b32 a202, v114
  v_accvgpr_write_b32 a203, v115
  v_mfma_f32_32x32x16_bf16 v[32:47], v[136:139], a[16:19], v[32:47]
  buffer_load_dwordx4 a[140:143], v248, s[20:23], s42 offen offset:1024 sc1
  v_exp_f32 v72, v72
  v_exp_f32 v73, v73
  v_mfma_f32_32x32x16_bf16 v[32:47], v[140:143], a[20:23], v[32:47]
  v_exp_f32 v74, v74
  v_exp_f32 v75, v75
  v_cvt_pk_bf16_f32 v116, v240, v241
  v_cvt_pk_bf16_f32 v117, v242, v243
  v_mfma_f32_32x32x16_bf16 v[32:47], v[144:147], a[24:27], v[32:47]
  v_exp_f32 v76, v76
  v_exp_f32 v77, v77
  v_cvt_pk_bf16_f32 v118, v244, v245
  v_cvt_pk_bf16_f32 v119, v246, v247
  v_mfma_f32_32x32x16_bf16 v[32:47], v[148:151], a[28:31], v[32:47]
  buffer_load_dwordx4 a[80:83], v248, s[20:23], s54 offen offset:0 sc1
  v_exp_f32 v78, v78
  v_exp_f32 v79, v79
  v_accvgpr_write_b32 a204, v116
  v_mfma_f32_32x32x16_bf16 v[32:47], v[152:155], a[32:35], v[32:47]
  buffer_load_dwordx4 a[84:87], v248, s[20:23], s54 offen offset:1024 sc1
  v_rcp_f32 v48, v48
  v_rcp_f32 v49, v49
  v_accvgpr_write_b32 a205, v117
  v_mfma_f32_32x32x16_bf16 v[32:47], v[156:159], a[36:39], v[32:47]
  v_rcp_f32 v50, v50
  v_rcp_f32 v51, v51
  v_accvgpr_write_b32 a206, v118
  v_accvgpr_write_b32 a207, v119
  v_mfma_f32_32x32x16_bf16 v[32:47], v[160:163], a[40:43], v[32:47]
  buffer_load_dwordx4 a[88:91], v248, s[20:23], s54 offen offset:2048 sc1
  v_rcp_f32 v52, v52
  v_rcp_f32 v53, v53
  v_fma_f32 v64, v64, s60, s60 clamp
  v_mfma_f32_32x32x16_bf16 v[32:47], v[164:167], a[44:47], v[32:47]
  buffer_load_dwordx4 a[92:95], v248, s[20:23], s54 offen offset:3072 sc1
  v_rcp_f32 v54, v54
  v_rcp_f32_e64 v55, v55
  v_fma_f32 v65, v65, s60, s60 clamp
  v_fma_f32 v66, v66, s60, s60 clamp
  v_fma_f32 v67, v67, s60, s60 clamp
  v_fma_f32 v68, v68, s60, s60 clamp
  v_fma_f32 v69, v69, s60, s60 clamp
  v_pk_fma_f32 v[70:71], v[70:71], s[60:61], s[60:61] clamp
  v_pk_fma_f32 v[72:73], v[72:73], s[60:61], s[60:61] clamp
  v_pk_fma_f32 v[74:75], v[74:75], s[60:61], s[60:61] clamp
  v_pk_fma_f32 v[76:77], v[76:77], s[60:61], s[60:61] clamp
  v_pk_fma_f32 v[78:79], v[78:79], s[60:61], s[60:61] clamp
  v_pk_mul_f32 v[0:1], v[0:1], v[48:49]
  v_pk_mul_f32 v[2:3], v[2:3], v[50:51]
  v_pk_mul_f32 v[4:5], v[4:5], v[52:53]
  v_pk_mul_f32 v[6:7], v[6:7], v[54:55]
  v_pk_mul_f32 v[8:9], v[8:9], v[48:49]
  v_pk_mul_f32 v[10:11], v[10:11], v[50:51]
  v_pk_mul_f32 v[12:13], v[12:13], v[52:53]
  v_pk_mul_f32 v[14:15], v[14:15], v[54:55]
  v_pk_fma_f32 v[80:81], v[0:1], v[0:1], v[80:81]
  v_pk_fma_f32 v[82:83], v[2:3], v[2:3], v[82:83]
  v_pk_fma_f32 v[84:85], v[4:5], v[4:5], v[84:85]
  v_pk_fma_f32 v[86:87], v[6:7], v[6:7], v[86:87]
  v_pk_fma_f32 v[88:89], v[8:9], v[8:9], v[88:89]
  v_pk_fma_f32 v[90:91], v[10:11], v[10:11], v[90:91]
  v_pk_fma_f32 v[92:93], v[12:13], v[12:13], v[92:93]
  v_pk_fma_f32 v[94:95], v[14:15], v[14:15], v[94:95]
  v_pk_fma_f32 v[48:49], v[32:33], v[32:33], s[62:63]
  v_pk_fma_f32 v[50:51], v[34:35], v[34:35], s[62:63]
  v_pk_fma_f32 v[52:53], v[36:37], v[36:37], s[62:63]
  v_pk_fma_f32 v[54:55], v[38:39], v[38:39], s[62:63]
  v_pk_fma_f32 v[56:57], v[40:41], v[40:41], s[62:63]
  v_pk_fma_f32 v[58:59], v[42:43], v[42:43], s[62:63]
  v_pk_fma_f32 v[60:61], v[44:45], v[44:45], s[62:63]
  v_pk_fma_f32 v[62:63], v[46:47], v[46:47], s[62:63]
  v_pk_mul_f32 v[48:49], v[32:33], v[48:49] neg_lo:[1,0] neg_hi:[1,0]
  v_pk_mul_f32 v[50:51], v[34:35], v[50:51] neg_lo:[1,0] neg_hi:[1,0]
  v_pk_mul_f32 v[52:53], v[36:37], v[52:53] neg_lo:[1,0] neg_hi:[1,0]
  v_pk_mul_f32 v[54:55], v[38:39], v[54:55] neg_lo:[1,0] neg_hi:[1,0]
  v_pk_mul_f32 v[56:57], v[40:41], v[56:57] neg_lo:[1,0] neg_hi:[1,0]
  v_pk_mul_f32 v[58:59], v[42:43], v[58:59] neg_lo:[1,0] neg_hi:[1,0]
  v_pk_mul_f32 v[60:61], v[44:45], v[60:61] neg_lo:[1,0] neg_hi:[1,0]
  v_pk_mul_f32 v[62:63], v[46:47], v[62:63] neg_lo:[1,0] neg_hi:[1,0]
  v_pk_mul_f32 v[16:17], v[16:17], v[72:73]
  v_pk_mul_f32 v[18:19], v[18:19], v[74:75]
  v_pk_mul_f32 v[20:21], v[20:21], v[76:77]
  v_pk_mul_f32 v[22:23], v[22:23], v[78:79]
  v_pk_mul_f32 v[24:25], v[24:25], v[64:65]
  v_pk_mul_f32 v[26:27], v[26:27], v[66:67]
  v_pk_mul_f32 v[28:29], v[28:29], v[68:69]
  v_pk_mul_f32 v[30:31], v[30:31], v[70:71]
  v_pk_mul_f32 v[64:65], v[64:65], v[72:73]
  v_pk_mul_f32 v[66:67], v[66:67], v[74:75]
  v_pk_mul_f32 v[68:69], v[68:69], v[76:77]
  v_pk_mul_f32 v[70:71], v[70:71], v[78:79]
  v_mfma_f32_32x32x16_bf16 v[232:247], v[168:171], a[0:3], 0
  v_exp_f32 v48, v48
  v_exp_f32 v49, v49
  v_cvt_pk_bf16_f32 v112, v0, v1
  v_cvt_pk_bf16_f32 v113, v2, v3
  v_mfma_f32_32x32x16_bf16 v[232:247], v[172:175], a[4:7], v[232:247]
  ds_read_b128 a[0:3], v249 offset:39168
  v_exp_f32 v50, v50
  v_exp_f32 v51, v51
  v_cvt_pk_bf16_f32 v114, v4, v5
  v_mfma_f32_32x32x16_bf16 v[232:247], v[176:179], a[8:11], v[232:247]
  ds_read_b128 a[4:7], v249 offset:40192
  v_exp_f32 v52, v52
  v_exp_f32 v53, v53
  v_cvt_pk_bf16_f32 v115, v6, v7
  v_mfma_f32_32x32x16_bf16 v[232:247], v[180:183], a[12:15], v[232:247]
  ds_read_b128 a[8:11], v249 offset:41216
  v_exp_f32 v54, v54
  v_exp_f32 v55, v55
  v_accvgpr_write_b32 a208, v112
  v_mfma_f32_32x32x16_bf16 v[232:247], v[184:187], a[16:19], v[232:247]
  ds_read_b128 a[12:15], v249 offset:42240
  v_exp_f32 v56, v56
  v_exp_f32 v57, v57
  v_accvgpr_write_b32 a209, v113
  v_mfma_f32_32x32x16_bf16 v[232:247], v[188:191], a[20:23], v[232:247]
  ds_read_b128 a[16:19], v249 offset:43264
  v_exp_f32 v58, v58
  v_exp_f32 v59, v59
  v_accvgpr_write_b32 a210, v114
  v_mfma_f32_32x32x16_bf16 v[232:247], v[192:195], a[24:27], v[232:247]
  ds_read_b128 a[20:23], v249 offset:44288
  v_exp_f32 v60, v60
  v_exp_f32 v61, v61
  v_accvgpr_write_b32 a211, v115
  v_mfma_f32_32x32x16_bf16 v[232:247], v[196:199], a[28:31], v[232:247]
  ds_read_b128 a[24:27], v249 offset:45312
  v_exp_f32 v62, v62
  v_exp_f32 v63, v63
  v_cvt_pk_bf16_f32 v116, v8, v9
  v_mfma_f32_32x32x16_bf16 v[232:247], v[200:203], a[32:35], v[232:247]
  ds_read_b128 a[28:31], v249 offset:46336
  v_rcp_f32 v64, v64
  v_rcp_f32 v65, v65
  v_cvt_pk_bf16_f32 v117, v10, v11
  v_mfma_f32_32x32x16_bf16 v[232:247], v[204:207], a[36:39], v[232:247]
  ds_read_b128 a[32:35], v249 offset:47360
  v_rcp_f32 v66, v66
  v_rcp_f32 v67, v67
  v_cvt_pk_bf16_f32 v118, v12, v13
  v_mfma_f32_32x32x16_bf16 v[232:247], v[208:211], a[40:43], v[232:247]
  ds_read_b128 a[36:39], v249 offset:48384
  v_rcp_f32 v68, v68
  v_rcp_f32 v69, v69
  v_cvt_pk_bf16_f32 v119, v14, v15
  v_mfma_f32_32x32x16_bf16 v[232:247], v[212:215], a[44:47], v[232:247]
  ds_read_b128 a[40:43], v249 offset:49408
  ds_read_b128 a[44:47], v249 offset:50432
  v_rcp_f32 v70, v70
  v_rcp_f32 v71, v71
  v_accvgpr_write_b32 a212, v116
  v_accvgpr_write_b32 a213, v117
  v_accvgpr_write_b32 a214, v118
  v_accvgpr_write_b32 a215, v119
  v_pk_fma_f32 v[48:49], v[48:49], s[60:61], s[60:61] clamp
  v_pk_fma_f32 v[50:51], v[50:51], s[60:61], s[60:61] clamp
  v_pk_fma_f32 v[52:53], v[52:53], s[60:61], s[60:61] clamp
  v_pk_fma_f32 v[54:55], v[54:55], s[60:61], s[60:61] clamp
  v_pk_fma_f32 v[56:57], v[56:57], s[60:61], s[60:61] clamp
  v_pk_fma_f32 v[58:59], v[58:59], s[60:61], s[60:61] clamp
  v_pk_fma_f32 v[60:61], v[60:61], s[60:61], s[60:61] clamp
  v_pk_fma_f32 v[62:63], v[62:63], s[60:61], s[60:61] clamp
  v_pk_mul_f32 v[16:17], v[16:17], v[64:65]
  v_pk_mul_f32 v[18:19], v[18:19], v[66:67]
  v_pk_mul_f32 v[20:21], v[20:21], v[68:69]
  v_pk_mul_f32 v[22:23], v[22:23], v[70:71]
  v_pk_mul_f32 v[24:25], v[24:25], v[64:65]
  v_pk_mul_f32 v[26:27], v[26:27], v[66:67]
  v_pk_mul_f32 v[28:29], v[28:29], v[68:69]
  v_pk_mul_f32 v[30:31], v[30:31], v[70:71]
  v_pk_fma_f32 v[96:97], v[16:17], v[16:17], v[96:97]
  v_pk_fma_f32 v[98:99], v[18:19], v[18:19], v[98:99]
  v_pk_fma_f32 v[100:101], v[20:21], v[20:21], v[100:101]
  v_pk_fma_f32 v[102:103], v[22:23], v[22:23], v[102:103]
  v_pk_fma_f32 v[104:105], v[24:25], v[24:25], v[104:105]
  v_pk_fma_f32 v[106:107], v[26:27], v[26:27], v[106:107]
  v_pk_fma_f32 v[108:109], v[28:29], v[28:29], v[108:109]
  v_pk_fma_f32 v[110:111], v[30:31], v[30:31], v[110:111]
  v_pk_fma_f32 v[64:65], v[232:233], v[232:233], s[62:63]
  v_pk_fma_f32 v[66:67], v[234:235], v[234:235], s[62:63]
  v_pk_fma_f32 v[68:69], v[236:237], v[236:237], s[62:63]
  v_pk_fma_f32 v[70:71], v[238:239], v[238:239], s[62:63]
  v_pk_fma_f32 v[72:73], v[240:241], v[240:241], s[62:63]
  v_pk_fma_f32 v[74:75], v[242:243], v[242:243], s[62:63]
  v_pk_fma_f32 v[76:77], v[244:245], v[244:245], s[62:63]
  v_pk_fma_f32 v[78:79], v[246:247], v[246:247], s[62:63]
  v_pk_mul_f32 v[64:65], v[232:233], v[64:65] neg_lo:[1,0] neg_hi:[1,0]
  v_pk_mul_f32 v[66:67], v[234:235], v[66:67] neg_lo:[1,0] neg_hi:[1,0]
  v_pk_mul_f32 v[68:69], v[236:237], v[68:69] neg_lo:[1,0] neg_hi:[1,0]
  v_pk_mul_f32 v[70:71], v[238:239], v[70:71] neg_lo:[1,0] neg_hi:[1,0]
  v_pk_mul_f32 v[72:73], v[240:241], v[72:73] neg_lo:[1,0] neg_hi:[1,0]
  v_pk_mul_f32 v[74:75], v[242:243], v[74:75] neg_lo:[1,0] neg_hi:[1,0]
  v_pk_mul_f32 v[76:77], v[244:245], v[76:77] neg_lo:[1,0] neg_hi:[1,0]
  v_pk_mul_f32 v[78:79], v[246:247], v[78:79] neg_lo:[1,0] neg_hi:[1,0]
  v_pk_mul_f32 v[32:33], v[32:33], v[56:57]
  v_pk_mul_f32 v[34:35], v[34:35], v[58:59]
  v_pk_mul_f32 v[36:37], v[36:37], v[60:61]
  v_pk_mul_f32 v[38:39], v[38:39], v[62:63]
  v_pk_mul_f32 v[40:41], v[40:41], v[48:49]
  v_pk_mul_f32 v[42:43], v[42:43], v[50:51]
  v_pk_mul_f32 v[44:45], v[44:45], v[52:53]
  v_pk_mul_f32 v[46:47], v[46:47], v[54:55]
  v_pk_mul_f32 v[48:49], v[48:49], v[56:57]
  v_pk_mul_f32 v[50:51], v[50:51], v[58:59]
  v_pk_mul_f32 v[52:53], v[52:53], v[60:61]
  v_pk_mul_f32 v[54:55], v[54:55], v[62:63]
  s_waitcnt lgkmcnt(0)
  v_mfma_f32_32x32x16_bf16 v[0:15], v[120:123], a[0:3], 0
  v_exp_f32 v64, v64
  v_exp_f32 v65, v65
  v_cvt_pk_bf16_f32 v112, v16, v17
  v_cvt_pk_bf16_f32 v113, v18, v19
  v_mfma_f32_32x32x16_bf16 v[0:15], v[124:127], a[4:7], v[0:15]
  v_exp_f32 v66, v66
  v_exp_f32 v67, v67
  v_cvt_pk_bf16_f32 v114, v20, v21
  v_cvt_pk_bf16_f32 v115, v22, v23
  v_mfma_f32_32x32x16_bf16 v[0:15], v[128:131], a[8:11], v[0:15]
  v_exp_f32 v68, v68
  v_exp_f32 v69, v69
  v_accvgpr_write_b32 a216, v112
  v_accvgpr_write_b32 a217, v113
  v_mfma_f32_32x32x16_bf16 v[0:15], v[132:135], a[12:15], v[0:15]
  v_exp_f32 v70, v70
  v_exp_f32 v71, v71
  v_accvgpr_write_b32 a218, v114
  v_accvgpr_write_b32 a219, v115
  v_mfma_f32_32x32x16_bf16 v[0:15], v[136:139], a[16:19], v[0:15]
  v_exp_f32 v72, v72
  v_exp_f32 v73, v73
  v_cvt_pk_bf16_f32 v116, v24, v25
  v_cvt_pk_bf16_f32 v117, v26, v27
  v_mfma_f32_32x32x16_bf16 v[0:15], v[140:143], a[20:23], v[0:15]
  v_exp_f32 v74, v74
  v_exp_f32 v75, v75
  v_cvt_pk_bf16_f32 v118, v28, v29
  v_cvt_pk_bf16_f32 v119, v30, v31
  v_mfma_f32_32x32x16_bf16 v[0:15], v[144:147], a[24:27], v[0:15]
  v_exp_f32 v76, v76
  v_exp_f32 v77, v77
  v_accvgpr_write_b32 a220, v116
  v_accvgpr_write_b32 a221, v117
  v_mfma_f32_32x32x16_bf16 v[0:15], v[148:151], a[28:31], v[0:15]
  buffer_load_dwordx4 a[96:99], v248, s[20:23], s57 offen offset:0 sc1
  v_exp_f32 v78, v78
  v_exp_f32 v79, v79
  v_accvgpr_write_b32 a222, v118
  v_mfma_f32_32x32x16_bf16 v[0:15], v[152:155], a[32:35], v[0:15]
  buffer_load_dwordx4 a[100:103], v248, s[20:23], s57 offen offset:1024 sc1
  v_rcp_f32 v48, v48
  v_rcp_f32 v49, v49
  v_accvgpr_write_b32 a223, v119
  v_mfma_f32_32x32x16_bf16 v[0:15], v[156:159], a[36:39], v[0:15]
  v_rcp_f32 v50, v50
  v_rcp_f32 v51, v51
  v_fma_f32 v64, v64, s60, s60 clamp
  v_fma_f32 v65, v65, s60, s60 clamp
  v_mfma_f32_32x32x16_bf16 v[0:15], v[160:163], a[40:43], v[0:15]
  buffer_load_dwordx4 a[104:107], v248, s[20:23], s57 offen offset:2048 sc1
  v_rcp_f32 v52, v52
  v_rcp_f32 v53, v53
  v_fma_f32 v66, v66, s60, s60 clamp
  v_mfma_f32_32x32x16_bf16 v[0:15], v[164:167], a[44:47], v[0:15]
  buffer_load_dwordx4 a[108:111], v248, s[20:23], s57 offen offset:3072 sc1
  v_rcp_f32 v54, v54
  v_rcp_f32_e64 v55, v55
  v_fma_f32 v67, v67, s60, s60 clamp
  v_fma_f32 v68, v68, s60, s60 clamp
  v_fma_f32 v69, v69, s60, s60 clamp
  v_fma_f32 v70, v70, s60, s60 clamp
  v_fma_f32 v71, v71, s60, s60 clamp
  v_pk_fma_f32 v[72:73], v[72:73], s[60:61], s[60:61] clamp
  v_pk_fma_f32 v[74:75], v[74:75], s[60:61], s[60:61] clamp
  v_pk_fma_f32 v[76:77], v[76:77], s[60:61], s[60:61] clamp
  v_pk_fma_f32 v[78:79], v[78:79], s[60:61], s[60:61] clamp
  v_pk_mul_f32 v[32:33], v[32:33], v[48:49]
  v_pk_mul_f32 v[34:35], v[34:35], v[50:51]
  v_pk_mul_f32 v[36:37], v[36:37], v[52:53]
  v_pk_mul_f32 v[38:39], v[38:39], v[54:55]
  v_pk_mul_f32 v[40:41], v[40:41], v[48:49]
  v_pk_mul_f32 v[42:43], v[42:43], v[50:51]
  v_pk_mul_f32 v[44:45], v[44:45], v[52:53]
  v_pk_mul_f32 v[46:47], v[46:47], v[54:55]
  v_pk_fma_f32 v[80:81], v[32:33], v[32:33], v[80:81]
  v_pk_fma_f32 v[82:83], v[34:35], v[34:35], v[82:83]
  v_pk_fma_f32 v[84:85], v[36:37], v[36:37], v[84:85]
  v_pk_fma_f32 v[86:87], v[38:39], v[38:39], v[86:87]
  v_pk_fma_f32 v[88:89], v[40:41], v[40:41], v[88:89]
  v_pk_fma_f32 v[90:91], v[42:43], v[42:43], v[90:91]
  v_pk_fma_f32 v[92:93], v[44:45], v[44:45], v[92:93]
  v_pk_fma_f32 v[94:95], v[46:47], v[46:47], v[94:95]
  v_pk_fma_f32 v[48:49], v[0:1], v[0:1], s[62:63]
  v_pk_fma_f32 v[50:51], v[2:3], v[2:3], s[62:63]
  v_pk_fma_f32 v[52:53], v[4:5], v[4:5], s[62:63]
  v_pk_fma_f32 v[54:55], v[6:7], v[6:7], s[62:63]
  v_pk_fma_f32 v[56:57], v[8:9], v[8:9], s[62:63]
  v_pk_fma_f32 v[58:59], v[10:11], v[10:11], s[62:63]
  v_pk_fma_f32 v[60:61], v[12:13], v[12:13], s[62:63]
  v_pk_fma_f32 v[62:63], v[14:15], v[14:15], s[62:63]
  v_pk_mul_f32 v[48:49], v[0:1], v[48:49] neg_lo:[1,0] neg_hi:[1,0]
  v_pk_mul_f32 v[50:51], v[2:3], v[50:51] neg_lo:[1,0] neg_hi:[1,0]
  v_pk_mul_f32 v[52:53], v[4:5], v[52:53] neg_lo:[1,0] neg_hi:[1,0]
  v_pk_mul_f32 v[54:55], v[6:7], v[54:55] neg_lo:[1,0] neg_hi:[1,0]
  v_pk_mul_f32 v[56:57], v[8:9], v[56:57] neg_lo:[1,0] neg_hi:[1,0]
  v_pk_mul_f32 v[58:59], v[10:11], v[58:59] neg_lo:[1,0] neg_hi:[1,0]
  v_pk_mul_f32 v[60:61], v[12:13], v[60:61] neg_lo:[1,0] neg_hi:[1,0]
  v_pk_mul_f32 v[62:63], v[14:15], v[62:63] neg_lo:[1,0] neg_hi:[1,0]
  v_pk_mul_f32 v[232:233], v[232:233], v[72:73]
  v_pk_mul_f32 v[234:235], v[234:235], v[74:75]
  v_pk_mul_f32 v[236:237], v[236:237], v[76:77]
  v_pk_mul_f32 v[238:239], v[238:239], v[78:79]
  v_pk_mul_f32 v[240:241], v[240:241], v[64:65]
  v_pk_mul_f32 v[242:243], v[242:243], v[66:67]
  v_pk_mul_f32 v[244:245], v[244:245], v[68:69]
  v_pk_mul_f32 v[246:247], v[246:247], v[70:71]
  v_pk_mul_f32 v[64:65], v[64:65], v[72:73]
  v_pk_mul_f32 v[66:67], v[66:67], v[74:75]
  v_pk_mul_f32 v[68:69], v[68:69], v[76:77]
  v_pk_mul_f32 v[70:71], v[70:71], v[78:79]
  v_mfma_f32_32x32x16_bf16 v[16:31], v[168:171], a[0:3], 0
  v_exp_f32 v48, v48
  v_exp_f32 v49, v49
  v_cvt_pk_bf16_f32 v112, v32, v33
  v_cvt_pk_bf16_f32 v113, v34, v35
  v_mfma_f32_32x32x16_bf16 v[16:31], v[172:175], a[4:7], v[16:31]
  ds_read_b128 a[0:3], v250 offset:0
  v_exp_f32 v50, v50
  v_exp_f32 v51, v51
  v_cvt_pk_bf16_f32 v114, v36, v37
  v_mfma_f32_32x32x16_bf16 v[16:31], v[176:179], a[8:11], v[16:31]
  ds_read_b128 a[4:7], v250 offset:1024
  v_exp_f32 v52, v52
  v_exp_f32 v53, v53
  v_cvt_pk_bf16_f32 v115, v38, v39
  v_mfma_f32_32x32x16_bf16 v[16:31], v[180:183], a[12:15], v[16:31]
  ds_read_b128 a[8:11], v250 offset:2048
  v_exp_f32 v54, v54
  v_exp_f32 v55, v55
  v_accvgpr_write_b32 a224, v112
  v_mfma_f32_32x32x16_bf16 v[16:31], v[184:187], a[16:19], v[16:31]
  ds_read_b128 a[12:15], v250 offset:3072
  v_exp_f32 v56, v56
  v_exp_f32 v57, v57
  v_accvgpr_write_b32 a225, v113
  v_mfma_f32_32x32x16_bf16 v[16:31], v[188:191], a[20:23], v[16:31]
  ds_read_b128 a[16:19], v250 offset:4096
  v_exp_f32 v58, v58
  v_exp_f32 v59, v59
  v_accvgpr_write_b32 a226, v114
  v_mfma_f32_32x32x16_bf16 v[16:31], v[192:195], a[24:27], v[16:31]
  ds_read_b128 a[20:23], v250 offset:5120
  v_exp_f32 v60, v60
  v_exp_f32 v61, v61
  v_accvgpr_write_b32 a227, v115
  v_mfma_f32_32x32x16_bf16 v[16:31], v[196:199], a[28:31], v[16:31]
  ds_read_b128 a[24:27], v250 offset:6144
  v_exp_f32 v62, v62
  v_exp_f32 v63, v63
  v_cvt_pk_bf16_f32 v116, v40, v41
  v_mfma_f32_32x32x16_bf16 v[16:31], v[200:203], a[32:35], v[16:31]
  ds_read_b128 a[28:31], v250 offset:7168
  v_rcp_f32 v64, v64
  v_rcp_f32 v65, v65
  v_cvt_pk_bf16_f32 v117, v42, v43
  v_mfma_f32_32x32x16_bf16 v[16:31], v[204:207], a[36:39], v[16:31]
  ds_read_b128 a[32:35], v250 offset:8192
  v_rcp_f32 v66, v66
  v_rcp_f32 v67, v67
  v_cvt_pk_bf16_f32 v118, v44, v45
  v_mfma_f32_32x32x16_bf16 v[16:31], v[208:211], a[40:43], v[16:31]
  ds_read_b128 a[36:39], v250 offset:9216
  v_rcp_f32 v68, v68
  v_rcp_f32 v69, v69
  v_cvt_pk_bf16_f32 v119, v46, v47
  v_mfma_f32_32x32x16_bf16 v[16:31], v[212:215], a[44:47], v[16:31]
  ds_read_b128 a[40:43], v250 offset:10240
  ds_read_b128 a[44:47], v250 offset:11264
  v_rcp_f32 v70, v70
  v_rcp_f32 v71, v71
  v_accvgpr_write_b32 a228, v116
  v_accvgpr_write_b32 a229, v117
  v_accvgpr_write_b32 a230, v118
  v_accvgpr_write_b32 a231, v119
  v_bfe_u32 v254, v248, 8, 1
  v_bfe_u32 v253, v248, 4, 3
  v_lshlrev_b32 v254, 5, v254
  v_bfe_u32 v255, v248, 7, 1
  v_lshl_add_u32 v254, v253, 2, v254
  v_lshrrev_b32 v253, 9, v248
  v_lshl_add_u32 v254, v255, 6, v254
  s_mul_i32 s45, s3, 384
  v_lshl_add_u32 v253, v253, 7, v254
  v_pk_fma_f32 v[48:49], v[48:49], s[60:61], s[60:61] clamp
  v_pk_fma_f32 v[50:51], v[50:51], s[60:61], s[60:61] clamp
  v_pk_fma_f32 v[52:53], v[52:53], s[60:61], s[60:61] clamp
  v_pk_fma_f32 v[54:55], v[54:55], s[60:61], s[60:61] clamp
  v_pk_fma_f32 v[56:57], v[56:57], s[60:61], s[60:61] clamp
  v_pk_fma_f32 v[58:59], v[58:59], s[60:61], s[60:61] clamp
  v_pk_fma_f32 v[60:61], v[60:61], s[60:61], s[60:61] clamp
  v_pk_fma_f32 v[62:63], v[62:63], s[60:61], s[60:61] clamp
  v_pk_mul_f32 v[232:233], v[232:233], v[64:65]
  v_pk_mul_f32 v[234:235], v[234:235], v[66:67]
  v_pk_mul_f32 v[236:237], v[236:237], v[68:69]
  v_pk_mul_f32 v[238:239], v[238:239], v[70:71]
  v_pk_mul_f32 v[240:241], v[240:241], v[64:65]
  v_pk_mul_f32 v[242:243], v[242:243], v[66:67]
  v_pk_mul_f32 v[244:245], v[244:245], v[68:69]
  v_pk_mul_f32 v[246:247], v[246:247], v[70:71]
  v_pk_fma_f32 v[96:97], v[232:233], v[232:233], v[96:97]
  v_pk_fma_f32 v[98:99], v[234:235], v[234:235], v[98:99]
  v_pk_fma_f32 v[100:101], v[236:237], v[236:237], v[100:101]
  v_pk_fma_f32 v[102:103], v[238:239], v[238:239], v[102:103]
  v_pk_fma_f32 v[104:105], v[240:241], v[240:241], v[104:105]
  v_pk_fma_f32 v[106:107], v[242:243], v[242:243], v[106:107]
  v_pk_fma_f32 v[108:109], v[244:245], v[244:245], v[108:109]
  v_pk_fma_f32 v[110:111], v[246:247], v[246:247], v[110:111]
  v_pk_fma_f32 v[64:65], v[16:17], v[16:17], s[62:63]
  v_pk_fma_f32 v[66:67], v[18:19], v[18:19], s[62:63]
  v_pk_fma_f32 v[68:69], v[20:21], v[20:21], s[62:63]
  v_pk_fma_f32 v[70:71], v[22:23], v[22:23], s[62:63]
  v_pk_fma_f32 v[72:73], v[24:25], v[24:25], s[62:63]
  v_pk_fma_f32 v[74:75], v[26:27], v[26:27], s[62:63]
  v_pk_fma_f32 v[76:77], v[28:29], v[28:29], s[62:63]
  v_pk_fma_f32 v[78:79], v[30:31], v[30:31], s[62:63]
  v_pk_mul_f32 v[64:65], v[16:17], v[64:65] neg_lo:[1,0] neg_hi:[1,0]
  v_pk_mul_f32 v[66:67], v[18:19], v[66:67] neg_lo:[1,0] neg_hi:[1,0]
  v_pk_mul_f32 v[68:69], v[20:21], v[68:69] neg_lo:[1,0] neg_hi:[1,0]
  v_pk_mul_f32 v[70:71], v[22:23], v[70:71] neg_lo:[1,0] neg_hi:[1,0]
  v_pk_mul_f32 v[72:73], v[24:25], v[72:73] neg_lo:[1,0] neg_hi:[1,0]
  v_pk_mul_f32 v[74:75], v[26:27], v[74:75] neg_lo:[1,0] neg_hi:[1,0]
  v_pk_mul_f32 v[76:77], v[28:29], v[76:77] neg_lo:[1,0] neg_hi:[1,0]
  v_pk_mul_f32 v[78:79], v[30:31], v[78:79] neg_lo:[1,0] neg_hi:[1,0]
  v_pk_mul_f32 v[0:1], v[0:1], v[56:57]
  v_pk_mul_f32 v[2:3], v[2:3], v[58:59]
  v_pk_mul_f32 v[4:5], v[4:5], v[60:61]
  v_pk_mul_f32 v[6:7], v[6:7], v[62:63]
  v_pk_mul_f32 v[8:9], v[8:9], v[48:49]
  v_pk_mul_f32 v[10:11], v[10:11], v[50:51]
  v_pk_mul_f32 v[12:13], v[12:13], v[52:53]
  v_pk_mul_f32 v[14:15], v[14:15], v[54:55]
  v_pk_mul_f32 v[48:49], v[48:49], v[56:57]
  v_pk_mul_f32 v[50:51], v[50:51], v[58:59]
  v_pk_mul_f32 v[52:53], v[52:53], v[60:61]
  v_pk_mul_f32 v[54:55], v[54:55], v[62:63]
  s_waitcnt lgkmcnt(0)
  v_mfma_f32_32x32x16_bf16 v[32:47], v[120:123], a[0:3], 0
  v_exp_f32 v64, v64
  v_exp_f32 v65, v65
  v_cvt_pk_bf16_f32 v112, v232, v233
  v_cvt_pk_bf16_f32 v113, v234, v235
  v_mfma_f32_32x32x16_bf16 v[32:47], v[124:127], a[4:7], v[32:47]
  v_exp_f32 v66, v66
  v_exp_f32 v67, v67
  v_cvt_pk_bf16_f32 v114, v236, v237
  v_cvt_pk_bf16_f32 v115, v238, v239
  v_mfma_f32_32x32x16_bf16 v[32:47], v[128:131], a[8:11], v[32:47]
  v_exp_f32 v68, v68
  v_exp_f32 v69, v69
  v_accvgpr_write_b32 a232, v112
  v_accvgpr_write_b32 a233, v113
  v_mfma_f32_32x32x16_bf16 v[32:47], v[132:135], a[12:15], v[32:47]
  v_exp_f32 v70, v70
  v_exp_f32 v71, v71
  v_accvgpr_write_b32 a234, v114
  v_accvgpr_write_b32 a235, v115
  v_mfma_f32_32x32x16_bf16 v[32:47], v[136:139], a[16:19], v[32:47]
  buffer_load_dword v255, v254, s[28:31], s45 offen offset:256
  v_exp_f32 v72, v72
  v_exp_f32 v73, v73
  v_mfma_f32_32x32x16_bf16 v[32:47], v[140:143], a[20:23], v[32:47]
  v_exp_f32 v74, v74
  v_exp_f32 v75, v75
  v_cvt_pk_bf16_f32 v116, v240, v241
  v_cvt_pk_bf16_f32 v117, v242, v243
  v_mfma_f32_32x32x16_bf16 v[32:47], v[144:147], a[24:27], v[32:47]
  buffer_load_dword v253, v253, s[28:31], s45 offen
  v_exp_f32 v76, v76
  v_exp_f32 v77, v77
  v_mfma_f32_32x32x16_bf16 v[32:47], v[148:151], a[28:31], v[32:47]
  buffer_load_dwordx4 a[112:115], v248, s[20:23], s66 offen offset:0 sc1
  v_exp_f32 v78, v78
  v_exp_f32 v79, v79
  v_cvt_pk_bf16_f32 v118, v244, v245
  v_mfma_f32_32x32x16_bf16 v[32:47], v[152:155], a[32:35], v[32:47]
  buffer_load_dwordx4 a[116:119], v248, s[20:23], s66 offen offset:1024 sc1
  v_rcp_f32 v48, v48
  v_rcp_f32 v49, v49
  v_cvt_pk_bf16_f32 v119, v246, v247
  v_mfma_f32_32x32x16_bf16 v[32:47], v[156:159], a[36:39], v[32:47]
  v_rcp_f32 v50, v50
  v_rcp_f32 v51, v51
  v_accvgpr_write_b32 a236, v116
  v_accvgpr_write_b32 a237, v117
  v_mfma_f32_32x32x16_bf16 v[32:47], v[160:163], a[40:43], v[32:47]
  buffer_load_dwordx4 a[120:123], v248, s[20:23], s66 offen offset:2048 sc1
  v_rcp_f32 v52, v52
  v_rcp_f32 v53, v53
  v_accvgpr_write_b32 a238, v118
  v_mfma_f32_32x32x16_bf16 v[32:47], v[164:167], a[44:47], v[32:47]
  buffer_load_dwordx4 a[124:127], v248, s[20:23], s66 offen offset:3072 sc1
  v_rcp_f32 v54, v54
  v_rcp_f32_e64 v55, v55
  v_accvgpr_write_b32 a239, v119
  v_fma_f32 v64, v64, s60, s60 clamp
  v_fma_f32 v65, v65, s60, s60 clamp
  v_fma_f32 v66, v66, s60, s60 clamp
  v_fma_f32 v67, v67, s60, s60 clamp
  v_pk_fma_f32 v[68:69], v[68:69], s[60:61], s[60:61] clamp
  v_pk_fma_f32 v[70:71], v[70:71], s[60:61], s[60:61] clamp
  v_pk_fma_f32 v[72:73], v[72:73], s[60:61], s[60:61] clamp
  v_pk_fma_f32 v[74:75], v[74:75], s[60:61], s[60:61] clamp
  v_pk_fma_f32 v[76:77], v[76:77], s[60:61], s[60:61] clamp
  v_pk_fma_f32 v[78:79], v[78:79], s[60:61], s[60:61] clamp
  v_pk_mul_f32 v[0:1], v[0:1], v[48:49]
  v_pk_mul_f32 v[2:3], v[2:3], v[50:51]
  v_pk_mul_f32 v[4:5], v[4:5], v[52:53]
  v_pk_mul_f32 v[6:7], v[6:7], v[54:55]
  v_pk_mul_f32 v[8:9], v[8:9], v[48:49]
  v_pk_mul_f32 v[10:11], v[10:11], v[50:51]
  v_pk_mul_f32 v[12:13], v[12:13], v[52:53]
  v_pk_mul_f32 v[14:15], v[14:15], v[54:55]
  v_pk_fma_f32 v[80:81], v[0:1], v[0:1], v[80:81]
  v_pk_fma_f32 v[82:83], v[2:3], v[2:3], v[82:83]
  v_pk_fma_f32 v[84:85], v[4:5], v[4:5], v[84:85]
  v_pk_fma_f32 v[86:87], v[6:7], v[6:7], v[86:87]
  v_pk_fma_f32 v[88:89], v[8:9], v[8:9], v[88:89]
  v_pk_fma_f32 v[90:91], v[10:11], v[10:11], v[90:91]
  v_pk_fma_f32 v[92:93], v[12:13], v[12:13], v[92:93]
  v_pk_fma_f32 v[94:95], v[14:15], v[14:15], v[94:95]
  v_pk_fma_f32 v[48:49], v[32:33], v[32:33], s[62:63]
  v_pk_fma_f32 v[50:51], v[34:35], v[34:35], s[62:63]
  v_pk_fma_f32 v[52:53], v[36:37], v[36:37], s[62:63]
  v_pk_fma_f32 v[54:55], v[38:39], v[38:39], s[62:63]
  v_pk_fma_f32 v[56:57], v[40:41], v[40:41], s[62:63]
  v_pk_fma_f32 v[58:59], v[42:43], v[42:43], s[62:63]
  v_pk_fma_f32 v[60:61], v[44:45], v[44:45], s[62:63]
  v_pk_fma_f32 v[62:63], v[46:47], v[46:47], s[62:63]
  v_pk_mul_f32 v[48:49], v[32:33], v[48:49] neg_lo:[1,0] neg_hi:[1,0]
  v_pk_mul_f32 v[50:51], v[34:35], v[50:51] neg_lo:[1,0] neg_hi:[1,0]
  v_pk_mul_f32 v[52:53], v[36:37], v[52:53] neg_lo:[1,0] neg_hi:[1,0]
  v_pk_mul_f32 v[54:55], v[38:39], v[54:55] neg_lo:[1,0] neg_hi:[1,0]
  v_pk_mul_f32 v[56:57], v[40:41], v[56:57] neg_lo:[1,0] neg_hi:[1,0]
  v_pk_mul_f32 v[58:59], v[42:43], v[58:59] neg_lo:[1,0] neg_hi:[1,0]
  v_pk_mul_f32 v[60:61], v[44:45], v[60:61] neg_lo:[1,0] neg_hi:[1,0]
  v_pk_mul_f32 v[62:63], v[46:47], v[62:63] neg_lo:[1,0] neg_hi:[1,0]
  v_pk_mul_f32 v[16:17], v[16:17], v[72:73]
  v_pk_mul_f32 v[18:19], v[18:19], v[74:75]
  v_pk_mul_f32 v[20:21], v[20:21], v[76:77]
  v_pk_mul_f32 v[22:23], v[22:23], v[78:79]
  v_pk_mul_f32 v[24:25], v[24:25], v[64:65]
  v_pk_mul_f32 v[26:27], v[26:27], v[66:67]
  v_pk_mul_f32 v[28:29], v[28:29], v[68:69]
  v_pk_mul_f32 v[30:31], v[30:31], v[70:71]
  v_pk_mul_f32 v[64:65], v[64:65], v[72:73]
  v_pk_mul_f32 v[66:67], v[66:67], v[74:75]
  v_pk_mul_f32 v[68:69], v[68:69], v[76:77]
  v_pk_mul_f32 v[70:71], v[70:71], v[78:79]
  v_mfma_f32_32x32x16_bf16 v[232:247], v[168:171], a[0:3], 0
  v_exp_f32 v48, v48
  v_exp_f32 v49, v49
  v_cvt_pk_bf16_f32 v112, v0, v1
  v_cvt_pk_bf16_f32 v113, v2, v3
  v_mfma_f32_32x32x16_bf16 v[232:247], v[172:175], a[4:7], v[232:247]
  ds_read_b128 a[0:3], v250 offset:13056
  v_exp_f32 v50, v50
  v_exp_f32 v51, v51
  v_cvt_pk_bf16_f32 v114, v4, v5
  v_mfma_f32_32x32x16_bf16 v[232:247], v[176:179], a[8:11], v[232:247]
  ds_read_b128 a[4:7], v250 offset:14080
  v_exp_f32 v52, v52
  v_exp_f32 v53, v53
  v_cvt_pk_bf16_f32 v115, v6, v7
  v_mfma_f32_32x32x16_bf16 v[232:247], v[180:183], a[12:15], v[232:247]
  ds_read_b128 a[8:11], v250 offset:15104
  v_exp_f32 v54, v54
  v_exp_f32 v55, v55
  v_accvgpr_write_b32 a240, v112
  v_mfma_f32_32x32x16_bf16 v[232:247], v[184:187], a[16:19], v[232:247]
  ds_read_b128 a[12:15], v250 offset:16128
  s_mul_i32 s45, s3, 768
  s_add_u32 s45, s45, 884736
  s_lshl_b32 m0, s3, 10
  s_mov_b32 exec_hi, 0xffff
  buffer_load_dwordx4 v248, s[20:23], s45 offen sc1 lds
  s_mov_b32 exec_hi, -1
  v_exp_f32 v56, v56
  v_accvgpr_write_b32 a241, v113
  v_mfma_f32_32x32x16_bf16 v[232:247], v[188:191], a[20:23], v[232:247]
  ds_read_b128 a[16:19], v250 offset:17152
  v_exp_f32 v57, v57
  v_exp_f32 v58, v58
  v_accvgpr_write_b32 a242, v114
  v_mfma_f32_32x32x16_bf16 v[232:247], v[192:195], a[24:27], v[232:247]
  ds_read_b128 a[20:23], v250 offset:18176
  v_exp_f32 v59, v59
  v_exp_f32 v60, v60
  v_accvgpr_write_b32 a243, v115
  v_mfma_f32_32x32x16_bf16 v[232:247], v[196:199], a[28:31], v[232:247]
  ds_read_b128 a[24:27], v250 offset:19200
  v_exp_f32 v61, v61
  v_exp_f32 v62, v62
  v_cvt_pk_bf16_f32 v116, v8, v9
  v_mfma_f32_32x32x16_bf16 v[232:247], v[200:203], a[32:35], v[232:247]
  ds_read_b128 a[28:31], v250 offset:20224
  v_exp_f32 v63, v63
  v_rcp_f32 v64, v64
  v_cvt_pk_bf16_f32 v117, v10, v11
  v_mfma_f32_32x32x16_bf16 v[232:247], v[204:207], a[36:39], v[232:247]
  ds_read_b128 a[32:35], v250 offset:21248
  v_rcp_f32 v65, v65
  v_rcp_f32 v66, v66
  v_cvt_pk_bf16_f32 v118, v12, v13
  v_mfma_f32_32x32x16_bf16 v[232:247], v[208:211], a[40:43], v[232:247]
  ds_read_b128 a[36:39], v250 offset:22272
  v_rcp_f32 v67, v67
  v_rcp_f32 v68, v68
  v_cvt_pk_bf16_f32 v119, v14, v15
  v_mfma_f32_32x32x16_bf16 v[232:247], v[212:215], a[44:47], v[232:247]
  ds_read_b128 a[40:43], v250 offset:23296
  ds_read_b128 a[44:47], v250 offset:24320
  v_rcp_f32 v69, v69
  v_rcp_f32 v70, v70
  v_rcp_f32 v71, v71
  v_accvgpr_write_b32 a244, v116
  v_accvgpr_write_b32 a245, v117
  v_accvgpr_write_b32 a246, v118
  v_accvgpr_write_b32 a247, v119
  v_pk_fma_f32 v[48:49], v[48:49], s[60:61], s[60:61] clamp
  v_pk_fma_f32 v[50:51], v[50:51], s[60:61], s[60:61] clamp
  v_pk_fma_f32 v[52:53], v[52:53], s[60:61], s[60:61] clamp
  v_pk_fma_f32 v[54:55], v[54:55], s[60:61], s[60:61] clamp
  v_pk_fma_f32 v[56:57], v[56:57], s[60:61], s[60:61] clamp
  v_pk_fma_f32 v[58:59], v[58:59], s[60:61], s[60:61] clamp
  v_pk_fma_f32 v[60:61], v[60:61], s[60:61], s[60:61] clamp
  v_pk_fma_f32 v[62:63], v[62:63], s[60:61], s[60:61] clamp
  v_pk_mul_f32 v[16:17], v[16:17], v[64:65]
  v_pk_mul_f32 v[18:19], v[18:19], v[66:67]
  v_pk_mul_f32 v[20:21], v[20:21], v[68:69]
  v_pk_mul_f32 v[22:23], v[22:23], v[70:71]
  v_pk_mul_f32 v[24:25], v[24:25], v[64:65]
  v_pk_mul_f32 v[26:27], v[26:27], v[66:67]
  v_pk_mul_f32 v[28:29], v[28:29], v[68:69]
  v_pk_mul_f32 v[30:31], v[30:31], v[70:71]
  v_pk_fma_f32 v[96:97], v[16:17], v[16:17], v[96:97]
  v_pk_fma_f32 v[98:99], v[18:19], v[18:19], v[98:99]
  v_pk_fma_f32 v[100:101], v[20:21], v[20:21], v[100:101]
  v_pk_fma_f32 v[102:103], v[22:23], v[22:23], v[102:103]
  v_pk_fma_f32 v[104:105], v[24:25], v[24:25], v[104:105]
  v_pk_fma_f32 v[106:107], v[26:27], v[26:27], v[106:107]
  v_pk_fma_f32 v[108:109], v[28:29], v[28:29], v[108:109]
  v_pk_fma_f32 v[110:111], v[30:31], v[30:31], v[110:111]
  v_pk_fma_f32 v[64:65], v[232:233], v[232:233], s[62:63]
  v_pk_fma_f32 v[66:67], v[234:235], v[234:235], s[62:63]
  v_pk_fma_f32 v[68:69], v[236:237], v[236:237], s[62:63]
  v_pk_fma_f32 v[70:71], v[238:239], v[238:239], s[62:63]
  v_pk_fma_f32 v[72:73], v[240:241], v[240:241], s[62:63]
  v_pk_fma_f32 v[74:75], v[242:243], v[242:243], s[62:63]
  v_pk_fma_f32 v[76:77], v[244:245], v[244:245], s[62:63]
  v_pk_fma_f32 v[78:79], v[246:247], v[246:247], s[62:63]
  v_pk_mul_f32 v[64:65], v[232:233], v[64:65] neg_lo:[1,0] neg_hi:[1,0]
  v_pk_mul_f32 v[66:67], v[234:235], v[66:67] neg_lo:[1,0] neg_hi:[1,0]
  v_pk_mul_f32 v[68:69], v[236:237], v[68:69] neg_lo:[1,0] neg_hi:[1,0]
  v_pk_mul_f32 v[70:71], v[238:239], v[70:71] neg_lo:[1,0] neg_hi:[1,0]
  v_pk_mul_f32 v[72:73], v[240:241], v[72:73] neg_lo:[1,0] neg_hi:[1,0]
  v_pk_mul_f32 v[74:75], v[242:243], v[74:75] neg_lo:[1,0] neg_hi:[1,0]
  v_pk_mul_f32 v[76:77], v[244:245], v[76:77] neg_lo:[1,0] neg_hi:[1,0]
  v_pk_mul_f32 v[78:79], v[246:247], v[78:79] neg_lo:[1,0] neg_hi:[1,0]
  v_pk_mul_f32 v[32:33], v[32:33], v[56:57]
  v_pk_mul_f32 v[34:35], v[34:35], v[58:59]
  v_pk_mul_f32 v[36:37], v[36:37], v[60:61]
  v_pk_mul_f32 v[38:39], v[38:39], v[62:63]
  v_pk_mul_f32 v[40:41], v[40:41], v[48:49]
  v_pk_mul_f32 v[42:43], v[42:43], v[50:51]
  v_pk_mul_f32 v[44:45], v[44:45], v[52:53]
  v_pk_mul_f32 v[46:47], v[46:47], v[54:55]
  v_pk_mul_f32 v[48:49], v[48:49], v[56:57]
  v_pk_mul_f32 v[50:51], v[50:51], v[58:59]
  v_pk_mul_f32 v[52:53], v[52:53], v[60:61]
  v_pk_mul_f32 v[54:55], v[54:55], v[62:63]
  s_waitcnt lgkmcnt(0)
  v_mfma_f32_32x32x16_bf16 v[0:15], v[120:123], a[0:3], 0
  v_exp_f32 v64, v64
  v_exp_f32 v65, v65
  v_cvt_pk_bf16_f32 v112, v16, v17
  v_cvt_pk_bf16_f32 v113, v18, v19
  v_mfma_f32_32x32x16_bf16 v[0:15], v[124:127], a[4:7], v[0:15]
  v_exp_f32 v66, v66
  v_exp_f32 v67, v67
  v_cvt_pk_bf16_f32 v114, v20, v21
  v_cvt_pk_bf16_f32 v115, v22, v23
  v_mfma_f32_32x32x16_bf16 v[0:15], v[128:131], a[8:11], v[0:15]
  v_exp_f32 v68, v68
  v_exp_f32 v69, v69
  v_accvgpr_write_b32 a248, v112
  v_accvgpr_write_b32 a249, v113
  v_mfma_f32_32x32x16_bf16 v[0:15], v[132:135], a[12:15], v[0:15]
  v_exp_f32 v70, v70
  v_exp_f32 v71, v71
  v_accvgpr_write_b32 a250, v114
  v_accvgpr_write_b32 a251, v115
  v_mfma_f32_32x32x16_bf16 v[0:15], v[136:139], a[16:19], v[0:15]
  v_exp_f32 v72, v72
  v_exp_f32 v73, v73
  v_cvt_pk_bf16_f32 v116, v24, v25
  v_cvt_pk_bf16_f32 v117, v26, v27
  v_mfma_f32_32x32x16_bf16 v[0:15], v[140:143], a[20:23], v[0:15]
  v_exp_f32 v74, v74
  v_exp_f32 v75, v75
  v_cvt_pk_bf16_f32 v118, v28, v29
  v_cvt_pk_bf16_f32 v119, v30, v31
  v_mfma_f32_32x32x16_bf16 v[0:15], v[144:147], a[24:27], v[0:15]
  v_exp_f32 v76, v76
  v_exp_f32 v77, v77
  v_accvgpr_write_b32 a252, v116
  v_accvgpr_write_b32 a253, v117
  v_mfma_f32_32x32x16_bf16 v[0:15], v[148:151], a[28:31], v[0:15]
  buffer_load_dwordx4 a[128:131], v248, s[20:23], s67 offen offset:0 sc1
  v_exp_f32 v78, v78
  v_exp_f32 v79, v79
  v_accvgpr_write_b32 a254, v118
  v_mfma_f32_32x32x16_bf16 v[0:15], v[152:155], a[32:35], v[0:15]
  buffer_load_dwordx4 a[132:135], v248, s[20:23], s67 offen offset:1024 sc1
  v_rcp_f32 v48, v48
  v_rcp_f32 v49, v49
  v_accvgpr_write_b32 a255, v119
  v_mfma_f32_32x32x16_bf16 v[0:15], v[156:159], a[36:39], v[0:15]
  v_rcp_f32 v50, v50
  v_rcp_f32 v51, v51
  v_fma_f32 v64, v64, s60, s60 clamp
  v_fma_f32 v65, v65, s60, s60 clamp
  v_mfma_f32_32x32x16_bf16 v[0:15], v[160:163], a[40:43], v[0:15]
  buffer_load_dwordx4 a[136:139], v248, s[20:23], s67 offen offset:2048 sc1
  v_rcp_f32 v52, v52
  v_rcp_f32 v53, v53
  v_fma_f32 v66, v66, s60, s60 clamp
  v_mfma_f32_32x32x16_bf16 v[0:15], v[164:167], a[44:47], v[0:15]
  buffer_load_dwordx4 a[140:143], v248, s[20:23], s67 offen offset:3072 sc1
  v_rcp_f32 v54, v54
  v_rcp_f32_e64 v55, v55
  v_fma_f32 v67, v67, s60, s60 clamp
  v_fma_f32 v68, v68, s60, s60 clamp
  v_fma_f32 v69, v69, s60, s60 clamp
  v_fma_f32 v70, v70, s60, s60 clamp
  v_fma_f32 v71, v71, s60, s60 clamp
  v_pk_fma_f32 v[72:73], v[72:73], s[60:61], s[60:61] clamp
  v_pk_fma_f32 v[74:75], v[74:75], s[60:61], s[60:61] clamp
  v_pk_fma_f32 v[76:77], v[76:77], s[60:61], s[60:61] clamp
  v_pk_fma_f32 v[78:79], v[78:79], s[60:61], s[60:61] clamp
  v_pk_mul_f32 v[32:33], v[32:33], v[48:49]
  v_pk_mul_f32 v[34:35], v[34:35], v[50:51]
  v_pk_mul_f32 v[36:37], v[36:37], v[52:53]
  v_pk_mul_f32 v[38:39], v[38:39], v[54:55]
  v_pk_mul_f32 v[40:41], v[40:41], v[48:49]
  v_pk_mul_f32 v[42:43], v[42:43], v[50:51]
  v_pk_mul_f32 v[44:45], v[44:45], v[52:53]
  v_pk_mul_f32 v[46:47], v[46:47], v[54:55]
  v_pk_fma_f32 v[80:81], v[32:33], v[32:33], v[80:81]
  v_pk_fma_f32 v[82:83], v[34:35], v[34:35], v[82:83]
  v_pk_fma_f32 v[84:85], v[36:37], v[36:37], v[84:85]
  v_pk_fma_f32 v[86:87], v[38:39], v[38:39], v[86:87]
  v_pk_fma_f32 v[88:89], v[40:41], v[40:41], v[88:89]
  v_pk_fma_f32 v[90:91], v[42:43], v[42:43], v[90:91]
  v_pk_fma_f32 v[92:93], v[44:45], v[44:45], v[92:93]
  v_pk_fma_f32 v[94:95], v[46:47], v[46:47], v[94:95]
  v_pk_fma_f32 v[48:49], v[0:1], v[0:1], s[62:63]
  v_pk_fma_f32 v[50:51], v[2:3], v[2:3], s[62:63]
  v_pk_fma_f32 v[52:53], v[4:5], v[4:5], s[62:63]
  v_pk_fma_f32 v[54:55], v[6:7], v[6:7], s[62:63]
  v_pk_fma_f32 v[56:57], v[8:9], v[8:9], s[62:63]
  v_pk_fma_f32 v[58:59], v[10:11], v[10:11], s[62:63]
  v_pk_fma_f32 v[60:61], v[12:13], v[12:13], s[62:63]
  v_pk_fma_f32 v[62:63], v[14:15], v[14:15], s[62:63]
  v_pk_mul_f32 v[48:49], v[0:1], v[48:49] neg_lo:[1,0] neg_hi:[1,0]
  v_pk_mul_f32 v[50:51], v[2:3], v[50:51] neg_lo:[1,0] neg_hi:[1,0]
  v_pk_mul_f32 v[52:53], v[4:5], v[52:53] neg_lo:[1,0] neg_hi:[1,0]
  v_pk_mul_f32 v[54:55], v[6:7], v[54:55] neg_lo:[1,0] neg_hi:[1,0]
  v_pk_mul_f32 v[56:57], v[8:9], v[56:57] neg_lo:[1,0] neg_hi:[1,0]
  v_pk_mul_f32 v[58:59], v[10:11], v[58:59] neg_lo:[1,0] neg_hi:[1,0]
  v_pk_mul_f32 v[60:61], v[12:13], v[60:61] neg_lo:[1,0] neg_hi:[1,0]
  v_pk_mul_f32 v[62:63], v[14:15], v[62:63] neg_lo:[1,0] neg_hi:[1,0]
  v_pk_mul_f32 v[232:233], v[232:233], v[72:73]
  v_pk_mul_f32 v[234:235], v[234:235], v[74:75]
  v_pk_mul_f32 v[236:237], v[236:237], v[76:77]
  v_pk_mul_f32 v[238:239], v[238:239], v[78:79]
  v_pk_mul_f32 v[240:241], v[240:241], v[64:65]
  v_pk_mul_f32 v[242:243], v[242:243], v[66:67]
  v_pk_mul_f32 v[244:245], v[244:245], v[68:69]
  v_pk_mul_f32 v[246:247], v[246:247], v[70:71]
  v_pk_mul_f32 v[64:65], v[64:65], v[72:73]
  v_pk_mul_f32 v[66:67], v[66:67], v[74:75]
  v_pk_mul_f32 v[68:69], v[68:69], v[76:77]
  v_pk_mul_f32 v[70:71], v[70:71], v[78:79]
  v_mfma_f32_32x32x16_bf16 v[16:31], v[168:171], a[0:3], 0
  v_exp_f32 v48, v48
  v_exp_f32 v49, v49
  v_cvt_pk_bf16_f32 v216, v32, v33
  v_cvt_pk_bf16_f32 v217, v34, v35
  v_mfma_f32_32x32x16_bf16 v[16:31], v[172:175], a[4:7], v[16:31]
  ds_read_b128 a[0:3], v250 offset:26112
  v_exp_f32 v50, v50
  v_exp_f32 v51, v51
  v_cvt_pk_bf16_f32 v218, v36, v37
  v_mfma_f32_32x32x16_bf16 v[16:31], v[176:179], a[8:11], v[16:31]
  ds_read_b128 a[4:7], v250 offset:27136
  v_exp_f32 v52, v52
  v_exp_f32 v53, v53
  v_cvt_pk_bf16_f32 v219, v38, v39
  v_mfma_f32_32x32x16_bf16 v[16:31], v[180:183], a[12:15], v[16:31]
  ds_read_b128 a[8:11], v250 offset:28160
  v_exp_f32 v54, v54
  v_exp_f32 v55, v55
  v_cvt_pk_bf16_f32 v220, v40, v41
  v_mfma_f32_32x32x16_bf16 v[16:31], v[184:187], a[16:19], v[16:31]
  ds_read_b128 a[12:15], v250 offset:29184
  v_exp_f32 v56, v56
  v_exp_f32 v57, v57
  v_cvt_pk_bf16_f32 v221, v42, v43
  v_mfma_f32_32x32x16_bf16 v[16:31], v[188:191], a[20:23], v[16:31]
  ds_read_b128 a[16:19], v250 offset:30208
  v_exp_f32 v58, v58
  v_exp_f32 v59, v59
  v_cvt_pk_bf16_f32 v222, v44, v45
  v_mfma_f32_32x32x16_bf16 v[16:31], v[192:195], a[24:27], v[16:31]
  ds_read_b128 a[20:23], v250 offset:31232
  v_exp_f32 v60, v60
  v_exp_f32 v61, v61
  v_cvt_pk_bf16_f32 v223, v46, v47
  v_mfma_f32_32x32x16_bf16 v[16:31], v[196:199], a[28:31], v[16:31]
  ds_read_b128 a[24:27], v250 offset:32256
  v_exp_f32 v62, v62
  v_exp_f32 v63, v63
  v_fma_f32 v48, v48, s60, s60 clamp
  v_mfma_f32_32x32x16_bf16 v[16:31], v[200:203], a[32:35], v[16:31]
  ds_read_b128 a[28:31], v250 offset:33280
  v_rcp_f32 v64, v64
  v_rcp_f32 v65, v65
  v_fma_f32 v49, v49, s60, s60 clamp
  v_mfma_f32_32x32x16_bf16 v[16:31], v[204:207], a[36:39], v[16:31]
  ds_read_b128 a[32:35], v250 offset:34304
  v_rcp_f32 v66, v66
  v_rcp_f32 v67, v67
  v_fma_f32 v50, v50, s60, s60 clamp
  v_mfma_f32_32x32x16_bf16 v[16:31], v[208:211], a[40:43], v[16:31]
  ds_read_b128 a[36:39], v250 offset:35328
  v_rcp_f32 v68, v68
  v_rcp_f32 v69, v69
  v_fma_f32 v51, v51, s60, s60 clamp
  v_mfma_f32_32x32x16_bf16 v[16:31], v[212:215], a[44:47], v[16:31]
  ds_read_b128 a[40:43], v250 offset:36352
  ds_read_b128 a[44:47], v250 offset:37376
  v_rcp_f32 v70, v70
  v_rcp_f32 v71, v71
  v_fma_f32 v52, v52, s60, s60 clamp
  v_fma_f32 v53, v53, s60, s60 clamp
  v_fma_f32 v54, v54, s60, s60 clamp
  v_fma_f32 v55, v55, s60, s60 clamp
  v_pk_fma_f32 v[56:57], v[56:57], s[60:61], s[60:61] clamp
  v_pk_fma_f32 v[58:59], v[58:59], s[60:61], s[60:61] clamp
  v_pk_fma_f32 v[60:61], v[60:61], s[60:61], s[60:61] clamp
  v_pk_fma_f32 v[62:63], v[62:63], s[60:61], s[60:61] clamp
  v_pk_mul_f32 v[232:233], v[232:233], v[64:65]
  v_pk_mul_f32 v[234:235], v[234:235], v[66:67]
  v_pk_mul_f32 v[236:237], v[236:237], v[68:69]
  v_pk_mul_f32 v[238:239], v[238:239], v[70:71]
  v_pk_mul_f32 v[240:241], v[240:241], v[64:65]
  v_pk_mul_f32 v[242:243], v[242:243], v[66:67]
  v_pk_mul_f32 v[244:245], v[244:245], v[68:69]
  v_pk_mul_f32 v[246:247], v[246:247], v[70:71]
  v_pk_fma_f32 v[96:97], v[232:233], v[232:233], v[96:97]
  v_pk_fma_f32 v[98:99], v[234:235], v[234:235], v[98:99]
  v_pk_fma_f32 v[100:101], v[236:237], v[236:237], v[100:101]
  v_pk_fma_f32 v[102:103], v[238:239], v[238:239], v[102:103]
  v_pk_fma_f32 v[104:105], v[240:241], v[240:241], v[104:105]
  v_pk_fma_f32 v[106:107], v[242:243], v[242:243], v[106:107]
  v_pk_fma_f32 v[108:109], v[244:245], v[244:245], v[108:109]
  v_pk_fma_f32 v[110:111], v[246:247], v[246:247], v[110:111]
  v_pk_fma_f32 v[64:65], v[16:17], v[16:17], s[62:63]
  v_pk_fma_f32 v[66:67], v[18:19], v[18:19], s[62:63]
  v_pk_fma_f32 v[68:69], v[20:21], v[20:21], s[62:63]
  v_pk_fma_f32 v[70:71], v[22:23], v[22:23], s[62:63]
  v_pk_fma_f32 v[72:73], v[24:25], v[24:25], s[62:63]
  v_pk_fma_f32 v[74:75], v[26:27], v[26:27], s[62:63]
  v_pk_fma_f32 v[76:77], v[28:29], v[28:29], s[62:63]
  v_pk_fma_f32 v[78:79], v[30:31], v[30:31], s[62:63]
  v_pk_mul_f32 v[64:65], v[16:17], v[64:65] neg_lo:[1,0] neg_hi:[1,0]
  v_pk_mul_f32 v[66:67], v[18:19], v[66:67] neg_lo:[1,0] neg_hi:[1,0]
  v_pk_mul_f32 v[68:69], v[20:21], v[68:69] neg_lo:[1,0] neg_hi:[1,0]
  v_pk_mul_f32 v[70:71], v[22:23], v[70:71] neg_lo:[1,0] neg_hi:[1,0]
  v_pk_mul_f32 v[72:73], v[24:25], v[72:73] neg_lo:[1,0] neg_hi:[1,0]
  v_pk_mul_f32 v[74:75], v[26:27], v[74:75] neg_lo:[1,0] neg_hi:[1,0]
  v_pk_mul_f32 v[76:77], v[28:29], v[76:77] neg_lo:[1,0] neg_hi:[1,0]
  v_pk_mul_f32 v[78:79], v[30:31], v[78:79] neg_lo:[1,0] neg_hi:[1,0]
  v_pk_mul_f32 v[0:1], v[0:1], v[56:57]
  v_pk_mul_f32 v[2:3], v[2:3], v[58:59]
  v_pk_mul_f32 v[4:5], v[4:5], v[60:61]
  v_pk_mul_f32 v[6:7], v[6:7], v[62:63]
  v_pk_mul_f32 v[8:9], v[8:9], v[48:49]
  v_pk_mul_f32 v[10:11], v[10:11], v[50:51]
  v_pk_mul_f32 v[12:13], v[12:13], v[52:53]
  v_pk_mul_f32 v[14:15], v[14:15], v[54:55]
  v_pk_mul_f32 v[48:49], v[48:49], v[56:57]
  v_pk_mul_f32 v[50:51], v[50:51], v[58:59]
  v_pk_mul_f32 v[52:53], v[52:53], v[60:61]
  v_pk_mul_f32 v[54:55], v[54:55], v[62:63]
  s_waitcnt lgkmcnt(0)
  v_mfma_f32_32x32x16_bf16 v[32:47], v[120:123], a[0:3], 0
  v_exp_f32 v64, v64
  v_exp_f32 v65, v65
  v_cvt_pk_bf16_f32 v224, v232, v233
  v_cvt_pk_bf16_f32 v225, v234, v235
  v_mfma_f32_32x32x16_bf16 v[32:47], v[124:127], a[4:7], v[32:47]
  v_exp_f32 v66, v66
  v_exp_f32 v67, v67
  v_cvt_pk_bf16_f32 v226, v236, v237
  v_cvt_pk_bf16_f32 v227, v238, v239
  v_mfma_f32_32x32x16_bf16 v[32:47], v[128:131], a[8:11], v[32:47]
  v_exp_f32 v68, v68
  v_exp_f32 v69, v69
  v_cvt_pk_bf16_f32 v228, v240, v241
  v_cvt_pk_bf16_f32 v229, v242, v243
  v_mfma_f32_32x32x16_bf16 v[32:47], v[132:135], a[12:15], v[32:47]
  v_exp_f32 v70, v70
  v_exp_f32 v71, v71
  v_cvt_pk_bf16_f32 v230, v244, v245
  v_cvt_pk_bf16_f32 v231, v246, v247
  v_mfma_f32_32x32x16_bf16 v[32:47], v[136:139], a[16:19], v[32:47]
  v_exp_f32 v72, v72
  v_exp_f32 v73, v73
  v_fma_f32 v64, v64, s60, s60 clamp
  v_fma_f32 v65, v65, s60, s60 clamp
  v_mfma_f32_32x32x16_bf16 v[32:47], v[140:143], a[20:23], v[32:47]
  v_exp_f32 v74, v74
  v_exp_f32 v75, v75
  v_fma_f32 v66, v66, s60, s60 clamp
  v_fma_f32 v67, v67, s60, s60 clamp
  v_mfma_f32_32x32x16_bf16 v[32:47], v[144:147], a[24:27], v[32:47]
  v_exp_f32 v76, v76
  v_exp_f32 v77, v77
  v_fma_f32 v68, v68, s60, s60 clamp
  v_fma_f32 v69, v69, s60, s60 clamp
  v_mfma_f32_32x32x16_bf16 v[32:47], v[148:151], a[28:31], v[32:47]
  v_exp_f32 v78, v78
  v_exp_f32 v79, v79
  v_fma_f32 v70, v70, s60, s60 clamp
  v_fma_f32 v71, v71, s60, s60 clamp
  v_mfma_f32_32x32x16_bf16 v[32:47], v[152:155], a[32:35], v[32:47]
  v_rcp_f32 v48, v48
  v_rcp_f32 v49, v49
  v_fma_f32 v72, v72, s60, s60 clamp
  v_fma_f32 v73, v73, s60, s60 clamp
  v_mfma_f32_32x32x16_bf16 v[32:47], v[156:159], a[36:39], v[32:47]
  v_rcp_f32 v50, v50
  v_rcp_f32 v51, v51
  v_fma_f32 v74, v74, s60, s60 clamp
  v_fma_f32 v75, v75, s60, s60 clamp
  v_mfma_f32_32x32x16_bf16 v[32:47], v[160:163], a[40:43], v[32:47]
  v_rcp_f32 v52, v52
  v_rcp_f32 v53, v53
  v_fma_f32 v76, v76, s60, s60 clamp
  v_fma_f32 v77, v77, s60, s60 clamp
  v_mfma_f32_32x32x16_bf16 v[32:47], v[164:167], a[44:47], v[32:47]
  v_rcp_f32 v54, v54
  v_rcp_f32_e64 v55, v55
  v_fma_f32 v78, v78, s60, s60 clamp
  v_fma_f32 v79, v79, s60, s60 clamp
  v_pk_mul_f32 v[0:1], v[0:1], v[48:49]
  v_pk_mul_f32 v[2:3], v[2:3], v[50:51]
  v_pk_mul_f32 v[4:5], v[4:5], v[52:53]
  v_pk_mul_f32 v[6:7], v[6:7], v[54:55]
  v_pk_mul_f32 v[8:9], v[8:9], v[48:49]
  v_pk_mul_f32 v[10:11], v[10:11], v[50:51]
  v_pk_mul_f32 v[12:13], v[12:13], v[52:53]
  v_pk_mul_f32 v[14:15], v[14:15], v[54:55]
  v_pk_fma_f32 v[80:81], v[0:1], v[0:1], v[80:81]
  v_pk_fma_f32 v[82:83], v[2:3], v[2:3], v[82:83]
  v_pk_fma_f32 v[84:85], v[4:5], v[4:5], v[84:85]
  v_pk_fma_f32 v[86:87], v[6:7], v[6:7], v[86:87]
  v_pk_fma_f32 v[88:89], v[8:9], v[8:9], v[88:89]
  v_pk_fma_f32 v[90:91], v[10:11], v[10:11], v[90:91]
  v_pk_fma_f32 v[92:93], v[12:13], v[12:13], v[92:93]
  v_pk_fma_f32 v[94:95], v[14:15], v[14:15], v[94:95]
  v_pk_fma_f32 v[48:49], v[32:33], v[32:33], s[62:63]
  v_pk_fma_f32 v[50:51], v[34:35], v[34:35], s[62:63]
  v_pk_fma_f32 v[52:53], v[36:37], v[36:37], s[62:63]
  v_pk_fma_f32 v[54:55], v[38:39], v[38:39], s[62:63]
  v_pk_fma_f32 v[56:57], v[40:41], v[40:41], s[62:63]
  v_pk_fma_f32 v[58:59], v[42:43], v[42:43], s[62:63]
  v_pk_fma_f32 v[60:61], v[44:45], v[44:45], s[62:63]
  v_pk_fma_f32 v[62:63], v[46:47], v[46:47], s[62:63]
  v_pk_mul_f32 v[48:49], v[32:33], v[48:49] neg_lo:[1,0] neg_hi:[1,0]
  v_pk_mul_f32 v[50:51], v[34:35], v[50:51] neg_lo:[1,0] neg_hi:[1,0]
  v_pk_mul_f32 v[52:53], v[36:37], v[52:53] neg_lo:[1,0] neg_hi:[1,0]
  v_pk_mul_f32 v[54:55], v[38:39], v[54:55] neg_lo:[1,0] neg_hi:[1,0]
  v_pk_mul_f32 v[56:57], v[40:41], v[56:57] neg_lo:[1,0] neg_hi:[1,0]
  v_pk_mul_f32 v[58:59], v[42:43], v[58:59] neg_lo:[1,0] neg_hi:[1,0]
  v_pk_mul_f32 v[60:61], v[44:45], v[60:61] neg_lo:[1,0] neg_hi:[1,0]
  v_pk_mul_f32 v[62:63], v[46:47], v[62:63] neg_lo:[1,0] neg_hi:[1,0]
  v_pk_mul_f32 v[16:17], v[16:17], v[72:73]
  v_pk_mul_f32 v[18:19], v[18:19], v[74:75]
  v_pk_mul_f32 v[20:21], v[20:21], v[76:77]
  v_pk_mul_f32 v[22:23], v[22:23], v[78:79]
  v_pk_mul_f32 v[24:25], v[24:25], v[64:65]
  v_pk_mul_f32 v[26:27], v[26:27], v[66:67]
  v_pk_mul_f32 v[28:29], v[28:29], v[68:69]
  v_pk_mul_f32 v[30:31], v[30:31], v[70:71]
  v_pk_mul_f32 v[64:65], v[64:65], v[72:73]
  v_pk_mul_f32 v[66:67], v[66:67], v[74:75]
  v_pk_mul_f32 v[68:69], v[68:69], v[76:77]
  v_pk_mul_f32 v[70:71], v[70:71], v[78:79]
  v_mfma_f32_32x32x16_bf16 v[232:247], v[168:171], a[0:3], 0
  v_exp_f32 v48, v48
  v_exp_f32 v49, v49
  v_cvt_pk_bf16_f32 v120, v0, v1
  v_cvt_pk_bf16_f32 v121, v2, v3
  v_mfma_f32_32x32x16_bf16 v[232:247], v[172:175], a[4:7], v[232:247]
  ds_read_b128 a[0:3], v249 offset:0
  v_exp_f32 v50, v50
  v_exp_f32 v51, v51
  v_cvt_pk_bf16_f32 v122, v4, v5
  v_mfma_f32_32x32x16_bf16 v[232:247], v[176:179], a[8:11], v[232:247]
  ds_read_b128 a[4:7], v249 offset:1024
  v_exp_f32 v52, v52
  v_exp_f32 v53, v53
  v_cvt_pk_bf16_f32 v123, v6, v7
  v_mfma_f32_32x32x16_bf16 v[232:247], v[180:183], a[12:15], v[232:247]
  ds_read_b128 a[8:11], v249 offset:2048
  v_exp_f32 v54, v54
  v_exp_f32 v55, v55
  v_cvt_pk_bf16_f32 v124, v8, v9
  v_mfma_f32_32x32x16_bf16 v[232:247], v[184:187], a[16:19], v[232:247]
  ds_read_b128 a[12:15], v249 offset:3072
  v_exp_f32 v56, v56
  v_exp_f32 v57, v57
  v_cvt_pk_bf16_f32 v125, v10, v11
  v_mfma_f32_32x32x16_bf16 v[232:247], v[188:191], a[20:23], v[232:247]
  ds_read_b128 a[16:19], v249 offset:4096
  v_exp_f32 v58, v58
  v_exp_f32 v59, v59
  v_cvt_pk_bf16_f32 v126, v12, v13
  v_mfma_f32_32x32x16_bf16 v[232:247], v[192:195], a[24:27], v[232:247]
  ds_read_b128 a[20:23], v249 offset:5120
  v_exp_f32 v60, v60
  v_exp_f32 v61, v61
  v_cvt_pk_bf16_f32 v127, v14, v15
  v_mfma_f32_32x32x16_bf16 v[232:247], v[196:199], a[28:31], v[232:247]
  ds_read_b128 a[24:27], v249 offset:6144
  v_exp_f32 v62, v62
  v_exp_f32 v63, v63
  v_fma_f32 v48, v48, s60, s60 clamp
  v_mfma_f32_32x32x16_bf16 v[232:247], v[200:203], a[32:35], v[232:247]
  ds_read_b128 a[28:31], v249 offset:7168
  v_rcp_f32 v64, v64
  v_rcp_f32 v65, v65
  v_fma_f32 v49, v49, s60, s60 clamp
  v_mfma_f32_32x32x16_bf16 v[232:247], v[204:207], a[36:39], v[232:247]
  ds_read_b128 a[32:35], v249 offset:8192
  v_rcp_f32 v66, v66
  v_rcp_f32 v67, v67
  v_fma_f32 v50, v50, s60, s60 clamp
  v_mfma_f32_32x32x16_bf16 v[232:247], v[208:211], a[40:43], v[232:247]
  ds_read_b128 a[36:39], v249 offset:9216
  v_rcp_f32 v68, v68
  v_rcp_f32 v69, v69
  v_fma_f32 v51, v51, s60, s60 clamp
  v_mfma_f32_32x32x16_bf16 v[232:247], v[212:215], a[44:47], v[232:247]
  ds_read_b128 a[40:43], v249 offset:10240
  ds_read_b128 a[44:47], v249 offset:11264
  v_rcp_f32 v70, v70
  v_rcp_f32 v71, v71
  v_fma_f32 v52, v52, s60, s60 clamp
  v_fma_f32 v53, v53, s60, s60 clamp
  v_fma_f32 v54, v54, s60, s60 clamp
  v_fma_f32 v55, v55, s60, s60 clamp
  v_pk_fma_f32 v[56:57], v[56:57], s[60:61], s[60:61] clamp
  v_pk_fma_f32 v[58:59], v[58:59], s[60:61], s[60:61] clamp
  v_pk_fma_f32 v[60:61], v[60:61], s[60:61], s[60:61] clamp
  v_pk_fma_f32 v[62:63], v[62:63], s[60:61], s[60:61] clamp
  v_pk_mul_f32 v[16:17], v[16:17], v[64:65]
  v_pk_mul_f32 v[18:19], v[18:19], v[66:67]
  v_pk_mul_f32 v[20:21], v[20:21], v[68:69]
  v_pk_mul_f32 v[22:23], v[22:23], v[70:71]
  v_pk_mul_f32 v[24:25], v[24:25], v[64:65]
  v_pk_mul_f32 v[26:27], v[26:27], v[66:67]
  v_pk_mul_f32 v[28:29], v[28:29], v[68:69]
  v_pk_mul_f32 v[30:31], v[30:31], v[70:71]
  v_pk_fma_f32 v[96:97], v[16:17], v[16:17], v[96:97]
  v_pk_fma_f32 v[98:99], v[18:19], v[18:19], v[98:99]
  v_pk_fma_f32 v[100:101], v[20:21], v[20:21], v[100:101]
  v_pk_fma_f32 v[102:103], v[22:23], v[22:23], v[102:103]
  v_pk_fma_f32 v[104:105], v[24:25], v[24:25], v[104:105]
  v_pk_fma_f32 v[106:107], v[26:27], v[26:27], v[106:107]
  v_pk_fma_f32 v[108:109], v[28:29], v[28:29], v[108:109]
  v_pk_fma_f32 v[110:111], v[30:31], v[30:31], v[110:111]
  v_pk_fma_f32 v[64:65], v[232:233], v[232:233], s[62:63]
  v_pk_fma_f32 v[66:67], v[234:235], v[234:235], s[62:63]
  v_pk_fma_f32 v[68:69], v[236:237], v[236:237], s[62:63]
  v_pk_fma_f32 v[70:71], v[238:239], v[238:239], s[62:63]
  v_pk_fma_f32 v[72:73], v[240:241], v[240:241], s[62:63]
  v_pk_fma_f32 v[74:75], v[242:243], v[242:243], s[62:63]
  v_pk_fma_f32 v[76:77], v[244:245], v[244:245], s[62:63]
  v_pk_fma_f32 v[78:79], v[246:247], v[246:247], s[62:63]
  v_pk_mul_f32 v[64:65], v[232:233], v[64:65] neg_lo:[1,0] neg_hi:[1,0]
  v_pk_mul_f32 v[66:67], v[234:235], v[66:67] neg_lo:[1,0] neg_hi:[1,0]
  v_pk_mul_f32 v[68:69], v[236:237], v[68:69] neg_lo:[1,0] neg_hi:[1,0]
  v_pk_mul_f32 v[70:71], v[238:239], v[70:71] neg_lo:[1,0] neg_hi:[1,0]
  v_pk_mul_f32 v[72:73], v[240:241], v[72:73] neg_lo:[1,0] neg_hi:[1,0]
  v_pk_mul_f32 v[74:75], v[242:243], v[74:75] neg_lo:[1,0] neg_hi:[1,0]
  v_pk_mul_f32 v[76:77], v[244:245], v[76:77] neg_lo:[1,0] neg_hi:[1,0]
  v_pk_mul_f32 v[78:79], v[246:247], v[78:79] neg_lo:[1,0] neg_hi:[1,0]
  v_pk_mul_f32 v[32:33], v[32:33], v[56:57]
  v_pk_mul_f32 v[34:35], v[34:35], v[58:59]
  v_pk_mul_f32 v[36:37], v[36:37], v[60:61]
  v_pk_mul_f32 v[38:39], v[38:39], v[62:63]
  v_pk_mul_f32 v[40:41], v[40:41], v[48:49]
  v_pk_mul_f32 v[42:43], v[42:43], v[50:51]
  v_pk_mul_f32 v[44:45], v[44:45], v[52:53]
  v_pk_mul_f32 v[46:47], v[46:47], v[54:55]
  v_pk_mul_f32 v[48:49], v[48:49], v[56:57]
  v_pk_mul_f32 v[50:51], v[50:51], v[58:59]
  v_pk_mul_f32 v[52:53], v[52:53], v[60:61]
  v_pk_mul_f32 v[54:55], v[54:55], v[62:63]
  s_waitcnt lgkmcnt(0)
  s_waitcnt vmcnt(15)
  v_mfma_f32_32x32x16_bf16 v[0:15], a[48:51], a[0:3], 0
  v_exp_f32 v64, v64
  v_exp_f32 v65, v65
  v_cvt_pk_bf16_f32 v128, v16, v17
  v_cvt_pk_bf16_f32 v129, v18, v19
  v_mfma_f32_32x32x16_bf16 v[0:15], a[52:55], a[4:7], v[0:15]
  v_exp_f32 v66, v66
  v_exp_f32 v67, v67
  v_cvt_pk_bf16_f32 v130, v20, v21
  v_cvt_pk_bf16_f32 v131, v22, v23
  v_mfma_f32_32x32x16_bf16 v[0:15], a[56:59], a[8:11], v[0:15]
  v_exp_f32 v68, v68
  v_exp_f32 v69, v69
  v_cvt_pk_bf16_f32 v132, v24, v25
  v_cvt_pk_bf16_f32 v133, v26, v27
  v_mfma_f32_32x32x16_bf16 v[0:15], a[60:63], a[12:15], v[0:15]
  v_exp_f32 v70, v70
  v_exp_f32 v71, v71
  v_cvt_pk_bf16_f32 v134, v28, v29
  v_cvt_pk_bf16_f32 v135, v30, v31
  v_mfma_f32_32x32x16_bf16 v[0:15], a[64:67], a[16:19], v[0:15]
  v_exp_f32 v72, v72
  v_exp_f32 v73, v73
  v_fma_f32 v64, v64, s60, s60 clamp
  v_fma_f32 v65, v65, s60, s60 clamp
  v_mfma_f32_32x32x16_bf16 v[0:15], a[68:71], a[20:23], v[0:15]
  v_exp_f32 v74, v74
  v_exp_f32 v75, v75
  v_fma_f32 v66, v66, s60, s60 clamp
  v_fma_f32 v67, v67, s60, s60 clamp
  v_mfma_f32_32x32x16_bf16 v[0:15], a[72:75], a[24:27], v[0:15]
  v_exp_f32 v76, v76
  v_exp_f32 v77, v77
  v_fma_f32 v68, v68, s60, s60 clamp
  v_fma_f32 v69, v69, s60, s60 clamp
  v_mfma_f32_32x32x16_bf16 v[0:15], a[76:79], a[28:31], v[0:15]
  v_exp_f32 v78, v78
  v_exp_f32 v79, v79
  v_fma_f32 v70, v70, s60, s60 clamp
  v_fma_f32 v71, v71, s60, s60 clamp
  v_mfma_f32_32x32x16_bf16 v[0:15], a[80:83], a[32:35], v[0:15]
  v_rcp_f32 v48, v48
  v_rcp_f32 v49, v49
  v_fma_f32 v72, v72, s60, s60 clamp
  v_fma_f32 v73, v73, s60, s60 clamp
  v_mfma_f32_32x32x16_bf16 v[0:15], a[84:87], a[36:39], v[0:15]
  v_rcp_f32 v50, v50
  v_rcp_f32 v51, v51
  v_fma_f32 v74, v74, s60, s60 clamp
  v_fma_f32 v75, v75, s60, s60 clamp
  v_mfma_f32_32x32x16_bf16 v[0:15], a[88:91], a[40:43], v[0:15]
  v_rcp_f32 v52, v52
  v_rcp_f32 v53, v53
  v_fma_f32 v76, v76, s60, s60 clamp
  v_fma_f32 v77, v77, s60, s60 clamp
  v_mfma_f32_32x32x16_bf16 v[0:15], a[92:95], a[44:47], v[0:15]
  v_rcp_f32 v54, v54
  v_rcp_f32 v55, v55
  v_fma_f32 v78, v78, s60, s60 clamp
  v_fma_f32 v79, v79, s60, s60 clamp
  v_pk_mul_f32 v[32:33], v[32:33], v[48:49]
  v_pk_mul_f32 v[34:35], v[34:35], v[50:51]
  v_pk_mul_f32 v[36:37], v[36:37], v[52:53]
  v_pk_mul_f32 v[38:39], v[38:39], v[54:55]
  v_pk_mul_f32 v[40:41], v[40:41], v[48:49]
  v_pk_mul_f32 v[42:43], v[42:43], v[50:51]
  v_pk_mul_f32 v[44:45], v[44:45], v[52:53]
  v_pk_mul_f32 v[46:47], v[46:47], v[54:55]
  v_pk_fma_f32 v[80:81], v[32:33], v[32:33], v[80:81]
  v_pk_fma_f32 v[82:83], v[34:35], v[34:35], v[82:83]
  v_pk_fma_f32 v[84:85], v[36:37], v[36:37], v[84:85]
  v_pk_fma_f32 v[86:87], v[38:39], v[38:39], v[86:87]
  v_pk_fma_f32 v[88:89], v[40:41], v[40:41], v[88:89]
  v_pk_fma_f32 v[90:91], v[42:43], v[42:43], v[90:91]
  v_pk_fma_f32 v[92:93], v[44:45], v[44:45], v[92:93]
  v_pk_fma_f32 v[94:95], v[46:47], v[46:47], v[94:95]
  v_pk_fma_f32 v[48:49], v[0:1], v[0:1], s[62:63]
  v_pk_fma_f32 v[50:51], v[2:3], v[2:3], s[62:63]
  v_pk_fma_f32 v[52:53], v[4:5], v[4:5], s[62:63]
  v_pk_fma_f32 v[54:55], v[6:7], v[6:7], s[62:63]
  v_pk_fma_f32 v[56:57], v[8:9], v[8:9], s[62:63]
  v_pk_fma_f32 v[58:59], v[10:11], v[10:11], s[62:63]
  v_pk_fma_f32 v[60:61], v[12:13], v[12:13], s[62:63]
  v_pk_fma_f32 v[62:63], v[14:15], v[14:15], s[62:63]
  v_pk_mul_f32 v[48:49], v[0:1], v[48:49] neg_lo:[1,0] neg_hi:[1,0]
  v_pk_mul_f32 v[50:51], v[2:3], v[50:51] neg_lo:[1,0] neg_hi:[1,0]
  v_pk_mul_f32 v[52:53], v[4:5], v[52:53] neg_lo:[1,0] neg_hi:[1,0]
  v_pk_mul_f32 v[54:55], v[6:7], v[54:55] neg_lo:[1,0] neg_hi:[1,0]
  v_pk_mul_f32 v[56:57], v[8:9], v[56:57] neg_lo:[1,0] neg_hi:[1,0]
  v_pk_mul_f32 v[58:59], v[10:11], v[58:59] neg_lo:[1,0] neg_hi:[1,0]
  v_pk_mul_f32 v[60:61], v[12:13], v[60:61] neg_lo:[1,0] neg_hi:[1,0]
  v_pk_mul_f32 v[62:63], v[14:15], v[62:63] neg_lo:[1,0] neg_hi:[1,0]
  v_pk_mul_f32 v[232:233], v[232:233], v[72:73]
  v_pk_mul_f32 v[234:235], v[234:235], v[74:75]
  v_pk_mul_f32 v[236:237], v[236:237], v[76:77]
  v_pk_mul_f32 v[238:239], v[238:239], v[78:79]
  v_pk_mul_f32 v[240:241], v[240:241], v[64:65]
  v_pk_mul_f32 v[242:243], v[242:243], v[66:67]
  v_pk_mul_f32 v[244:245], v[244:245], v[68:69]
  v_pk_mul_f32 v[246:247], v[246:247], v[70:71]
  v_pk_mul_f32 v[64:65], v[64:65], v[72:73]
  v_pk_mul_f32 v[66:67], v[66:67], v[74:75]
  v_pk_mul_f32 v[68:69], v[68:69], v[76:77]
  v_pk_mul_f32 v[70:71], v[70:71], v[78:79]
  v_permlane16_swap_b32 v80, v88
  v_permlane16_swap_b32 v81, v89
  v_permlane16_swap_b32 v82, v90
  v_permlane16_swap_b32 v83, v91
  v_permlane16_swap_b32 v84, v92
  v_permlane16_swap_b32 v85, v93
  v_permlane16_swap_b32 v86, v94
  v_permlane16_swap_b32 v87, v95
  v_pk_add_f32 v[80:81], v[80:81], v[88:89]
  v_pk_add_f32 v[82:83], v[82:83], v[90:91]
  v_pk_add_f32 v[84:85], v[84:85], v[92:93]
  v_pk_add_f32 v[86:87], v[86:87], v[94:95]
  s_waitcnt vmcnt(0)
  v_mfma_f32_32x32x16_bf16 v[16:31], a[96:99], a[0:3], 0
  v_exp_f32 v48, v48
  v_exp_f32 v49, v49
  v_cvt_pk_bf16_f32 v136, v32, v33
  v_cvt_pk_bf16_f32 v137, v34, v35
  v_add_f32_dpp v80, v80, v80 row_ror:8 row_mask:0xf bank_mask:0x3
  v_mfma_f32_32x32x16_bf16 v[16:31], a[100:103], a[4:7], v[16:31]
  ds_read_b128 a[0:3], v249 offset:13056
  v_exp_f32 v50, v50
  v_exp_f32 v51, v51
  v_cvt_pk_bf16_f32 v138, v36, v37
  v_add_f32_dpp v81, v81, v81 row_ror:8 row_mask:0xf bank_mask:0x3
  v_mfma_f32_32x32x16_bf16 v[16:31], a[104:107], a[8:11], v[16:31]
  ds_read_b128 a[4:7], v249 offset:14080
  v_exp_f32 v52, v52
  v_exp_f32 v53, v53
  v_cvt_pk_bf16_f32 v139, v38, v39
  v_add_f32_dpp v82, v82, v82 row_ror:8 row_mask:0xf bank_mask:0x3
  v_mfma_f32_32x32x16_bf16 v[16:31], a[108:111], a[12:15], v[16:31]
  ds_read_b128 a[8:11], v249 offset:15104
  v_exp_f32 v54, v54
  v_exp_f32 v55, v55
  v_cvt_pk_bf16_f32 v140, v40, v41
  v_add_f32_dpp v83, v83, v83 row_ror:8 row_mask:0xf bank_mask:0x3
  v_mfma_f32_32x32x16_bf16 v[16:31], a[112:115], a[16:19], v[16:31]
  ds_read_b128 a[12:15], v249 offset:16128
  v_exp_f32 v56, v56
  v_exp_f32 v57, v57
  v_cvt_pk_bf16_f32 v141, v42, v43
  v_add_f32_dpp v80, v84, v84 row_ror:8 row_mask:0xf bank_mask:0xc
  v_mfma_f32_32x32x16_bf16 v[16:31], a[116:119], a[20:23], v[16:31]
  ds_read_b128 a[16:19], v249 offset:17152
  v_exp_f32 v58, v58
  v_exp_f32 v59, v59
  v_cvt_pk_bf16_f32 v142, v44, v45
  v_add_f32_dpp v81, v85, v85 row_ror:8 row_mask:0xf bank_mask:0xc
  v_mfma_f32_32x32x16_bf16 v[16:31], a[120:123], a[24:27], v[16:31]
  ds_read_b128 a[20:23], v249 offset:18176
  v_exp_f32 v60, v60
  v_exp_f32 v61, v61
  v_cvt_pk_bf16_f32 v143, v46, v47
  v_add_f32_dpp v82, v86, v86 row_ror:8 row_mask:0xf bank_mask:0xc
  v_mfma_f32_32x32x16_bf16 v[16:31], a[124:127], a[28:31], v[16:31]
  ds_read_b128 a[24:27], v249 offset:19200
  v_exp_f32 v62, v62
  v_exp_f32 v63, v63
  v_add_f32_dpp v83, v87, v87 row_ror:8 row_mask:0xf bank_mask:0xc
  v_mfma_f32_32x32x16_bf16 v[16:31], a[128:131], a[32:35], v[16:31]
  ds_read_b128 a[28:31], v249 offset:20224
  v_rcp_f32 v64, v64
  v_rcp_f32 v65, v65
  v_add_f32_dpp v80, v80, v80 row_half_mirror row_mask:0xf bank_mask:0x5
  v_mfma_f32_32x32x16_bf16 v[16:31], a[132:135], a[36:39], v[16:31]
  ds_read_b128 a[32:35], v249 offset:21248
  v_rcp_f32 v66, v66
  v_rcp_f32 v67, v67
  v_add_f32_dpp v81, v81, v81 row_half_mirror row_mask:0xf bank_mask:0x5
  v_mfma_f32_32x32x16_bf16 v[16:31], a[136:139], a[40:43], v[16:31]
  ds_read_b128 a[36:39], v249 offset:22272
  v_rcp_f32 v68, v68
  v_rcp_f32 v69, v69
  v_add_f32_dpp v80, v82, v82 row_half_mirror row_mask:0xf bank_mask:0xa
  v_mfma_f32_32x32x16_bf16 v[16:31], a[140:143], a[44:47], v[16:31]
  ds_read_b128 a[40:43], v249 offset:23296
  ds_read_b128 a[44:47], v249 offset:24320
  v_rcp_f32 v70, v70
  v_rcp_f32_e64 v71, v71
  v_add_f32_dpp v81, v83, v83 row_half_mirror row_mask:0xf bank_mask:0xa
  v_fma_f32 v48, v48, s60, s60 clamp
  v_fma_f32 v49, v49, s60, s60 clamp
  v_pk_fma_f32 v[50:51], v[50:51], s[60:61], s[60:61] clamp
  v_pk_fma_f32 v[52:53], v[52:53], s[60:61], s[60:61] clamp
  v_pk_fma_f32 v[54:55], v[54:55], s[60:61], s[60:61] clamp
  v_pk_fma_f32 v[56:57], v[56:57], s[60:61], s[60:61] clamp
  v_pk_fma_f32 v[58:59], v[58:59], s[60:61], s[60:61] clamp
  v_pk_fma_f32 v[60:61], v[60:61], s[60:61], s[60:61] clamp
  v_pk_fma_f32 v[62:63], v[62:63], s[60:61], s[60:61] clamp
  v_pk_mul_f32 v[232:233], v[232:233], v[64:65]
  v_pk_mul_f32 v[234:235], v[234:235], v[66:67]
  v_pk_mul_f32 v[236:237], v[236:237], v[68:69]
  v_pk_mul_f32 v[238:239], v[238:239], v[70:71]
  v_pk_mul_f32 v[240:241], v[240:241], v[64:65]
  v_pk_mul_f32 v[242:243], v[242:243], v[66:67]
  v_pk_mul_f32 v[244:245], v[244:245], v[68:69]
  v_pk_mul_f32 v[246:247], v[246:247], v[70:71]
  v_pk_fma_f32 v[96:97], v[232:233], v[232:233], v[96:97]
  v_pk_fma_f32 v[98:99], v[234:235], v[234:235], v[98:99]
  v_pk_fma_f32 v[100:101], v[236:237], v[236:237], v[100:101]
  v_pk_fma_f32 v[102:103], v[238:239], v[238:239], v[102:103]
  v_pk_fma_f32 v[104:105], v[240:241], v[240:241], v[104:105]
  v_pk_fma_f32 v[106:107], v[242:243], v[242:243], v[106:107]
  v_pk_fma_f32 v[108:109], v[244:245], v[244:245], v[108:109]
  v_pk_fma_f32 v[110:111], v[246:247], v[246:247], v[110:111]
  v_pk_fma_f32 v[64:65], v[16:17], v[16:17], s[62:63]
  v_pk_fma_f32 v[66:67], v[18:19], v[18:19], s[62:63]
  v_pk_fma_f32 v[68:69], v[20:21], v[20:21], s[62:63]
  v_pk_fma_f32 v[70:71], v[22:23], v[22:23], s[62:63]
  v_pk_fma_f32 v[72:73], v[24:25], v[24:25], s[62:63]
  v_pk_fma_f32 v[74:75], v[26:27], v[26:27], s[62:63]
  v_pk_fma_f32 v[76:77], v[28:29], v[28:29], s[62:63]
  v_pk_fma_f32 v[78:79], v[30:31], v[30:31], s[62:63]
  v_pk_mul_f32 v[64:65], v[16:17], v[64:65] neg_lo:[1,0] neg_hi:[1,0]
  v_pk_mul_f32 v[66:67], v[18:19], v[66:67] neg_lo:[1,0] neg_hi:[1,0]
  v_pk_mul_f32 v[68:69], v[20:21], v[68:69] neg_lo:[1,0] neg_hi:[1,0]
  v_pk_mul_f32 v[70:71], v[22:23], v[70:71] neg_lo:[1,0] neg_hi:[1,0]
  v_pk_mul_f32 v[72:73], v[24:25], v[72:73] neg_lo:[1,0] neg_hi:[1,0]
  v_pk_mul_f32 v[74:75], v[26:27], v[74:75] neg_lo:[1,0] neg_hi:[1,0]
  v_pk_mul_f32 v[76:77], v[28:29], v[76:77] neg_lo:[1,0] neg_hi:[1,0]
  v_pk_mul_f32 v[78:79], v[30:31], v[78:79] neg_lo:[1,0] neg_hi:[1,0]
  v_pk_mul_f32 v[0:1], v[0:1], v[56:57]
  v_pk_mul_f32 v[2:3], v[2:3], v[58:59]
  v_pk_mul_f32 v[4:5], v[4:5], v[60:61]
  v_pk_mul_f32 v[6:7], v[6:7], v[62:63]
  v_pk_mul_f32 v[8:9], v[8:9], v[48:49]
  v_pk_mul_f32 v[10:11], v[10:11], v[50:51]
  v_pk_mul_f32 v[12:13], v[12:13], v[52:53]
  v_pk_mul_f32 v[14:15], v[14:15], v[54:55]
  v_pk_mul_f32 v[48:49], v[48:49], v[56:57]
  v_pk_mul_f32 v[50:51], v[50:51], v[58:59]
  v_pk_mul_f32 v[52:53], v[52:53], v[60:61]
  v_pk_mul_f32 v[54:55], v[54:55], v[62:63]
  v_permlane16_swap_b32 v96, v104
  v_permlane16_swap_b32 v97, v105
  v_permlane16_swap_b32 v98, v106
  v_permlane16_swap_b32 v99, v107
  v_permlane16_swap_b32 v100, v108
  v_permlane16_swap_b32 v101, v109
  v_permlane16_swap_b32 v102, v110
  v_permlane16_swap_b32 v103, v111
  v_pk_add_f32 v[96:97], v[96:97], v[104:105]
  v_pk_add_f32 v[98:99], v[98:99], v[106:107]
  v_pk_add_f32 v[100:101], v[100:101], v[108:109]
  v_pk_add_f32 v[102:103], v[102:103], v[110:111]
  s_waitcnt lgkmcnt(0)
  v_mfma_f32_32x32x16_bf16 v[32:47], a[48:51], a[0:3], 0
  v_exp_f32 v64, v64
  v_exp_f32 v65, v65
  v_cvt_pk_bf16_f32 v144, v232, v233
  v_cvt_pk_bf16_f32 v145, v234, v235
  v_cndmask_b32 v82, v80, v81, s[6:7]
  v_mfma_f32_32x32x16_bf16 v[32:47], a[52:55], a[4:7], v[32:47]
  v_exp_f32 v66, v66
  v_exp_f32 v67, v67
  v_cvt_pk_bf16_f32 v146, v236, v237
  v_cvt_pk_bf16_f32 v147, v238, v239
  v_cndmask_b32 v83, v81, v80, s[6:7]
  v_mfma_f32_32x32x16_bf16 v[32:47], a[56:59], a[8:11], v[32:47]
  v_exp_f32 v68, v68
  v_exp_f32 v69, v69
  v_cvt_pk_bf16_f32 v148, v240, v241
  v_cvt_pk_bf16_f32 v149, v242, v243
  v_add_f32_dpp v82, v83, v82 quad_perm:[1,0,3,2] row_mask:0xf bank_mask:0xf
  v_mfma_f32_32x32x16_bf16 v[32:47], a[60:63], a[12:15], v[32:47]
  v_exp_f32 v70, v70
  v_exp_f32 v71, v71
  v_cvt_pk_bf16_f32 v150, v244, v245
  v_cvt_pk_bf16_f32 v151, v246, v247
  v_add_f32_dpp v84, v82, v82 quad_perm:[2,3,0,1] row_mask:0xf bank_mask:0xf
  v_mfma_f32_32x32x16_bf16 v[32:47], a[64:67], a[16:19], v[32:47]
  v_exp_f32 v72, v72
  v_exp_f32 v73, v73
  v_cndmask_b32 v84, v84, 1.0, s[64:65]
  v_fma_f32 v64, v64, s60, s60 clamp
  v_mfma_f32_32x32x16_bf16 v[32:47], a[68:71], a[20:23], v[32:47]
  v_exp_f32 v74, v74
  v_exp_f32 v75, v75
  buffer_atomic_add_f32 v84, v251, s[20:23], s77 offen offset:512 sc1
  v_fma_f32 v65, v65, s60, s60 clamp
  v_mfma_f32_32x32x16_bf16 v[32:47], a[72:75], a[24:27], v[32:47]
  v_exp_f32 v76, v76
  v_exp_f32 v77, v77
  v_add_f32_dpp v96, v96, v96 row_ror:8 row_mask:0xf bank_mask:0x3
  v_fma_f32 v66, v66, s60, s60 clamp
  v_mfma_f32_32x32x16_bf16 v[32:47], a[76:79], a[28:31], v[32:47]
  v_exp_f32 v78, v78
  v_exp_f32 v79, v79
  v_add_f32_dpp v97, v97, v97 row_ror:8 row_mask:0xf bank_mask:0x3
  v_fma_f32 v67, v67, s60, s60 clamp
  v_mfma_f32_32x32x16_bf16 v[32:47], a[80:83], a[32:35], v[32:47]
  v_rcp_f32 v48, v48
  v_rcp_f32 v49, v49
  v_add_f32_dpp v98, v98, v98 row_ror:8 row_mask:0xf bank_mask:0x3
  v_fma_f32 v68, v68, s60, s60 clamp
  v_mfma_f32_32x32x16_bf16 v[32:47], a[84:87], a[36:39], v[32:47]
  v_rcp_f32 v50, v50
  v_rcp_f32 v51, v51
  v_add_f32_dpp v99, v99, v99 row_ror:8 row_mask:0xf bank_mask:0x3
  v_fma_f32 v69, v69, s60, s60 clamp
  v_mfma_f32_32x32x16_bf16 v[32:47], a[88:91], a[40:43], v[32:47]
  v_rcp_f32 v52, v52
  v_rcp_f32 v53, v53
  v_add_f32_dpp v96, v100, v100 row_ror:8 row_mask:0xf bank_mask:0xc
  v_fma_f32 v70, v70, s60, s60 clamp
  v_mfma_f32_32x32x16_bf16 v[32:47], a[92:95], a[44:47], v[32:47]
  v_rcp_f32 v54, v54
  v_rcp_f32 v55, v55
  v_add_f32_dpp v97, v101, v101 row_ror:8 row_mask:0xf bank_mask:0xc
  v_fma_f32 v71, v71, s60, s60 clamp
  v_fma_f32 v72, v72, s60, s60 clamp
  v_fma_f32 v73, v73, s60, s60 clamp
  v_fma_f32 v74, v74, s60, s60 clamp
  v_fma_f32 v75, v75, s60, s60 clamp
  v_lshrrev_b32_e64 v254, 1, v248
  s_mul_i32 s44, s3, 1536
  s_add_u32 s44, s44, 888832
  s_lshl_b32 s46, s3, 10
  s_add_u32 s46, s46, 913408
  s_bfe_u32 s51, s2, 0x20003
  s_lshl_b32 s51, s51, 8
  s_add_u32 s51, s51, s46
  s_mov_b32 s50, 0x425c0000
  v_pk_fma_f32 v[76:77], v[76:77], s[60:61], s[60:61] clamp
  v_pk_fma_f32 v[78:79], v[78:79], s[60:61], s[60:61] clamp
  v_pk_mul_f32 v[0:1], v[0:1], v[48:49]
  v_pk_mul_f32 v[2:3], v[2:3], v[50:51]
  v_pk_mul_f32 v[4:5], v[4:5], v[52:53]
  v_pk_mul_f32 v[6:7], v[6:7], v[54:55]
  v_pk_mul_f32 v[8:9], v[8:9], v[48:49]
  v_pk_mul_f32 v[10:11], v[10:11], v[50:51]
  v_pk_mul_f32 v[12:13], v[12:13], v[52:53]
  v_pk_mul_f32 v[14:15], v[14:15], v[54:55]
  v_pk_mul_f32 v[80:81], v[0:1], v[0:1]
  v_pk_mul_f32 v[82:83], v[2:3], v[2:3]
  v_pk_mul_f32 v[84:85], v[4:5], v[4:5]
  v_pk_mul_f32 v[86:87], v[6:7], v[6:7]
  v_pk_mul_f32 v[88:89], v[8:9], v[8:9]
  v_pk_mul_f32 v[90:91], v[10:11], v[10:11]
  v_pk_mul_f32 v[92:93], v[12:13], v[12:13]
  v_pk_mul_f32 v[94:95], v[14:15], v[14:15]
  v_pk_fma_f32 v[48:49], v[32:33], v[32:33], s[62:63]
  v_pk_fma_f32 v[50:51], v[34:35], v[34:35], s[62:63]
  v_pk_fma_f32 v[52:53], v[36:37], v[36:37], s[62:63]
  v_pk_fma_f32 v[54:55], v[38:39], v[38:39], s[62:63]
  v_pk_fma_f32 v[56:57], v[40:41], v[40:41], s[62:63]
  v_pk_fma_f32 v[58:59], v[42:43], v[42:43], s[62:63]
  v_pk_fma_f32 v[60:61], v[44:45], v[44:45], s[62:63]
  v_pk_fma_f32 v[62:63], v[46:47], v[46:47], s[62:63]
  v_pk_mul_f32 v[48:49], v[32:33], v[48:49] neg_lo:[1,0] neg_hi:[1,0]
  v_pk_mul_f32 v[50:51], v[34:35], v[50:51] neg_lo:[1,0] neg_hi:[1,0]
  v_pk_mul_f32 v[52:53], v[36:37], v[52:53] neg_lo:[1,0] neg_hi:[1,0]
  v_pk_mul_f32 v[54:55], v[38:39], v[54:55] neg_lo:[1,0] neg_hi:[1,0]
  v_pk_mul_f32 v[56:57], v[40:41], v[56:57] neg_lo:[1,0] neg_hi:[1,0]
  v_pk_mul_f32 v[58:59], v[42:43], v[58:59] neg_lo:[1,0] neg_hi:[1,0]
  v_pk_mul_f32 v[60:61], v[44:45], v[60:61] neg_lo:[1,0] neg_hi:[1,0]
  v_pk_mul_f32 v[62:63], v[46:47], v[62:63] neg_lo:[1,0] neg_hi:[1,0]
  v_pk_mul_f32 v[16:17], v[16:17], v[72:73]
  v_pk_mul_f32 v[18:19], v[18:19], v[74:75]
  v_pk_mul_f32 v[20:21], v[20:21], v[76:77]
  v_pk_mul_f32 v[22:23], v[22:23], v[78:79]
  v_pk_mul_f32 v[24:25], v[24:25], v[64:65]
  v_pk_mul_f32 v[26:27], v[26:27], v[66:67]
  v_pk_mul_f32 v[28:29], v[28:29], v[68:69]
  v_pk_mul_f32 v[30:31], v[30:31], v[70:71]
  v_pk_mul_f32 v[64:65], v[64:65], v[72:73]
  v_pk_mul_f32 v[66:67], v[66:67], v[74:75]
  v_pk_mul_f32 v[68:69], v[68:69], v[76:77]
  v_pk_mul_f32 v[70:71], v[70:71], v[78:79]
  v_mfma_f32_32x32x16_bf16 v[232:247], a[96:99], a[0:3], 0
  v_exp_f32 v48, v48
  v_exp_f32 v49, v49
  v_cvt_pk_bf16_f32 v152, v0, v1
  v_cvt_pk_bf16_f32 v153, v2, v3
  v_add_f32_dpp v98, v102, v102 row_ror:8 row_mask:0xf bank_mask:0xc
  v_mfma_f32_32x32x16_bf16 v[232:247], a[100:103], a[4:7], v[232:247]
  ds_read_b128 a[0:3], v249 offset:26112
  v_exp_f32 v50, v50
  v_exp_f32 v51, v51
  v_cvt_pk_bf16_f32 v154, v4, v5
  v_add_f32_dpp v99, v103, v103 row_ror:8 row_mask:0xf bank_mask:0xc
  v_mfma_f32_32x32x16_bf16 v[232:247], a[104:107], a[8:11], v[232:247]
  ds_read_b128 a[4:7], v249 offset:27136
  v_exp_f32 v52, v52
  v_exp_f32 v53, v53
  v_cvt_pk_bf16_f32 v155, v6, v7
  v_add_f32_dpp v96, v96, v96 row_half_mirror row_mask:0xf bank_mask:0x5
  v_mfma_f32_32x32x16_bf16 v[232:247], a[108:111], a[12:15], v[232:247]
  ds_read_b128 a[8:11], v249 offset:28160
  v_exp_f32 v54, v54
  v_exp_f32 v55, v55
  v_cvt_pk_bf16_f32 v156, v8, v9
  v_add_f32_dpp v97, v97, v97 row_half_mirror row_mask:0xf bank_mask:0x5
  v_mfma_f32_32x32x16_bf16 v[232:247], a[112:115], a[16:19], v[232:247]
  ds_read_b128 a[12:15], v249 offset:29184
  v_exp_f32 v56, v56
  v_exp_f32 v57, v57
  v_cvt_pk_bf16_f32 v157, v10, v11
  v_add_f32_dpp v96, v98, v98 row_half_mirror row_mask:0xf bank_mask:0xa
  v_mfma_f32_32x32x16_bf16 v[232:247], a[116:119], a[20:23], v[232:247]
  ds_read_b128 a[16:19], v249 offset:30208
  v_exp_f32 v58, v58
  v_exp_f32 v59, v59
  v_cvt_pk_bf16_f32 v158, v12, v13
  v_add_f32_dpp v97, v99, v99 row_half_mirror row_mask:0xf bank_mask:0xa
  v_mfma_f32_32x32x16_bf16 v[232:247], a[120:123], a[24:27], v[232:247]
  ds_read_b128 a[20:23], v249 offset:31232
  v_exp_f32 v60, v60
  v_exp_f32 v61, v61
  v_cvt_pk_bf16_f32 v159, v14, v15
  v_cndmask_b32 v98, v96, v97, s[6:7]
  v_mfma_f32_32x32x16_bf16 v[232:247], a[124:127], a[28:31], v[232:247]
  ds_read_b128 a[24:27], v249 offset:32256
  v_exp_f32 v62, v62
  v_exp_f32 v63, v63
  v_cndmask_b32 v99, v97, v96, s[6:7]
  v_mfma_f32_32x32x16_bf16 v[232:247], a[128:131], a[32:35], v[232:247]
  ds_read_b128 a[28:31], v249 offset:33280
  v_rcp_f32 v64, v64
  v_rcp_f32 v65, v65
  v_add_f32_dpp v98, v99, v98 quad_perm:[1,0,3,2] row_mask:0xf bank_mask:0xf
  v_mfma_f32_32x32x16_bf16 v[232:247], a[132:135], a[36:39], v[232:247]
  ds_read_b128 a[32:35], v249 offset:34304
  v_rcp_f32 v66, v66
  v_rcp_f32 v67, v67
  v_add_f32_dpp v100, v98, v98 quad_perm:[2,3,0,1] row_mask:0xf bank_mask:0xf
  v_mfma_f32_32x32x16_bf16 v[232:247], a[136:139], a[40:43], v[232:247]
  ds_read_b128 a[36:39], v249 offset:35328
  v_rcp_f32 v68, v68
  v_rcp_f32 v69, v69
  v_cndmask_b32 v100, v100, 1.0, s[64:65]
  v_mfma_f32_32x32x16_bf16 v[232:247], a[140:143], a[44:47], v[232:247]
  ds_read_b128 a[40:43], v249 offset:36352
  ds_read_b128 a[44:47], v249 offset:37376
  v_rcp_f32 v70, v70
  v_rcp_f32 v71, v71
  buffer_atomic_add_f32 v100, v251, s[20:23], s77 offen offset:768 sc1
  v_fma_f32 v48, v48, s60, s60 clamp
  v_fma_f32 v49, v49, s60, s60 clamp
  v_pk_fma_f32 v[50:51], v[50:51], s[60:61], s[60:61] clamp
  v_pk_fma_f32 v[52:53], v[52:53], s[60:61], s[60:61] clamp
  v_pk_fma_f32 v[54:55], v[54:55], s[60:61], s[60:61] clamp
  v_pk_fma_f32 v[56:57], v[56:57], s[60:61], s[60:61] clamp
  v_pk_fma_f32 v[58:59], v[58:59], s[60:61], s[60:61] clamp
  v_pk_fma_f32 v[60:61], v[60:61], s[60:61], s[60:61] clamp
  v_pk_fma_f32 v[62:63], v[62:63], s[60:61], s[60:61] clamp
  v_pk_mul_f32 v[16:17], v[16:17], v[64:65]
  v_pk_mul_f32 v[18:19], v[18:19], v[66:67]
  v_pk_mul_f32 v[20:21], v[20:21], v[68:69]
  v_pk_mul_f32 v[22:23], v[22:23], v[70:71]
  v_pk_mul_f32 v[24:25], v[24:25], v[64:65]
  v_pk_mul_f32 v[26:27], v[26:27], v[66:67]
  v_pk_mul_f32 v[28:29], v[28:29], v[68:69]
  v_pk_mul_f32 v[30:31], v[30:31], v[70:71]
  v_pk_mul_f32 v[96:97], v[16:17], v[16:17]
  v_pk_mul_f32 v[98:99], v[18:19], v[18:19]
  v_pk_mul_f32 v[100:101], v[20:21], v[20:21]
  v_pk_mul_f32 v[102:103], v[22:23], v[22:23]
  v_pk_mul_f32 v[104:105], v[24:25], v[24:25]
  v_pk_mul_f32 v[106:107], v[26:27], v[26:27]
  v_pk_mul_f32 v[108:109], v[28:29], v[28:29]
  v_pk_mul_f32 v[110:111], v[30:31], v[30:31]
  v_pk_fma_f32 v[64:65], v[232:233], v[232:233], s[62:63]
  v_pk_fma_f32 v[66:67], v[234:235], v[234:235], s[62:63]
  v_pk_fma_f32 v[68:69], v[236:237], v[236:237], s[62:63]
  v_pk_fma_f32 v[70:71], v[238:239], v[238:239], s[62:63]
  v_pk_fma_f32 v[72:73], v[240:241], v[240:241], s[62:63]
  v_pk_fma_f32 v[74:75], v[242:243], v[242:243], s[62:63]
  v_pk_fma_f32 v[76:77], v[244:245], v[244:245], s[62:63]
  v_pk_fma_f32 v[78:79], v[246:247], v[246:247], s[62:63]
  v_pk_mul_f32 v[64:65], v[232:233], v[64:65] neg_lo:[1,0] neg_hi:[1,0]
  v_pk_mul_f32 v[66:67], v[234:235], v[66:67] neg_lo:[1,0] neg_hi:[1,0]
  v_pk_mul_f32 v[68:69], v[236:237], v[68:69] neg_lo:[1,0] neg_hi:[1,0]
  v_pk_mul_f32 v[70:71], v[238:239], v[70:71] neg_lo:[1,0] neg_hi:[1,0]
  v_pk_mul_f32 v[72:73], v[240:241], v[72:73] neg_lo:[1,0] neg_hi:[1,0]
  v_pk_mul_f32 v[74:75], v[242:243], v[74:75] neg_lo:[1,0] neg_hi:[1,0]
  v_pk_mul_f32 v[76:77], v[244:245], v[76:77] neg_lo:[1,0] neg_hi:[1,0]
  v_pk_mul_f32 v[78:79], v[246:247], v[78:79] neg_lo:[1,0] neg_hi:[1,0]
  v_pk_mul_f32 v[32:33], v[32:33], v[56:57]
  v_pk_mul_f32 v[34:35], v[34:35], v[58:59]
  v_pk_mul_f32 v[36:37], v[36:37], v[60:61]
  v_pk_mul_f32 v[38:39], v[38:39], v[62:63]
  v_pk_mul_f32 v[40:41], v[40:41], v[48:49]
  v_pk_mul_f32 v[42:43], v[42:43], v[50:51]
  v_pk_mul_f32 v[44:45], v[44:45], v[52:53]
  v_pk_mul_f32 v[46:47], v[46:47], v[54:55]
  v_pk_mul_f32 v[48:49], v[48:49], v[56:57]
  v_pk_mul_f32 v[50:51], v[50:51], v[58:59]
  v_pk_mul_f32 v[52:53], v[52:53], v[60:61]
  v_pk_mul_f32 v[54:55], v[54:55], v[62:63]
  s_waitcnt lgkmcnt(0)
  v_mfma_f32_32x32x16_bf16 v[0:15], a[48:51], a[0:3], 0
  v_exp_f32 v64, v64
  v_exp_f32 v65, v65
  v_cvt_pk_bf16_f32 v160, v16, v17
  v_cvt_pk_bf16_f32 v161, v18, v19
  v_mfma_f32_32x32x16_bf16 v[0:15], a[52:55], a[4:7], v[0:15]
  v_exp_f32 v66, v66
  v_exp_f32 v67, v67
  v_cvt_pk_bf16_f32 v162, v20, v21
  v_cvt_pk_bf16_f32 v163, v22, v23
  v_mfma_f32_32x32x16_bf16 v[0:15], a[56:59], a[8:11], v[0:15]
  v_exp_f32 v68, v68
  v_exp_f32 v69, v69
  v_cvt_pk_bf16_f32 v164, v24, v25
  v_cvt_pk_bf16_f32 v165, v26, v27
  v_mfma_f32_32x32x16_bf16 v[0:15], a[60:63], a[12:15], v[0:15]
  v_exp_f32 v70, v70
  v_exp_f32 v71, v71
  v_cvt_pk_bf16_f32 v166, v28, v29
  v_cvt_pk_bf16_f32 v167, v30, v31
  v_mfma_f32_32x32x16_bf16 v[0:15], a[64:67], a[16:19], v[0:15]
  v_exp_f32 v72, v72
  v_exp_f32 v73, v73
  v_fma_f32 v64, v64, s60, s60 clamp
  v_fma_f32 v65, v65, s60, s60 clamp
  v_mfma_f32_32x32x16_bf16 v[0:15], a[68:71], a[20:23], v[0:15]
  v_exp_f32 v74, v74
  v_exp_f32 v75, v75
  v_fma_f32 v66, v66, s60, s60 clamp
  v_fma_f32 v67, v67, s60, s60 clamp
  v_mfma_f32_32x32x16_bf16 v[0:15], a[72:75], a[24:27], v[0:15]
  v_exp_f32 v76, v76
  v_exp_f32 v77, v77
  v_fma_f32 v68, v68, s60, s60 clamp
  v_fma_f32 v69, v69, s60, s60 clamp
  v_mfma_f32_32x32x16_bf16 v[0:15], a[76:79], a[28:31], v[0:15]
  v_exp_f32 v78, v78
  v_exp_f32 v79, v79
  v_fma_f32 v70, v70, s60, s60 clamp
  v_fma_f32 v71, v71, s60, s60 clamp
  v_mfma_f32_32x32x16_bf16 v[0:15], a[80:83], a[32:35], v[0:15]
  v_rcp_f32 v48, v48
  v_rcp_f32 v49, v49
  v_fma_f32 v72, v72, s60, s60 clamp
  v_fma_f32 v73, v73, s60, s60 clamp
  v_mfma_f32_32x32x16_bf16 v[0:15], a[84:87], a[36:39], v[0:15]
  v_rcp_f32 v50, v50
  v_rcp_f32 v51, v51
  v_fma_f32 v74, v74, s60, s60 clamp
  v_fma_f32 v75, v75, s60, s60 clamp
  v_mfma_f32_32x32x16_bf16 v[0:15], a[88:91], a[40:43], v[0:15]
  v_rcp_f32 v52, v52
  v_rcp_f32 v53, v53
  v_fma_f32 v76, v76, s60, s60 clamp
  v_fma_f32 v77, v77, s60, s60 clamp
  v_mfma_f32_32x32x16_bf16 v[0:15], a[92:95], a[44:47], v[0:15]
  v_rcp_f32 v54, v54
  v_rcp_f32_e64 v55, v55
  v_fma_f32 v78, v78, s60, s60 clamp
  v_fma_f32 v79, v79, s60, s60 clamp
  v_pk_mul_f32 v[32:33], v[32:33], v[48:49]
  v_pk_mul_f32 v[34:35], v[34:35], v[50:51]
  v_pk_mul_f32 v[36:37], v[36:37], v[52:53]
  v_pk_mul_f32 v[38:39], v[38:39], v[54:55]
  v_pk_mul_f32 v[40:41], v[40:41], v[48:49]
  v_pk_mul_f32 v[42:43], v[42:43], v[50:51]
  v_pk_mul_f32 v[44:45], v[44:45], v[52:53]
  v_pk_mul_f32 v[46:47], v[46:47], v[54:55]
  v_pk_fma_f32 v[80:81], v[32:33], v[32:33], v[80:81]
  v_pk_fma_f32 v[82:83], v[34:35], v[34:35], v[82:83]
  v_pk_fma_f32 v[84:85], v[36:37], v[36:37], v[84:85]
  v_pk_fma_f32 v[86:87], v[38:39], v[38:39], v[86:87]
  v_pk_fma_f32 v[88:89], v[40:41], v[40:41], v[88:89]
  v_pk_fma_f32 v[90:91], v[42:43], v[42:43], v[90:91]
  v_pk_fma_f32 v[92:93], v[44:45], v[44:45], v[92:93]
  v_pk_fma_f32 v[94:95], v[46:47], v[46:47], v[94:95]
  v_pk_fma_f32 v[48:49], v[0:1], v[0:1], s[62:63]
  v_pk_fma_f32 v[50:51], v[2:3], v[2:3], s[62:63]
  v_pk_fma_f32 v[52:53], v[4:5], v[4:5], s[62:63]
  v_pk_fma_f32 v[54:55], v[6:7], v[6:7], s[62:63]
  v_pk_fma_f32 v[56:57], v[8:9], v[8:9], s[62:63]
  v_pk_fma_f32 v[58:59], v[10:11], v[10:11], s[62:63]
  v_pk_fma_f32 v[60:61], v[12:13], v[12:13], s[62:63]
  v_pk_fma_f32 v[62:63], v[14:15], v[14:15], s[62:63]
  v_pk_mul_f32 v[48:49], v[0:1], v[48:49] neg_lo:[1,0] neg_hi:[1,0]
  v_pk_mul_f32 v[50:51], v[2:3], v[50:51] neg_lo:[1,0] neg_hi:[1,0]
  v_pk_mul_f32 v[52:53], v[4:5], v[52:53] neg_lo:[1,0] neg_hi:[1,0]
  v_pk_mul_f32 v[54:55], v[6:7], v[54:55] neg_lo:[1,0] neg_hi:[1,0]
  v_pk_mul_f32 v[56:57], v[8:9], v[56:57] neg_lo:[1,0] neg_hi:[1,0]
  v_pk_mul_f32 v[58:59], v[10:11], v[58:59] neg_lo:[1,0] neg_hi:[1,0]
  v_pk_mul_f32 v[60:61], v[12:13], v[60:61] neg_lo:[1,0] neg_hi:[1,0]
  v_pk_mul_f32 v[62:63], v[14:15], v[62:63] neg_lo:[1,0] neg_hi:[1,0]
  v_pk_mul_f32 v[232:233], v[232:233], v[72:73]
  v_pk_mul_f32 v[234:235], v[234:235], v[74:75]
  v_pk_mul_f32 v[236:237], v[236:237], v[76:77]
  v_pk_mul_f32 v[238:239], v[238:239], v[78:79]
  v_pk_mul_f32 v[240:241], v[240:241], v[64:65]
  v_pk_mul_f32 v[242:243], v[242:243], v[66:67]
  v_pk_mul_f32 v[244:245], v[244:245], v[68:69]
  v_pk_mul_f32 v[246:247], v[246:247], v[70:71]
  v_pk_mul_f32 v[64:65], v[64:65], v[72:73]
  v_pk_mul_f32 v[66:67], v[66:67], v[74:75]
  v_pk_mul_f32 v[68:69], v[68:69], v[76:77]
  v_pk_mul_f32 v[70:71], v[70:71], v[78:79]
  v_mfma_f32_32x32x16_bf16 v[16:31], a[96:99], a[0:3], 0
  v_exp_f32 v48, v48
  v_exp_f32 v49, v49
  v_cvt_pk_bf16_f32 v168, v32, v33
  v_cvt_pk_bf16_f32 v169, v34, v35
  v_mfma_f32_32x32x16_bf16 v[16:31], a[100:103], a[4:7], v[16:31]
  ds_read_b128 a[0:3], v249 offset:39168
  v_exp_f32 v50, v50
  v_exp_f32 v51, v51
  v_cvt_pk_bf16_f32 v170, v36, v37
  v_mfma_f32_32x32x16_bf16 v[16:31], a[104:107], a[8:11], v[16:31]
  ds_read_b128 a[4:7], v249 offset:40192
  v_exp_f32 v52, v52
  v_exp_f32 v53, v53
  v_cvt_pk_bf16_f32 v171, v38, v39
  v_mfma_f32_32x32x16_bf16 v[16:31], a[108:111], a[12:15], v[16:31]
  ds_read_b128 a[8:11], v249 offset:41216
  v_exp_f32 v54, v54
  v_exp_f32 v55, v55
  v_cvt_pk_bf16_f32 v172, v40, v41
  v_mfma_f32_32x32x16_bf16 v[16:31], a[112:115], a[16:19], v[16:31]
  ds_read_b128 a[12:15], v249 offset:42240
  v_exp_f32 v56, v56
  v_exp_f32 v57, v57
  v_cvt_pk_bf16_f32 v173, v42, v43
  v_mfma_f32_32x32x16_bf16 v[16:31], a[116:119], a[20:23], v[16:31]
  ds_read_b128 a[16:19], v249 offset:43264
  v_exp_f32 v58, v58
  v_exp_f32 v59, v59
  v_cvt_pk_bf16_f32 v174, v44, v45
  v_mfma_f32_32x32x16_bf16 v[16:31], a[120:123], a[24:27], v[16:31]
  ds_read_b128 a[20:23], v249 offset:44288
  v_exp_f32 v60, v60
  v_exp_f32 v61, v61
  v_cvt_pk_bf16_f32 v175, v46, v47
  v_mfma_f32_32x32x16_bf16 v[16:31], a[124:127], a[28:31], v[16:31]
  ds_read_b128 a[24:27], v249 offset:45312
  v_exp_f32 v62, v62
  v_exp_f32 v63, v63
  v_fma_f32 v48, v48, s60, s60 clamp
  v_mfma_f32_32x32x16_bf16 v[16:31], a[128:131], a[32:35], v[16:31]
  ds_read_b128 a[28:31], v249 offset:46336
  v_rcp_f32 v64, v64
  v_rcp_f32 v65, v65
  v_fma_f32 v49, v49, s60, s60 clamp
  v_mfma_f32_32x32x16_bf16 v[16:31], a[132:135], a[36:39], v[16:31]
  ds_read_b128 a[32:35], v249 offset:47360
  v_rcp_f32 v66, v66
  v_rcp_f32 v67, v67
  v_fma_f32 v50, v50, s60, s60 clamp
  v_mfma_f32_32x32x16_bf16 v[16:31], a[136:139], a[40:43], v[16:31]
  ds_read_b128 a[36:39], v249 offset:48384
  v_rcp_f32 v68, v68
  v_rcp_f32 v69, v69
  v_fma_f32 v51, v51, s60, s60 clamp
  v_mfma_f32_32x32x16_bf16 v[16:31], a[140:143], a[44:47], v[16:31]
  ds_read_b128 a[40:43], v249 offset:49408
  ds_read_b128 a[44:47], v249 offset:50432
  v_rcp_f32 v70, v70
  v_rcp_f32 v71, v71
  v_fma_f32 v52, v52, s60, s60 clamp
  v_fma_f32 v53, v53, s60, s60 clamp
  v_fma_f32 v54, v54, s60, s60 clamp
  v_fma_f32 v55, v55, s60, s60 clamp
  v_pk_fma_f32 v[56:57], v[56:57], s[60:61], s[60:61] clamp
  v_pk_fma_f32 v[58:59], v[58:59], s[60:61], s[60:61] clamp
  v_pk_fma_f32 v[60:61], v[60:61], s[60:61], s[60:61] clamp
  v_pk_fma_f32 v[62:63], v[62:63], s[60:61], s[60:61] clamp
  v_pk_mul_f32 v[232:233], v[232:233], v[64:65]
  v_pk_mul_f32 v[234:235], v[234:235], v[66:67]
  v_pk_mul_f32 v[236:237], v[236:237], v[68:69]
  v_pk_mul_f32 v[238:239], v[238:239], v[70:71]
  v_pk_mul_f32 v[240:241], v[240:241], v[64:65]
  v_pk_mul_f32 v[242:243], v[242:243], v[66:67]
  v_pk_mul_f32 v[244:245], v[244:245], v[68:69]
  v_pk_mul_f32 v[246:247], v[246:247], v[70:71]
  v_pk_fma_f32 v[96:97], v[232:233], v[232:233], v[96:97]
  v_pk_fma_f32 v[98:99], v[234:235], v[234:235], v[98:99]
  v_pk_fma_f32 v[100:101], v[236:237], v[236:237], v[100:101]
  v_pk_fma_f32 v[102:103], v[238:239], v[238:239], v[102:103]
  v_pk_fma_f32 v[104:105], v[240:241], v[240:241], v[104:105]
  v_pk_fma_f32 v[106:107], v[242:243], v[242:243], v[106:107]
  v_pk_fma_f32 v[108:109], v[244:245], v[244:245], v[108:109]
  v_pk_fma_f32 v[110:111], v[246:247], v[246:247], v[110:111]
  v_pk_fma_f32 v[64:65], v[16:17], v[16:17], s[62:63]
  v_pk_fma_f32 v[66:67], v[18:19], v[18:19], s[62:63]
  v_pk_fma_f32 v[68:69], v[20:21], v[20:21], s[62:63]
  v_pk_fma_f32 v[70:71], v[22:23], v[22:23], s[62:63]
  v_pk_fma_f32 v[72:73], v[24:25], v[24:25], s[62:63]
  v_pk_fma_f32 v[74:75], v[26:27], v[26:27], s[62:63]
  v_pk_fma_f32 v[76:77], v[28:29], v[28:29], s[62:63]
  v_pk_fma_f32 v[78:79], v[30:31], v[30:31], s[62:63]
  v_pk_mul_f32 v[64:65], v[16:17], v[64:65] neg_lo:[1,0] neg_hi:[1,0]
  v_pk_mul_f32 v[66:67], v[18:19], v[66:67] neg_lo:[1,0] neg_hi:[1,0]
  v_pk_mul_f32 v[68:69], v[20:21], v[68:69] neg_lo:[1,0] neg_hi:[1,0]
  v_pk_mul_f32 v[70:71], v[22:23], v[70:71] neg_lo:[1,0] neg_hi:[1,0]
  v_pk_mul_f32 v[72:73], v[24:25], v[72:73] neg_lo:[1,0] neg_hi:[1,0]
  v_pk_mul_f32 v[74:75], v[26:27], v[74:75] neg_lo:[1,0] neg_hi:[1,0]
  v_pk_mul_f32 v[76:77], v[28:29], v[76:77] neg_lo:[1,0] neg_hi:[1,0]
  v_pk_mul_f32 v[78:79], v[30:31], v[78:79] neg_lo:[1,0] neg_hi:[1,0]
  v_pk_mul_f32 v[0:1], v[0:1], v[56:57]
  v_pk_mul_f32 v[2:3], v[2:3], v[58:59]
  v_pk_mul_f32 v[4:5], v[4:5], v[60:61]
  v_pk_mul_f32 v[6:7], v[6:7], v[62:63]
  v_pk_mul_f32 v[8:9], v[8:9], v[48:49]
  v_pk_mul_f32 v[10:11], v[10:11], v[50:51]
  v_pk_mul_f32 v[12:13], v[12:13], v[52:53]
  v_pk_mul_f32 v[14:15], v[14:15], v[54:55]
  v_pk_mul_f32 v[48:49], v[48:49], v[56:57]
  v_pk_mul_f32 v[50:51], v[50:51], v[58:59]
  v_pk_mul_f32 v[52:53], v[52:53], v[60:61]
  v_pk_mul_f32 v[54:55], v[54:55], v[62:63]
  s_waitcnt lgkmcnt(0)
  v_mfma_f32_32x32x16_bf16 v[32:47], a[48:51], a[0:3], 0
  v_exp_f32 v64, v64
  v_exp_f32 v65, v65
  v_cvt_pk_bf16_f32 v176, v232, v233
  v_cvt_pk_bf16_f32 v177, v234, v235
  v_mfma_f32_32x32x16_bf16 v[32:47], a[52:55], a[4:7], v[32:47]
  v_exp_f32 v66, v66
  v_exp_f32 v67, v67
  v_cvt_pk_bf16_f32 v178, v236, v237
  v_cvt_pk_bf16_f32 v179, v238, v239
  v_mfma_f32_32x32x16_bf16 v[32:47], a[56:59], a[8:11], v[32:47]
  v_exp_f32 v68, v68
  v_exp_f32 v69, v69
  v_cvt_pk_bf16_f32 v180, v240, v241
  v_cvt_pk_bf16_f32 v181, v242, v243
  v_mfma_f32_32x32x16_bf16 v[32:47], a[60:63], a[12:15], v[32:47]
  v_exp_f32 v70, v70
  v_exp_f32 v71, v71
  v_cvt_pk_bf16_f32 v182, v244, v245
  v_cvt_pk_bf16_f32 v183, v246, v247
  v_mfma_f32_32x32x16_bf16 v[32:47], a[64:67], a[16:19], v[32:47]
  v_exp_f32 v72, v72
  v_exp_f32 v73, v73
  v_fma_f32 v64, v64, s60, s60 clamp
  v_fma_f32 v65, v65, s60, s60 clamp
  v_mfma_f32_32x32x16_bf16 v[32:47], a[68:71], a[20:23], v[32:47]
  v_exp_f32 v74, v74
  v_exp_f32 v75, v75
  v_fma_f32 v66, v66, s60, s60 clamp
  v_fma_f32 v67, v67, s60, s60 clamp
  v_mfma_f32_32x32x16_bf16 v[32:47], a[72:75], a[24:27], v[32:47]
  v_exp_f32 v76, v76
  v_exp_f32 v77, v77
  v_fma_f32 v68, v68, s60, s60 clamp
  v_fma_f32 v69, v69, s60, s60 clamp
  v_mfma_f32_32x32x16_bf16 v[32:47], a[76:79], a[28:31], v[32:47]
  v_exp_f32 v78, v78
  v_exp_f32 v79, v79
  v_fma_f32 v70, v70, s60, s60 clamp
  v_fma_f32 v71, v71, s60, s60 clamp
  v_mfma_f32_32x32x16_bf16 v[32:47], a[80:83], a[32:35], v[32:47]
  v_rcp_f32 v48, v48
  v_rcp_f32 v49, v49
  v_fma_f32 v72, v72, s60, s60 clamp
  v_fma_f32 v73, v73, s60, s60 clamp
  v_mfma_f32_32x32x16_bf16 v[32:47], a[84:87], a[36:39], v[32:47]
  v_rcp_f32 v50, v50
  v_rcp_f32 v51, v51
  v_fma_f32 v74, v74, s60, s60 clamp
  v_fma_f32 v75, v75, s60, s60 clamp
  v_mfma_f32_32x32x16_bf16 v[32:47], a[88:91], a[40:43], v[32:47]
  v_rcp_f32 v52, v52
  v_rcp_f32 v53, v53
  v_fma_f32 v76, v76, s60, s60 clamp
  v_fma_f32 v77, v77, s60, s60 clamp
  v_mfma_f32_32x32x16_bf16 v[32:47], a[92:95], a[44:47], v[32:47]
  v_rcp_f32 v54, v54
  v_rcp_f32_e64 v55, v55
  v_fma_f32 v78, v78, s60, s60 clamp
  v_fma_f32 v79, v79, s60, s60 clamp
  v_pk_mul_f32 v[0:1], v[0:1], v[48:49]
  v_pk_mul_f32 v[2:3], v[2:3], v[50:51]
  v_pk_mul_f32 v[4:5], v[4:5], v[52:53]
  v_pk_mul_f32 v[6:7], v[6:7], v[54:55]
  v_pk_mul_f32 v[8:9], v[8:9], v[48:49]
  v_pk_mul_f32 v[10:11], v[10:11], v[50:51]
  v_pk_mul_f32 v[12:13], v[12:13], v[52:53]
  v_pk_mul_f32 v[14:15], v[14:15], v[54:55]
  v_pk_fma_f32 v[80:81], v[0:1], v[0:1], v[80:81]
  v_pk_fma_f32 v[82:83], v[2:3], v[2:3], v[82:83]
  v_pk_fma_f32 v[84:85], v[4:5], v[4:5], v[84:85]
  v_pk_fma_f32 v[86:87], v[6:7], v[6:7], v[86:87]
  v_pk_fma_f32 v[88:89], v[8:9], v[8:9], v[88:89]
  v_pk_fma_f32 v[90:91], v[10:11], v[10:11], v[90:91]
  v_pk_fma_f32 v[92:93], v[12:13], v[12:13], v[92:93]
  v_pk_fma_f32 v[94:95], v[14:15], v[14:15], v[94:95]
  v_pk_fma_f32 v[48:49], v[32:33], v[32:33], s[62:63]
  v_pk_fma_f32 v[50:51], v[34:35], v[34:35], s[62:63]
  v_pk_fma_f32 v[52:53], v[36:37], v[36:37], s[62:63]
  v_pk_fma_f32 v[54:55], v[38:39], v[38:39], s[62:63]
  v_pk_fma_f32 v[56:57], v[40:41], v[40:41], s[62:63]
  v_pk_fma_f32 v[58:59], v[42:43], v[42:43], s[62:63]
  v_pk_fma_f32 v[60:61], v[44:45], v[44:45], s[62:63]
  v_pk_fma_f32 v[62:63], v[46:47], v[46:47], s[62:63]
  v_pk_mul_f32 v[48:49], v[32:33], v[48:49] neg_lo:[1,0] neg_hi:[1,0]
  v_pk_mul_f32 v[50:51], v[34:35], v[50:51] neg_lo:[1,0] neg_hi:[1,0]
  v_pk_mul_f32 v[52:53], v[36:37], v[52:53] neg_lo:[1,0] neg_hi:[1,0]
  v_pk_mul_f32 v[54:55], v[38:39], v[54:55] neg_lo:[1,0] neg_hi:[1,0]
  v_pk_mul_f32 v[56:57], v[40:41], v[56:57] neg_lo:[1,0] neg_hi:[1,0]
  v_pk_mul_f32 v[58:59], v[42:43], v[58:59] neg_lo:[1,0] neg_hi:[1,0]
  v_pk_mul_f32 v[60:61], v[44:45], v[60:61] neg_lo:[1,0] neg_hi:[1,0]
  v_pk_mul_f32 v[62:63], v[46:47], v[62:63] neg_lo:[1,0] neg_hi:[1,0]
  v_pk_mul_f32 v[16:17], v[16:17], v[72:73]
  v_pk_mul_f32 v[18:19], v[18:19], v[74:75]
  v_pk_mul_f32 v[20:21], v[20:21], v[76:77]
  v_pk_mul_f32 v[22:23], v[22:23], v[78:79]
  v_pk_mul_f32 v[24:25], v[24:25], v[64:65]
  v_pk_mul_f32 v[26:27], v[26:27], v[66:67]
  v_pk_mul_f32 v[28:29], v[28:29], v[68:69]
  v_pk_mul_f32 v[30:31], v[30:31], v[70:71]
  v_pk_mul_f32 v[64:65], v[64:65], v[72:73]
  v_pk_mul_f32 v[66:67], v[66:67], v[74:75]
  v_pk_mul_f32 v[68:69], v[68:69], v[76:77]
  v_pk_mul_f32 v[70:71], v[70:71], v[78:79]
  v_mfma_f32_32x32x16_bf16 v[232:247], a[96:99], a[0:3], 0
  v_exp_f32 v48, v48
  v_exp_f32 v49, v49
  v_cvt_pk_bf16_f32 v184, v0, v1
  v_cvt_pk_bf16_f32 v185, v2, v3
  v_mfma_f32_32x32x16_bf16 v[232:247], a[100:103], a[4:7], v[232:247]
  ds_read_b128 a[0:3], v250 offset:0
  v_exp_f32 v50, v50
  v_exp_f32 v51, v51
  v_cvt_pk_bf16_f32 v186, v4, v5
  v_mfma_f32_32x32x16_bf16 v[232:247], a[104:107], a[8:11], v[232:247]
  ds_read_b128 a[4:7], v250 offset:1024
  v_exp_f32 v52, v52
  v_exp_f32 v53, v53
  v_cvt_pk_bf16_f32 v187, v6, v7
  v_mfma_f32_32x32x16_bf16 v[232:247], a[108:111], a[12:15], v[232:247]
  ds_read_b128 a[8:11], v250 offset:2048
  v_exp_f32 v54, v54
  v_exp_f32 v55, v55
  v_cvt_pk_bf16_f32 v188, v8, v9
  v_mfma_f32_32x32x16_bf16 v[232:247], a[112:115], a[16:19], v[232:247]
  ds_read_b128 a[12:15], v250 offset:3072
  v_exp_f32 v56, v56
  v_exp_f32 v57, v57
  v_cvt_pk_bf16_f32 v189, v10, v11
  v_mfma_f32_32x32x16_bf16 v[232:247], a[116:119], a[20:23], v[232:247]
  ds_read_b128 a[16:19], v250 offset:4096
  v_exp_f32 v58, v58
  v_exp_f32 v59, v59
  v_cvt_pk_bf16_f32 v190, v12, v13
  v_mfma_f32_32x32x16_bf16 v[232:247], a[120:123], a[24:27], v[232:247]
  ds_read_b128 a[20:23], v250 offset:5120
  v_exp_f32 v60, v60
  v_exp_f32 v61, v61
  v_cvt_pk_bf16_f32 v191, v14, v15
  v_mfma_f32_32x32x16_bf16 v[232:247], a[124:127], a[28:31], v[232:247]
  ds_read_b128 a[24:27], v250 offset:6144
  v_exp_f32 v62, v62
  v_exp_f32 v63, v63
  v_fma_f32 v48, v48, s60, s60 clamp
  v_mfma_f32_32x32x16_bf16 v[232:247], a[128:131], a[32:35], v[232:247]
  ds_read_b128 a[28:31], v250 offset:7168
  v_rcp_f32 v64, v64
  v_rcp_f32 v65, v65
  v_fma_f32 v49, v49, s60, s60 clamp
  v_mfma_f32_32x32x16_bf16 v[232:247], a[132:135], a[36:39], v[232:247]
  ds_read_b128 a[32:35], v250 offset:8192
  v_rcp_f32 v66, v66
  v_rcp_f32 v67, v67
  v_fma_f32 v50, v50, s60, s60 clamp
  v_mfma_f32_32x32x16_bf16 v[232:247], a[136:139], a[40:43], v[232:247]
  ds_read_b128 a[36:39], v250 offset:9216
  v_rcp_f32 v68, v68
  v_rcp_f32 v69, v69
  v_fma_f32 v51, v51, s60, s60 clamp
  v_mfma_f32_32x32x16_bf16 v[232:247], a[140:143], a[44:47], v[232:247]
  ds_read_b128 a[40:43], v250 offset:10240
  ds_read_b128 a[44:47], v250 offset:11264
  v_rcp_f32 v70, v70
  v_rcp_f32 v71, v71
  v_fma_f32 v52, v52, s60, s60 clamp
  v_fma_f32 v53, v53, s60, s60 clamp
  v_fma_f32 v54, v54, s60, s60 clamp
  v_fma_f32 v55, v55, s60, s60 clamp
  v_pk_fma_f32 v[56:57], v[56:57], s[60:61], s[60:61] clamp
  v_pk_fma_f32 v[58:59], v[58:59], s[60:61], s[60:61] clamp
  v_pk_fma_f32 v[60:61], v[60:61], s[60:61], s[60:61] clamp
  v_pk_fma_f32 v[62:63], v[62:63], s[60:61], s[60:61] clamp
  v_pk_mul_f32 v[16:17], v[16:17], v[64:65]
  v_pk_mul_f32 v[18:19], v[18:19], v[66:67]
  v_pk_mul_f32 v[20:21], v[20:21], v[68:69]
  v_pk_mul_f32 v[22:23], v[22:23], v[70:71]
  v_pk_mul_f32 v[24:25], v[24:25], v[64:65]
  v_pk_mul_f32 v[26:27], v[26:27], v[66:67]
  v_pk_mul_f32 v[28:29], v[28:29], v[68:69]
  v_pk_mul_f32 v[30:31], v[30:31], v[70:71]
  v_pk_fma_f32 v[96:97], v[16:17], v[16:17], v[96:97]
  v_pk_fma_f32 v[98:99], v[18:19], v[18:19], v[98:99]
  v_pk_fma_f32 v[100:101], v[20:21], v[20:21], v[100:101]
  v_pk_fma_f32 v[102:103], v[22:23], v[22:23], v[102:103]
  v_pk_fma_f32 v[104:105], v[24:25], v[24:25], v[104:105]
  v_pk_fma_f32 v[106:107], v[26:27], v[26:27], v[106:107]
  v_pk_fma_f32 v[108:109], v[28:29], v[28:29], v[108:109]
  v_pk_fma_f32 v[110:111], v[30:31], v[30:31], v[110:111]
  v_pk_fma_f32 v[64:65], v[232:233], v[232:233], s[62:63]
  v_pk_fma_f32 v[66:67], v[234:235], v[234:235], s[62:63]
  v_pk_fma_f32 v[68:69], v[236:237], v[236:237], s[62:63]
  v_pk_fma_f32 v[70:71], v[238:239], v[238:239], s[62:63]
  v_pk_fma_f32 v[72:73], v[240:241], v[240:241], s[62:63]
  v_pk_fma_f32 v[74:75], v[242:243], v[242:243], s[62:63]
  v_pk_fma_f32 v[76:77], v[244:245], v[244:245], s[62:63]
  v_pk_fma_f32 v[78:79], v[246:247], v[246:247], s[62:63]
  v_pk_mul_f32 v[64:65], v[232:233], v[64:65] neg_lo:[1,0] neg_hi:[1,0]
  v_pk_mul_f32 v[66:67], v[234:235], v[66:67] neg_lo:[1,0] neg_hi:[1,0]
  v_pk_mul_f32 v[68:69], v[236:237], v[68:69] neg_lo:[1,0] neg_hi:[1,0]
  v_pk_mul_f32 v[70:71], v[238:239], v[70:71] neg_lo:[1,0] neg_hi:[1,0]
  v_pk_mul_f32 v[72:73], v[240:241], v[72:73] neg_lo:[1,0] neg_hi:[1,0]
  v_pk_mul_f32 v[74:75], v[242:243], v[74:75] neg_lo:[1,0] neg_hi:[1,0]
  v_pk_mul_f32 v[76:77], v[244:245], v[76:77] neg_lo:[1,0] neg_hi:[1,0]
  v_pk_mul_f32 v[78:79], v[246:247], v[78:79] neg_lo:[1,0] neg_hi:[1,0]
  v_pk_mul_f32 v[32:33], v[32:33], v[56:57]
  v_pk_mul_f32 v[34:35], v[34:35], v[58:59]
  v_pk_mul_f32 v[36:37], v[36:37], v[60:61]
  v_pk_mul_f32 v[38:39], v[38:39], v[62:63]
  v_pk_mul_f32 v[40:41], v[40:41], v[48:49]
  v_pk_mul_f32 v[42:43], v[42:43], v[50:51]
  v_pk_mul_f32 v[44:45], v[44:45], v[52:53]
  v_pk_mul_f32 v[46:47], v[46:47], v[54:55]
  v_pk_mul_f32 v[48:49], v[48:49], v[56:57]
  v_pk_mul_f32 v[50:51], v[50:51], v[58:59]
  v_pk_mul_f32 v[52:53], v[52:53], v[60:61]
  v_pk_mul_f32 v[54:55], v[54:55], v[62:63]
  s_waitcnt lgkmcnt(0)
  v_mfma_f32_32x32x16_bf16 v[0:15], a[48:51], a[0:3], 0
  v_exp_f32 v64, v64
  v_exp_f32 v65, v65
  v_cvt_pk_bf16_f32 v192, v16, v17
  v_cvt_pk_bf16_f32 v193, v18, v19
  v_mfma_f32_32x32x16_bf16 v[0:15], a[52:55], a[4:7], v[0:15]
  v_exp_f32 v66, v66
  v_exp_f32 v67, v67
  v_cvt_pk_bf16_f32 v194, v20, v21
  v_cvt_pk_bf16_f32 v195, v22, v23
  v_mfma_f32_32x32x16_bf16 v[0:15], a[56:59], a[8:11], v[0:15]
  v_exp_f32 v68, v68
  v_exp_f32 v69, v69
  v_cvt_pk_bf16_f32 v196, v24, v25
  v_cvt_pk_bf16_f32 v197, v26, v27
  v_mfma_f32_32x32x16_bf16 v[0:15], a[60:63], a[12:15], v[0:15]
  v_exp_f32 v70, v70
  v_exp_f32 v71, v71
  v_cvt_pk_bf16_f32 v198, v28, v29
  v_cvt_pk_bf16_f32 v199, v30, v31
  v_mfma_f32_32x32x16_bf16 v[0:15], a[64:67], a[16:19], v[0:15]
  v_exp_f32 v72, v72
  v_exp_f32 v73, v73
  v_fma_f32 v64, v64, s60, s60 clamp
  v_fma_f32 v65, v65, s60, s60 clamp
  v_mfma_f32_32x32x16_bf16 v[0:15], a[68:71], a[20:23], v[0:15]
  v_exp_f32 v74, v74
  v_exp_f32 v75, v75
  v_fma_f32 v66, v66, s60, s60 clamp
  v_fma_f32 v67, v67, s60, s60 clamp
  v_mfma_f32_32x32x16_bf16 v[0:15], a[72:75], a[24:27], v[0:15]
  v_exp_f32 v76, v76
  v_exp_f32 v77, v77
  v_fma_f32 v68, v68, s60, s60 clamp
  v_fma_f32 v69, v69, s60, s60 clamp
  v_mfma_f32_32x32x16_bf16 v[0:15], a[76:79], a[28:31], v[0:15]
  v_exp_f32 v78, v78
  v_exp_f32 v79, v79
  v_fma_f32 v70, v70, s60, s60 clamp
  v_fma_f32 v71, v71, s60, s60 clamp
  v_mfma_f32_32x32x16_bf16 v[0:15], a[80:83], a[32:35], v[0:15]
  v_rcp_f32 v48, v48
  v_rcp_f32 v49, v49
  v_fma_f32 v72, v72, s60, s60 clamp
  v_fma_f32 v73, v73, s60, s60 clamp
  v_mfma_f32_32x32x16_bf16 v[0:15], a[84:87], a[36:39], v[0:15]
  v_rcp_f32 v50, v50
  v_rcp_f32 v51, v51
  v_fma_f32 v74, v74, s60, s60 clamp
  v_fma_f32 v75, v75, s60, s60 clamp
  v_mfma_f32_32x32x16_bf16 v[0:15], a[88:91], a[40:43], v[0:15]
  v_rcp_f32 v52, v52
  v_rcp_f32 v53, v53
  v_fma_f32 v76, v76, s60, s60 clamp
  v_fma_f32 v77, v77, s60, s60 clamp
  v_mfma_f32_32x32x16_bf16 v[0:15], a[92:95], a[44:47], v[0:15]
  v_rcp_f32 v54, v54
  v_rcp_f32_e64 v55, v55
  v_fma_f32 v78, v78, s60, s60 clamp
  v_fma_f32 v79, v79, s60, s60 clamp
  v_pk_mul_f32 v[32:33], v[32:33], v[48:49]
  v_pk_mul_f32 v[34:35], v[34:35], v[50:51]
  v_pk_mul_f32 v[36:37], v[36:37], v[52:53]
  v_pk_mul_f32 v[38:39], v[38:39], v[54:55]
  v_pk_mul_f32 v[40:41], v[40:41], v[48:49]
  v_pk_mul_f32 v[42:43], v[42:43], v[50:51]
  v_pk_mul_f32 v[44:45], v[44:45], v[52:53]
  v_pk_mul_f32 v[46:47], v[46:47], v[54:55]
  v_pk_fma_f32 v[80:81], v[32:33], v[32:33], v[80:81]
  v_pk_fma_f32 v[82:83], v[34:35], v[34:35], v[82:83]
  v_pk_fma_f32 v[84:85], v[36:37], v[36:37], v[84:85]
  v_pk_fma_f32 v[86:87], v[38:39], v[38:39], v[86:87]
  v_pk_fma_f32 v[88:89], v[40:41], v[40:41], v[88:89]
  v_pk_fma_f32 v[90:91], v[42:43], v[42:43], v[90:91]
  v_pk_fma_f32 v[92:93], v[44:45], v[44:45], v[92:93]
  v_pk_fma_f32 v[94:95], v[46:47], v[46:47], v[94:95]
  v_pk_fma_f32 v[48:49], v[0:1], v[0:1], s[62:63]
  v_pk_fma_f32 v[50:51], v[2:3], v[2:3], s[62:63]
  v_pk_fma_f32 v[52:53], v[4:5], v[4:5], s[62:63]
  v_pk_fma_f32 v[54:55], v[6:7], v[6:7], s[62:63]
  v_pk_fma_f32 v[56:57], v[8:9], v[8:9], s[62:63]
  v_pk_fma_f32 v[58:59], v[10:11], v[10:11], s[62:63]
  v_pk_fma_f32 v[60:61], v[12:13], v[12:13], s[62:63]
  v_pk_fma_f32 v[62:63], v[14:15], v[14:15], s[62:63]
  v_pk_mul_f32 v[48:49], v[0:1], v[48:49] neg_lo:[1,0] neg_hi:[1,0]
  v_pk_mul_f32 v[50:51], v[2:3], v[50:51] neg_lo:[1,0] neg_hi:[1,0]
  v_pk_mul_f32 v[52:53], v[4:5], v[52:53] neg_lo:[1,0] neg_hi:[1,0]
  v_pk_mul_f32 v[54:55], v[6:7], v[54:55] neg_lo:[1,0] neg_hi:[1,0]
  v_pk_mul_f32 v[56:57], v[8:9], v[56:57] neg_lo:[1,0] neg_hi:[1,0]
  v_pk_mul_f32 v[58:59], v[10:11], v[58:59] neg_lo:[1,0] neg_hi:[1,0]
  v_pk_mul_f32 v[60:61], v[12:13], v[60:61] neg_lo:[1,0] neg_hi:[1,0]
  v_pk_mul_f32 v[62:63], v[14:15], v[62:63] neg_lo:[1,0] neg_hi:[1,0]
  v_pk_mul_f32 v[232:233], v[232:233], v[72:73]
  v_pk_mul_f32 v[234:235], v[234:235], v[74:75]
  v_pk_mul_f32 v[236:237], v[236:237], v[76:77]
  v_pk_mul_f32 v[238:239], v[238:239], v[78:79]
  v_pk_mul_f32 v[240:241], v[240:241], v[64:65]
  v_pk_mul_f32 v[242:243], v[242:243], v[66:67]
  v_pk_mul_f32 v[244:245], v[244:245], v[68:69]
  v_pk_mul_f32 v[246:247], v[246:247], v[70:71]
  v_pk_mul_f32 v[64:65], v[64:65], v[72:73]
  v_pk_mul_f32 v[66:67], v[66:67], v[74:75]
  v_pk_mul_f32 v[68:69], v[68:69], v[76:77]
  v_pk_mul_f32 v[70:71], v[70:71], v[78:79]
  v_mfma_f32_32x32x16_bf16 v[16:31], a[96:99], a[0:3], 0
  v_exp_f32 v48, v48
  v_exp_f32 v49, v49
  v_cvt_pk_bf16_f32 v200, v32, v33
  v_cvt_pk_bf16_f32 v201, v34, v35
  v_mfma_f32_32x32x16_bf16 v[16:31], a[100:103], a[4:7], v[16:31]
  ds_read_b128 a[0:3], v250 offset:13056
  v_exp_f32 v50, v50
  v_exp_f32 v51, v51
  v_cvt_pk_bf16_f32 v202, v36, v37
  v_mfma_f32_32x32x16_bf16 v[16:31], a[104:107], a[8:11], v[16:31]
  ds_read_b128 a[4:7], v250 offset:14080
  v_exp_f32 v52, v52
  v_exp_f32 v53, v53
  v_cvt_pk_bf16_f32 v203, v38, v39
  v_mfma_f32_32x32x16_bf16 v[16:31], a[108:111], a[12:15], v[16:31]
  ds_read_b128 a[8:11], v250 offset:15104
  v_exp_f32 v54, v54
  v_exp_f32 v55, v55
  v_cvt_pk_bf16_f32 v204, v40, v41
  v_mfma_f32_32x32x16_bf16 v[16:31], a[112:115], a[16:19], v[16:31]
  ds_read_b128 a[12:15], v250 offset:16128
  v_exp_f32 v56, v56
  v_exp_f32 v57, v57
  v_cvt_pk_bf16_f32 v205, v42, v43
  v_mfma_f32_32x32x16_bf16 v[16:31], a[116:119], a[20:23], v[16:31]
  ds_read_b128 a[16:19], v250 offset:17152
  v_exp_f32 v58, v58
  v_exp_f32 v59, v59
  v_cvt_pk_bf16_f32 v206, v44, v45
  v_mfma_f32_32x32x16_bf16 v[16:31], a[120:123], a[24:27], v[16:31]
  ds_read_b128 a[20:23], v250 offset:18176
  v_exp_f32 v60, v60
  v_exp_f32 v61, v61
  v_cvt_pk_bf16_f32 v207, v46, v47
  v_mfma_f32_32x32x16_bf16 v[16:31], a[124:127], a[28:31], v[16:31]
  ds_read_b128 a[24:27], v250 offset:19200
  v_exp_f32 v62, v62
  v_exp_f32 v63, v63
  v_fma_f32 v48, v48, s60, s60 clamp
  v_mfma_f32_32x32x16_bf16 v[16:31], a[128:131], a[32:35], v[16:31]
  ds_read_b128 a[28:31], v250 offset:20224
  v_rcp_f32 v64, v64
  v_rcp_f32 v65, v65
  v_fma_f32 v49, v49, s60, s60 clamp
  v_mfma_f32_32x32x16_bf16 v[16:31], a[132:135], a[36:39], v[16:31]
  ds_read_b128 a[32:35], v250 offset:21248
  v_rcp_f32 v66, v66
  v_rcp_f32 v67, v67
  v_fma_f32 v50, v50, s60, s60 clamp
  v_mfma_f32_32x32x16_bf16 v[16:31], a[136:139], a[40:43], v[16:31]
  ds_read_b128 a[36:39], v250 offset:22272
  v_rcp_f32 v68, v68
  v_rcp_f32 v69, v69
  v_fma_f32 v51, v51, s60, s60 clamp
  v_mfma_f32_32x32x16_bf16 v[16:31], a[140:143], a[44:47], v[16:31]
  ds_read_b128 a[40:43], v250 offset:23296
  ds_read_b128 a[44:47], v250 offset:24320
  v_rcp_f32 v70, v70
  v_rcp_f32 v71, v71
  v_fma_f32 v52, v52, s60, s60 clamp
  v_fma_f32 v53, v53, s60, s60 clamp
  v_fma_f32 v54, v54, s60, s60 clamp
  v_fma_f32 v55, v55, s60, s60 clamp
  v_pk_fma_f32 v[56:57], v[56:57], s[60:61], s[60:61] clamp
  v_pk_fma_f32 v[58:59], v[58:59], s[60:61], s[60:61] clamp
  v_pk_fma_f32 v[60:61], v[60:61], s[60:61], s[60:61] clamp
  v_pk_fma_f32 v[62:63], v[62:63], s[60:61], s[60:61] clamp
  v_pk_mul_f32 v[232:233], v[232:233], v[64:65]
  v_pk_mul_f32 v[234:235], v[234:235], v[66:67]
  v_pk_mul_f32 v[236:237], v[236:237], v[68:69]
  v_pk_mul_f32 v[238:239], v[238:239], v[70:71]
  v_pk_mul_f32 v[240:241], v[240:241], v[64:65]
  v_pk_mul_f32 v[242:243], v[242:243], v[66:67]
  v_pk_mul_f32 v[244:245], v[244:245], v[68:69]
  v_pk_mul_f32 v[246:247], v[246:247], v[70:71]
  v_pk_fma_f32 v[96:97], v[232:233], v[232:233], v[96:97]
  v_pk_fma_f32 v[98:99], v[234:235], v[234:235], v[98:99]
  v_pk_fma_f32 v[100:101], v[236:237], v[236:237], v[100:101]
  v_pk_fma_f32 v[102:103], v[238:239], v[238:239], v[102:103]
  v_pk_fma_f32 v[104:105], v[240:241], v[240:241], v[104:105]
  v_pk_fma_f32 v[106:107], v[242:243], v[242:243], v[106:107]
  v_pk_fma_f32 v[108:109], v[244:245], v[244:245], v[108:109]
  v_pk_fma_f32 v[110:111], v[246:247], v[246:247], v[110:111]
  v_pk_fma_f32 v[64:65], v[16:17], v[16:17], s[62:63]
  v_pk_fma_f32 v[66:67], v[18:19], v[18:19], s[62:63]
  v_pk_fma_f32 v[68:69], v[20:21], v[20:21], s[62:63]
  v_pk_fma_f32 v[70:71], v[22:23], v[22:23], s[62:63]
  v_pk_fma_f32 v[72:73], v[24:25], v[24:25], s[62:63]
  v_pk_fma_f32 v[74:75], v[26:27], v[26:27], s[62:63]
  v_pk_fma_f32 v[76:77], v[28:29], v[28:29], s[62:63]
  v_pk_fma_f32 v[78:79], v[30:31], v[30:31], s[62:63]
  v_pk_mul_f32 v[64:65], v[16:17], v[64:65] neg_lo:[1,0] neg_hi:[1,0]
  v_pk_mul_f32 v[66:67], v[18:19], v[66:67] neg_lo:[1,0] neg_hi:[1,0]
  v_pk_mul_f32 v[68:69], v[20:21], v[68:69] neg_lo:[1,0] neg_hi:[1,0]
  v_pk_mul_f32 v[70:71], v[22:23], v[70:71] neg_lo:[1,0] neg_hi:[1,0]
  v_pk_mul_f32 v[72:73], v[24:25], v[72:73] neg_lo:[1,0] neg_hi:[1,0]
  v_pk_mul_f32 v[74:75], v[26:27], v[74:75] neg_lo:[1,0] neg_hi:[1,0]
  v_pk_mul_f32 v[76:77], v[28:29], v[76:77] neg_lo:[1,0] neg_hi:[1,0]
  v_pk_mul_f32 v[78:79], v[30:31], v[78:79] neg_lo:[1,0] neg_hi:[1,0]
  v_pk_mul_f32 v[0:1], v[0:1], v[56:57]
  v_pk_mul_f32 v[2:3], v[2:3], v[58:59]
  v_pk_mul_f32 v[4:5], v[4:5], v[60:61]
  v_pk_mul_f32 v[6:7], v[6:7], v[62:63]
  v_pk_mul_f32 v[8:9], v[8:9], v[48:49]
  v_pk_mul_f32 v[10:11], v[10:11], v[50:51]
  v_pk_mul_f32 v[12:13], v[12:13], v[52:53]
  v_pk_mul_f32 v[14:15], v[14:15], v[54:55]
  v_pk_mul_f32 v[48:49], v[48:49], v[56:57]
  v_pk_mul_f32 v[50:51], v[50:51], v[58:59]
  v_pk_mul_f32 v[52:53], v[52:53], v[60:61]
  v_pk_mul_f32 v[54:55], v[54:55], v[62:63]
  s_waitcnt lgkmcnt(0)
  v_mfma_f32_32x32x16_bf16 v[32:47], a[48:51], a[0:3], 0
  v_exp_f32 v64, v64
  v_exp_f32 v65, v65
  v_cvt_pk_bf16_f32 v208, v232, v233
  v_cvt_pk_bf16_f32 v209, v234, v235
  v_mfma_f32_32x32x16_bf16 v[32:47], a[52:55], a[4:7], v[32:47]
  v_exp_f32 v66, v66
  v_exp_f32 v67, v67
  v_cvt_pk_bf16_f32 v210, v236, v237
  v_cvt_pk_bf16_f32 v211, v238, v239
  v_mfma_f32_32x32x16_bf16 v[32:47], a[56:59], a[8:11], v[32:47]
  v_exp_f32 v68, v68
  v_exp_f32 v69, v69
  v_cvt_pk_bf16_f32 v212, v240, v241
  v_cvt_pk_bf16_f32 v213, v242, v243
  v_mfma_f32_32x32x16_bf16 v[32:47], a[60:63], a[12:15], v[32:47]
  v_exp_f32 v70, v70
  v_exp_f32 v71, v71
  v_cvt_pk_bf16_f32 v214, v244, v245
  v_cvt_pk_bf16_f32 v215, v246, v247
  v_mfma_f32_32x32x16_bf16 v[32:47], a[64:67], a[16:19], v[32:47]
  v_exp_f32 v72, v72
  v_exp_f32 v73, v73
  v_fma_f32 v64, v64, s60, s60 clamp
  v_fma_f32 v65, v65, s60, s60 clamp
  v_mfma_f32_32x32x16_bf16 v[32:47], a[68:71], a[20:23], v[32:47]
  v_exp_f32 v74, v74
  v_exp_f32 v75, v75
  v_fma_f32 v66, v66, s60, s60 clamp
  v_fma_f32 v67, v67, s60, s60 clamp
  v_mfma_f32_32x32x16_bf16 v[32:47], a[72:75], a[24:27], v[32:47]
  v_exp_f32 v76, v76
  v_exp_f32 v77, v77
  v_fma_f32 v68, v68, s60, s60 clamp
  v_fma_f32 v69, v69, s60, s60 clamp
  v_mfma_f32_32x32x16_bf16 v[32:47], a[76:79], a[28:31], v[32:47]
  v_exp_f32 v78, v78
  v_exp_f32 v79, v79
  v_fma_f32 v70, v70, s60, s60 clamp
  v_fma_f32 v71, v71, s60, s60 clamp
  v_mfma_f32_32x32x16_bf16 v[32:47], a[80:83], a[32:35], v[32:47]
  v_rcp_f32 v48, v48
  v_rcp_f32 v49, v49
  v_fma_f32 v72, v72, s60, s60 clamp
  v_fma_f32 v73, v73, s60, s60 clamp
  v_mfma_f32_32x32x16_bf16 v[32:47], a[84:87], a[36:39], v[32:47]
  v_rcp_f32 v50, v50
  v_rcp_f32 v51, v51
  v_fma_f32 v74, v74, s60, s60 clamp
  v_fma_f32 v75, v75, s60, s60 clamp
  v_mfma_f32_32x32x16_bf16 v[32:47], a[88:91], a[40:43], v[32:47]
  v_rcp_f32 v52, v52
  v_rcp_f32 v53, v53
  v_fma_f32 v76, v76, s60, s60 clamp
  v_fma_f32 v77, v77, s60, s60 clamp
  v_mfma_f32_32x32x16_bf16 v[32:47], a[92:95], a[44:47], v[32:47]
  v_rcp_f32 v54, v54
  v_rcp_f32_e64 v55, v55
  v_fma_f32 v78, v78, s60, s60 clamp
  v_fma_f32 v79, v79, s60, s60 clamp
  v_pk_mul_f32 v[0:1], v[0:1], v[48:49]
  v_pk_mul_f32 v[2:3], v[2:3], v[50:51]
  v_pk_mul_f32 v[4:5], v[4:5], v[52:53]
  v_pk_mul_f32 v[6:7], v[6:7], v[54:55]
  v_pk_mul_f32 v[8:9], v[8:9], v[48:49]
  v_pk_mul_f32 v[10:11], v[10:11], v[50:51]
  v_pk_mul_f32 v[12:13], v[12:13], v[52:53]
  v_pk_mul_f32 v[14:15], v[14:15], v[54:55]
  v_pk_fma_f32 v[80:81], v[0:1], v[0:1], v[80:81]
  v_pk_fma_f32 v[82:83], v[2:3], v[2:3], v[82:83]
  v_pk_fma_f32 v[84:85], v[4:5], v[4:5], v[84:85]
  v_pk_fma_f32 v[86:87], v[6:7], v[6:7], v[86:87]
  v_pk_fma_f32 v[88:89], v[8:9], v[8:9], v[88:89]
  v_pk_fma_f32 v[90:91], v[10:11], v[10:11], v[90:91]
  v_pk_fma_f32 v[92:93], v[12:13], v[12:13], v[92:93]
  v_pk_fma_f32 v[94:95], v[14:15], v[14:15], v[94:95]
  v_cvt_pk_bf16_f32 v232, v0, v1
  v_cvt_pk_bf16_f32 v233, v2, v3
  v_cvt_pk_bf16_f32 v234, v4, v5
  v_cvt_pk_bf16_f32 v235, v6, v7
  v_cvt_pk_bf16_f32 v236, v8, v9
  v_cvt_pk_bf16_f32 v237, v10, v11
  v_cvt_pk_bf16_f32 v238, v12, v13
  v_cvt_pk_bf16_f32 v239, v14, v15
  v_pk_fma_f32 v[48:49], v[32:33], v[32:33], s[62:63]
  v_pk_fma_f32 v[50:51], v[34:35], v[34:35], s[62:63]
  v_pk_fma_f32 v[52:53], v[36:37], v[36:37], s[62:63]
  v_pk_fma_f32 v[54:55], v[38:39], v[38:39], s[62:63]
  v_pk_fma_f32 v[56:57], v[40:41], v[40:41], s[62:63]
  v_pk_fma_f32 v[58:59], v[42:43], v[42:43], s[62:63]
  v_pk_fma_f32 v[60:61], v[44:45], v[44:45], s[62:63]
  v_pk_fma_f32 v[62:63], v[46:47], v[46:47], s[62:63]
  v_pk_mul_f32 v[48:49], v[32:33], v[48:49] neg_lo:[1,0] neg_hi:[1,0]
  v_pk_mul_f32 v[50:51], v[34:35], v[50:51] neg_lo:[1,0] neg_hi:[1,0]
  v_pk_mul_f32 v[52:53], v[36:37], v[52:53] neg_lo:[1,0] neg_hi:[1,0]
  v_pk_mul_f32 v[54:55], v[38:39], v[54:55] neg_lo:[1,0] neg_hi:[1,0]
  v_pk_mul_f32 v[56:57], v[40:41], v[56:57] neg_lo:[1,0] neg_hi:[1,0]
  v_pk_mul_f32 v[58:59], v[42:43], v[58:59] neg_lo:[1,0] neg_hi:[1,0]
  v_pk_mul_f32 v[60:61], v[44:45], v[60:61] neg_lo:[1,0] neg_hi:[1,0]
  v_pk_mul_f32 v[62:63], v[46:47], v[62:63] neg_lo:[1,0] neg_hi:[1,0]
  v_pk_mul_f32 v[16:17], v[16:17], v[72:73]
  v_pk_mul_f32 v[18:19], v[18:19], v[74:75]
  v_pk_mul_f32 v[20:21], v[20:21], v[76:77]
  v_pk_mul_f32 v[22:23], v[22:23], v[78:79]
  v_pk_mul_f32 v[24:25], v[24:25], v[64:65]
  v_pk_mul_f32 v[26:27], v[26:27], v[66:67]
  v_pk_mul_f32 v[28:29], v[28:29], v[68:69]
  v_pk_mul_f32 v[30:31], v[30:31], v[70:71]
  v_pk_mul_f32 v[64:65], v[64:65], v[72:73]
  v_pk_mul_f32 v[66:67], v[66:67], v[74:75]
  v_pk_mul_f32 v[68:69], v[68:69], v[76:77]
  v_pk_mul_f32 v[70:71], v[70:71], v[78:79]
  v_mfma_f32_32x32x16_bf16 v[0:15], a[96:99], a[0:3], 0
  v_exp_f32 v48, v48
  v_exp_f32 v49, v49
  v_fma_f32 v48, v48, s60, s60 clamp
  v_mfma_f32_32x32x16_bf16 v[0:15], a[100:103], a[4:7], v[0:15]
  ds_read_b128 a[0:3], v250 offset:26112
  v_exp_f32 v50, v50
  v_exp_f32 v51, v51
  v_fma_f32 v49, v49, s60, s60 clamp
  v_mfma_f32_32x32x16_bf16 v[0:15], a[104:107], a[8:11], v[0:15]
  ds_read_b128 a[4:7], v250 offset:27136
  v_exp_f32 v52, v52
  v_exp_f32 v53, v53
  v_fma_f32 v50, v50, s60, s60 clamp
  v_mfma_f32_32x32x16_bf16 v[0:15], a[108:111], a[12:15], v[0:15]
  ds_read_b128 a[8:11], v250 offset:28160
  v_exp_f32 v54, v54
  v_exp_f32 v55, v55
  v_fma_f32 v51, v51, s60, s60 clamp
  v_mfma_f32_32x32x16_bf16 v[0:15], a[112:115], a[16:19], v[0:15]
  ds_read_b128 a[12:15], v250 offset:29184
  v_exp_f32 v56, v56
  v_exp_f32 v57, v57
  v_fma_f32 v52, v52, s60, s60 clamp
  v_mfma_f32_32x32x16_bf16 v[0:15], a[116:119], a[20:23], v[0:15]
  ds_read_b128 a[16:19], v250 offset:30208
  v_exp_f32 v58, v58
  v_exp_f32 v59, v59
  v_fma_f32 v53, v53, s60, s60 clamp
  v_mfma_f32_32x32x16_bf16 v[0:15], a[120:123], a[24:27], v[0:15]
  ds_read_b128 a[20:23], v250 offset:31232
  v_exp_f32 v60, v60
  v_exp_f32 v61, v61
  v_fma_f32 v54, v54, s60, s60 clamp
  v_mfma_f32_32x32x16_bf16 v[0:15], a[124:127], a[28:31], v[0:15]
  ds_read_b128 a[24:27], v250 offset:32256
  v_exp_f32 v62, v62
  v_exp_f32 v63, v63
  v_fma_f32 v55, v55, s60, s60 clamp
  v_mfma_f32_32x32x16_bf16 v[0:15], a[128:131], a[32:35], v[0:15]
  ds_read_b128 a[28:31], v250 offset:33280
  v_rcp_f32 v64, v64
  v_rcp_f32 v65, v65
  v_fma_f32 v56, v56, s60, s60 clamp
  v_mfma_f32_32x32x16_bf16 v[0:15], a[132:135], a[36:39], v[0:15]
  ds_read_b128 a[32:35], v250 offset:34304
  v_rcp_f32 v66, v66
  v_rcp_f32 v67, v67
  v_fma_f32 v57, v57, s60, s60 clamp
  v_mfma_f32_32x32x16_bf16 v[0:15], a[136:139], a[40:43], v[0:15]
  ds_read_b128 a[36:39], v250 offset:35328
  v_rcp_f32 v68, v68
  v_rcp_f32 v69, v69
  v_fma_f32 v58, v58, s60, s60 clamp
  v_mfma_f32_32x32x16_bf16 v[0:15], a[140:143], a[44:47], v[0:15]
  ds_read_b128 a[40:43], v250 offset:36352
  ds_read_b128 a[44:47], v250 offset:37376
  v_rcp_f32 v70, v70
  v_rcp_f32 v71, v71
  v_fma_f32 v59, v59, s60, s60 clamp
  v_fma_f32 v60, v60, s60, s60 clamp
  v_fma_f32 v61, v61, s60, s60 clamp
  v_pk_fma_f32 v[62:63], v[62:63], s[60:61], s[60:61] clamp
  v_pk_mul_f32 v[16:17], v[16:17], v[64:65]
  v_pk_mul_f32 v[18:19], v[18:19], v[66:67]
  v_pk_mul_f32 v[20:21], v[20:21], v[68:69]
  v_pk_mul_f32 v[22:23], v[22:23], v[70:71]
  v_pk_mul_f32 v[24:25], v[24:25], v[64:65]
  v_pk_mul_f32 v[26:27], v[26:27], v[66:67]
  v_pk_mul_f32 v[28:29], v[28:29], v[68:69]
  v_pk_mul_f32 v[30:31], v[30:31], v[70:71]
  v_pk_fma_f32 v[96:97], v[16:17], v[16:17], v[96:97]
  v_pk_fma_f32 v[98:99], v[18:19], v[18:19], v[98:99]
  v_pk_fma_f32 v[100:101], v[20:21], v[20:21], v[100:101]
  v_pk_fma_f32 v[102:103], v[22:23], v[22:23], v[102:103]
  v_pk_fma_f32 v[104:105], v[24:25], v[24:25], v[104:105]
  v_pk_fma_f32 v[106:107], v[26:27], v[26:27], v[106:107]
  v_pk_fma_f32 v[108:109], v[28:29], v[28:29], v[108:109]
  v_pk_fma_f32 v[110:111], v[30:31], v[30:31], v[110:111]
  v_cvt_pk_bf16_f32 v240, v16, v17
  v_cvt_pk_bf16_f32 v241, v18, v19
  v_cvt_pk_bf16_f32 v242, v20, v21
  v_cvt_pk_bf16_f32 v243, v22, v23
  v_cvt_pk_bf16_f32 v244, v24, v25
  v_cvt_pk_bf16_f32 v245, v26, v27
  v_cvt_pk_bf16_f32 v246, v28, v29
  v_cvt_pk_bf16_f32 v247, v30, v31
  v_pk_fma_f32 v[64:65], v[0:1], v[0:1], s[62:63]
  v_pk_fma_f32 v[66:67], v[2:3], v[2:3], s[62:63]
  v_pk_fma_f32 v[68:69], v[4:5], v[4:5], s[62:63]
  v_pk_fma_f32 v[70:71], v[6:7], v[6:7], s[62:63]
  v_pk_fma_f32 v[72:73], v[8:9], v[8:9], s[62:63]
  v_pk_fma_f32 v[74:75], v[10:11], v[10:11], s[62:63]
  v_pk_fma_f32 v[76:77], v[12:13], v[12:13], s[62:63]
  v_pk_fma_f32 v[78:79], v[14:15], v[14:15], s[62:63]
  v_pk_mul_f32 v[64:65], v[0:1], v[64:65] neg_lo:[1,0] neg_hi:[1,0]
  v_pk_mul_f32 v[66:67], v[2:3], v[66:67] neg_lo:[1,0] neg_hi:[1,0]
  v_pk_mul_f32 v[68:69], v[4:5], v[68:69] neg_lo:[1,0] neg_hi:[1,0]
  v_pk_mul_f32 v[70:71], v[6:7], v[70:71] neg_lo:[1,0] neg_hi:[1,0]
  v_pk_mul_f32 v[72:73], v[8:9], v[72:73] neg_lo:[1,0] neg_hi:[1,0]
  v_pk_mul_f32 v[74:75], v[10:11], v[74:75] neg_lo:[1,0] neg_hi:[1,0]
  v_pk_mul_f32 v[76:77], v[12:13], v[76:77] neg_lo:[1,0] neg_hi:[1,0]
  v_pk_mul_f32 v[78:79], v[14:15], v[78:79] neg_lo:[1,0] neg_hi:[1,0]
  v_pk_mul_f32 v[32:33], v[32:33], v[56:57]
  v_pk_mul_f32 v[34:35], v[34:35], v[58:59]
  v_pk_mul_f32 v[36:37], v[36:37], v[60:61]
  v_pk_mul_f32 v[38:39], v[38:39], v[62:63]
  v_pk_mul_f32 v[40:41], v[40:41], v[48:49]
  v_pk_mul_f32 v[42:43], v[42:43], v[50:51]
  v_pk_mul_f32 v[44:45], v[44:45], v[52:53]
  v_pk_mul_f32 v[46:47], v[46:47], v[54:55]
  v_pk_mul_f32 v[48:49], v[48:49], v[56:57]
  v_pk_mul_f32 v[50:51], v[50:51], v[58:59]
  v_pk_mul_f32 v[52:53], v[52:53], v[60:61]
  v_pk_mul_f32 v[54:55], v[54:55], v[62:63]
  s_waitcnt lgkmcnt(0)
  v_mfma_f32_32x32x16_bf16 v[16:31], a[48:51], a[0:3], 0
  v_exp_f32 v64, v64
  v_exp_f32 v65, v65
  v_fma_f32 v64, v64, s60, s60 clamp
  v_mfma_f32_32x32x16_bf16 v[16:31], a[52:55], a[4:7], v[16:31]
  v_exp_f32 v66, v66
  v_exp_f32 v67, v67
  v_fma_f32 v65, v65, s60, s60 clamp
  v_fma_f32 v66, v66, s60, s60 clamp
  v_mfma_f32_32x32x16_bf16 v[16:31], a[56:59], a[8:11], v[16:31]
  v_exp_f32 v68, v68
  v_exp_f32 v69, v69
  v_fma_f32 v67, v67, s60, s60 clamp
  v_fma_f32 v68, v68, s60, s60 clamp
  v_mfma_f32_32x32x16_bf16 v[16:31], a[60:63], a[12:15], v[16:31]
  v_exp_f32 v70, v70
  v_exp_f32 v71, v71
  v_fma_f32 v69, v69, s60, s60 clamp
  v_fma_f32 v70, v70, s60, s60 clamp
  v_mfma_f32_32x32x16_bf16 v[16:31], a[64:67], a[16:19], v[16:31]
  v_exp_f32 v72, v72
  v_exp_f32 v73, v73
  v_fma_f32 v71, v71, s60, s60 clamp
  v_fma_f32 v72, v72, s60, s60 clamp
  v_mfma_f32_32x32x16_bf16 v[16:31], a[68:71], a[20:23], v[16:31]
  v_exp_f32 v74, v74
  v_exp_f32 v75, v75
  v_fma_f32 v73, v73, s60, s60 clamp
  v_fma_f32 v74, v74, s60, s60 clamp
  v_mfma_f32_32x32x16_bf16 v[16:31], a[72:75], a[24:27], v[16:31]
  v_exp_f32 v76, v76
  v_exp_f32 v77, v77
  v_fma_f32 v75, v75, s60, s60 clamp
  v_fma_f32 v76, v76, s60, s60 clamp
  v_mfma_f32_32x32x16_bf16 v[16:31], a[76:79], a[28:31], v[16:31]
  v_exp_f32 v78, v78
  v_exp_f32 v79, v79
  v_fma_f32 v77, v77, s60, s60 clamp
  v_fma_f32 v78, v78, s60, s60 clamp
  v_mfma_f32_32x32x16_bf16 v[16:31], a[80:83], a[32:35], v[16:31]
  v_rcp_f32 v48, v48
  v_rcp_f32 v49, v49
  v_fma_f32 v79, v79, s60, s60 clamp
  v_mfma_f32_32x32x16_bf16 v[16:31], a[84:87], a[36:39], v[16:31]
  v_rcp_f32 v50, v50
  v_rcp_f32 v51, v51
  v_mfma_f32_32x32x16_bf16 v[16:31], a[88:91], a[40:43], v[16:31]
  v_rcp_f32 v52, v52
  v_rcp_f32 v53, v53
  v_mfma_f32_32x32x16_bf16 v[16:31], a[92:95], a[44:47], v[16:31]
  v_rcp_f32 v54, v54
  v_rcp_f32_e64 v55, v55
  v_pk_mul_f32 v[32:33], v[32:33], v[48:49]
  v_pk_mul_f32 v[34:35], v[34:35], v[50:51]
  v_pk_mul_f32 v[36:37], v[36:37], v[52:53]
  v_pk_mul_f32 v[38:39], v[38:39], v[54:55]
  v_pk_mul_f32 v[40:41], v[40:41], v[48:49]
  v_pk_mul_f32 v[42:43], v[42:43], v[50:51]
  v_pk_mul_f32 v[44:45], v[44:45], v[52:53]
  v_pk_mul_f32 v[46:47], v[46:47], v[54:55]
  v_pk_fma_f32 v[80:81], v[32:33], v[32:33], v[80:81]
  v_pk_fma_f32 v[82:83], v[34:35], v[34:35], v[82:83]
  v_pk_fma_f32 v[84:85], v[36:37], v[36:37], v[84:85]
  v_pk_fma_f32 v[86:87], v[38:39], v[38:39], v[86:87]
  v_pk_fma_f32 v[88:89], v[40:41], v[40:41], v[88:89]
  v_pk_fma_f32 v[90:91], v[42:43], v[42:43], v[90:91]
  v_pk_fma_f32 v[92:93], v[44:45], v[44:45], v[92:93]
  v_pk_fma_f32 v[94:95], v[46:47], v[46:47], v[94:95]
  v_cvt_pk_bf16_f32 v112, v32, v33
  v_cvt_pk_bf16_f32 v113, v34, v35
  v_cvt_pk_bf16_f32 v114, v36, v37
  v_cvt_pk_bf16_f32 v115, v38, v39
  v_cvt_pk_bf16_f32 v116, v40, v41
  v_cvt_pk_bf16_f32 v117, v42, v43
  v_cvt_pk_bf16_f32 v118, v44, v45
  v_cvt_pk_bf16_f32 v119, v46, v47
  v_pk_fma_f32 v[48:49], v[16:17], v[16:17], s[62:63]
  v_pk_fma_f32 v[50:51], v[18:19], v[18:19], s[62:63]
  v_pk_fma_f32 v[52:53], v[20:21], v[20:21], s[62:63]
  v_pk_fma_f32 v[54:55], v[22:23], v[22:23], s[62:63]
  v_pk_fma_f32 v[56:57], v[24:25], v[24:25], s[62:63]
  v_pk_fma_f32 v[58:59], v[26:27], v[26:27], s[62:63]
  v_pk_fma_f32 v[60:61], v[28:29], v[28:29], s[62:63]
  v_pk_fma_f32 v[62:63], v[30:31], v[30:31], s[62:63]
  v_pk_mul_f32 v[48:49], v[16:17], v[48:49] neg_lo:[1,0] neg_hi:[1,0]
  v_pk_mul_f32 v[50:51], v[18:19], v[50:51] neg_lo:[1,0] neg_hi:[1,0]
  v_pk_mul_f32 v[52:53], v[20:21], v[52:53] neg_lo:[1,0] neg_hi:[1,0]
  v_pk_mul_f32 v[54:55], v[22:23], v[54:55] neg_lo:[1,0] neg_hi:[1,0]
  v_pk_mul_f32 v[56:57], v[24:25], v[56:57] neg_lo:[1,0] neg_hi:[1,0]
  v_pk_mul_f32 v[58:59], v[26:27], v[58:59] neg_lo:[1,0] neg_hi:[1,0]
  v_pk_mul_f32 v[60:61], v[28:29], v[60:61] neg_lo:[1,0] neg_hi:[1,0]
  v_pk_mul_f32 v[62:63], v[30:31], v[62:63] neg_lo:[1,0] neg_hi:[1,0]
  v_pk_mul_f32 v[0:1], v[0:1], v[72:73]
  v_pk_mul_f32 v[2:3], v[2:3], v[74:75]
  v_pk_mul_f32 v[4:5], v[4:5], v[76:77]
  v_pk_mul_f32 v[6:7], v[6:7], v[78:79]
  v_pk_mul_f32 v[8:9], v[8:9], v[64:65]
  v_pk_mul_f32 v[10:11], v[10:11], v[66:67]
  v_pk_mul_f32 v[12:13], v[12:13], v[68:69]
  v_pk_mul_f32 v[14:15], v[14:15], v[70:71]
  v_pk_mul_f32 v[64:65], v[64:65], v[72:73]
  v_pk_mul_f32 v[66:67], v[66:67], v[74:75]
  v_pk_mul_f32 v[68:69], v[68:69], v[76:77]
  v_pk_mul_f32 v[70:71], v[70:71], v[78:79]
  v_mfma_f32_32x32x16_bf16 v[32:47], a[96:99], a[0:3], 0
  v_exp_f32 v48, v48
  v_exp_f32 v49, v49
  v_fma_f32 v48, v48, s60, s60 clamp
  v_mfma_f32_32x32x16_bf16 v[32:47], a[100:103], a[4:7], v[32:47]
  v_exp_f32 v50, v50
  v_exp_f32 v51, v51
  v_fma_f32 v49, v49, s60, s60 clamp
  v_fma_f32 v50, v50, s60, s60 clamp
  v_mfma_f32_32x32x16_bf16 v[32:47], a[104:107], a[8:11], v[32:47]
  v_exp_f32 v52, v52
  v_exp_f32 v53, v53
  v_fma_f32 v51, v51, s60, s60 clamp
  v_fma_f32 v52, v52, s60, s60 clamp
  v_mfma_f32_32x32x16_bf16 v[32:47], a[108:111], a[12:15], v[32:47]
  v_exp_f32 v54, v54
  v_exp_f32 v55, v55
  v_fma_f32 v53, v53, s60, s60 clamp
  v_fma_f32 v54, v54, s60, s60 clamp
  v_mfma_f32_32x32x16_bf16 v[32:47], a[112:115], a[16:19], v[32:47]
  v_exp_f32 v56, v56
  v_exp_f32 v57, v57
  v_fma_f32 v55, v55, s60, s60 clamp
  v_fma_f32 v56, v56, s60, s60 clamp
  v_mfma_f32_32x32x16_bf16 v[32:47], a[116:119], a[20:23], v[32:47]
  v_exp_f32 v58, v58
  v_exp_f32 v59, v59
  v_fma_f32 v57, v57, s60, s60 clamp
  v_fma_f32 v58, v58, s60, s60 clamp
  v_mfma_f32_32x32x16_bf16 v[32:47], a[120:123], a[24:27], v[32:47]
  v_exp_f32 v60, v60
  v_exp_f32 v61, v61
  v_fma_f32 v59, v59, s60, s60 clamp
  v_fma_f32 v60, v60, s60, s60 clamp
  v_mfma_f32_32x32x16_bf16 v[32:47], a[124:127], a[28:31], v[32:47]
  v_exp_f32 v62, v62
  v_exp_f32 v63, v63
  v_fma_f32 v61, v61, s60, s60 clamp
  v_fma_f32 v62, v62, s60, s60 clamp
  v_mfma_f32_32x32x16_bf16 v[32:47], a[128:131], a[32:35], v[32:47]
  v_rcp_f32 v64, v64
  v_rcp_f32 v65, v65
  v_fma_f32 v63, v63, s60, s60 clamp
  v_mfma_f32_32x32x16_bf16 v[32:47], a[132:135], a[36:39], v[32:47]
  v_rcp_f32 v66, v66
  v_rcp_f32 v67, v67
  v_mfma_f32_32x32x16_bf16 v[32:47], a[136:139], a[40:43], v[32:47]
  v_rcp_f32 v68, v68
  v_rcp_f32 v69, v69
  v_mfma_f32_32x32x16_bf16 v[32:47], a[140:143], a[44:47], v[32:47]
  v_rcp_f32 v70, v70
  v_rcp_f32 v71, v71
  v_pk_mul_f32 v[0:1], v[0:1], v[64:65]
  v_pk_mul_f32 v[2:3], v[2:3], v[66:67]
  v_pk_mul_f32 v[4:5], v[4:5], v[68:69]
  v_pk_mul_f32 v[6:7], v[6:7], v[70:71]
  v_pk_mul_f32 v[8:9], v[8:9], v[64:65]
  v_pk_mul_f32 v[10:11], v[10:11], v[66:67]
  v_pk_mul_f32 v[12:13], v[12:13], v[68:69]
  v_pk_mul_f32 v[14:15], v[14:15], v[70:71]
  v_pk_fma_f32 v[96:97], v[0:1], v[0:1], v[96:97]
  v_pk_fma_f32 v[98:99], v[2:3], v[2:3], v[98:99]
  v_pk_fma_f32 v[100:101], v[4:5], v[4:5], v[100:101]
  v_pk_fma_f32 v[102:103], v[6:7], v[6:7], v[102:103]
  v_pk_fma_f32 v[104:105], v[8:9], v[8:9], v[104:105]
  v_pk_fma_f32 v[106:107], v[10:11], v[10:11], v[106:107]
  v_pk_fma_f32 v[108:109], v[12:13], v[12:13], v[108:109]
  v_pk_fma_f32 v[110:111], v[14:15], v[14:15], v[110:111]
  v_cvt_pk_bf16_f32 v0, v0, v1
  v_cvt_pk_bf16_f32 v1, v2, v3
  v_cvt_pk_bf16_f32 v2, v4, v5
  v_cvt_pk_bf16_f32 v3, v6, v7
  v_cvt_pk_bf16_f32 v4, v8, v9
  v_cvt_pk_bf16_f32 v5, v10, v11
  v_cvt_pk_bf16_f32 v6, v12, v13
  v_cvt_pk_bf16_f32 v7, v14, v15
  v_pk_fma_f32 v[64:65], v[32:33], v[32:33], s[62:63]
  v_pk_fma_f32 v[66:67], v[34:35], v[34:35], s[62:63]
  v_pk_fma_f32 v[68:69], v[36:37], v[36:37], s[62:63]
  v_pk_fma_f32 v[70:71], v[38:39], v[38:39], s[62:63]
  v_pk_fma_f32 v[72:73], v[40:41], v[40:41], s[62:63]
  v_pk_fma_f32 v[74:75], v[42:43], v[42:43], s[62:63]
  v_pk_fma_f32 v[76:77], v[44:45], v[44:45], s[62:63]
  v_pk_fma_f32 v[78:79], v[46:47], v[46:47], s[62:63]
  v_pk_mul_f32 v[64:65], v[32:33], v[64:65] neg_lo:[1,0] neg_hi:[1,0]
  v_pk_mul_f32 v[66:67], v[34:35], v[66:67] neg_lo:[1,0] neg_hi:[1,0]
  v_pk_mul_f32 v[68:69], v[36:37], v[68:69] neg_lo:[1,0] neg_hi:[1,0]
  v_pk_mul_f32 v[70:71], v[38:39], v[70:71] neg_lo:[1,0] neg_hi:[1,0]
  v_pk_mul_f32 v[72:73], v[40:41], v[72:73] neg_lo:[1,0] neg_hi:[1,0]
  v_pk_mul_f32 v[74:75], v[42:43], v[74:75] neg_lo:[1,0] neg_hi:[1,0]
  v_pk_mul_f32 v[76:77], v[44:45], v[76:77] neg_lo:[1,0] neg_hi:[1,0]
  v_pk_mul_f32 v[78:79], v[46:47], v[78:79] neg_lo:[1,0] neg_hi:[1,0]
  v_pk_mul_f32 v[16:17], v[16:17], v[56:57]
  v_pk_mul_f32 v[18:19], v[18:19], v[58:59]
  v_pk_mul_f32 v[20:21], v[20:21], v[60:61]
  v_pk_mul_f32 v[22:23], v[22:23], v[62:63]
  v_pk_mul_f32 v[24:25], v[24:25], v[48:49]
  v_pk_mul_f32 v[26:27], v[26:27], v[50:51]
  v_pk_mul_f32 v[28:29], v[28:29], v[52:53]
  v_pk_mul_f32 v[30:31], v[30:31], v[54:55]
  v_pk_mul_f32 v[48:49], v[48:49], v[56:57]
  v_pk_mul_f32 v[50:51], v[50:51], v[58:59]
  v_pk_mul_f32 v[52:53], v[52:53], v[60:61]
  v_pk_mul_f32 v[54:55], v[54:55], v[62:63]
  v_exp_f32 v64, v64
  v_exp_f32 v65, v65
  v_exp_f32 v66, v66
  v_exp_f32 v67, v67
  v_exp_f32 v68, v68
  v_exp_f32 v69, v69
  v_exp_f32 v70, v70
  v_exp_f32 v71, v71
  v_exp_f32 v72, v72
  v_exp_f32 v73, v73
  v_exp_f32 v74, v74
  v_exp_f32 v75, v75
  v_exp_f32 v76, v76
  v_exp_f32 v77, v77
  v_exp_f32 v78, v78
  v_exp_f32 v79, v79
  v_rcp_f32 v48, v48
  v_rcp_f32 v49, v49
  v_rcp_f32 v50, v50
  v_rcp_f32 v51, v51
  v_rcp_f32 v52, v52
  v_rcp_f32 v53, v53
  v_rcp_f32 v54, v54
  v_rcp_f32 v55, v55
  v_pk_fma_f32 v[64:65], v[64:65], s[60:61], s[60:61] clamp
  v_pk_fma_f32 v[66:67], v[66:67], s[60:61], s[60:61] clamp
  v_pk_fma_f32 v[68:69], v[68:69], s[60:61], s[60:61] clamp
  v_pk_fma_f32 v[70:71], v[70:71], s[60:61], s[60:61] clamp
  v_pk_fma_f32 v[72:73], v[72:73], s[60:61], s[60:61] clamp
  v_pk_fma_f32 v[74:75], v[74:75], s[60:61], s[60:61] clamp
  v_pk_fma_f32 v[76:77], v[76:77], s[60:61], s[60:61] clamp
  v_pk_fma_f32 v[78:79], v[78:79], s[60:61], s[60:61] clamp
  v_pk_mul_f32 v[16:17], v[16:17], v[48:49]
  v_pk_mul_f32 v[18:19], v[18:19], v[50:51]
  v_pk_mul_f32 v[20:21], v[20:21], v[52:53]
  v_pk_mul_f32 v[22:23], v[22:23], v[54:55]
  v_pk_mul_f32 v[24:25], v[24:25], v[48:49]
  v_pk_mul_f32 v[26:27], v[26:27], v[50:51]
  v_pk_mul_f32 v[28:29], v[28:29], v[52:53]
  v_pk_mul_f32 v[30:31], v[30:31], v[54:55]
  v_pk_fma_f32 v[80:81], v[16:17], v[16:17], v[80:81]
  v_pk_fma_f32 v[82:83], v[18:19], v[18:19], v[82:83]
  v_pk_fma_f32 v[84:85], v[20:21], v[20:21], v[84:85]
  v_pk_fma_f32 v[86:87], v[22:23], v[22:23], v[86:87]
  v_pk_fma_f32 v[88:89], v[24:25], v[24:25], v[88:89]
  v_pk_fma_f32 v[90:91], v[26:27], v[26:27], v[90:91]
  v_pk_fma_f32 v[92:93], v[28:29], v[28:29], v[92:93]
  v_pk_fma_f32 v[94:95], v[30:31], v[30:31], v[94:95]
  v_permlane16_swap_b32 v80, v88
  v_permlane16_swap_b32 v81, v89
  v_permlane16_swap_b32 v82, v90
  v_permlane16_swap_b32 v83, v91
  v_permlane16_swap_b32 v84, v92
  v_permlane16_swap_b32 v85, v93
  v_permlane16_swap_b32 v86, v94
  v_permlane16_swap_b32 v87, v95
  v_pk_add_f32 v[80:81], v[80:81], v[88:89]
  v_pk_add_f32 v[82:83], v[82:83], v[90:91]
  v_pk_add_f32 v[84:85], v[84:85], v[92:93]
  v_pk_add_f32 v[86:87], v[86:87], v[94:95]
  v_add_f32_dpp v80, v80, v80 row_ror:8 row_mask:0xf bank_mask:0x3
  v_add_f32_dpp v81, v81, v81 row_ror:8 row_mask:0xf bank_mask:0x3
  v_add_f32_dpp v82, v82, v82 row_ror:8 row_mask:0xf bank_mask:0x3
  v_add_f32_dpp v83, v83, v83 row_ror:8 row_mask:0xf bank_mask:0x3
  v_add_f32_dpp v80, v84, v84 row_ror:8 row_mask:0xf bank_mask:0xc
  v_add_f32_dpp v81, v85, v85 row_ror:8 row_mask:0xf bank_mask:0xc
  v_add_f32_dpp v82, v86, v86 row_ror:8 row_mask:0xf bank_mask:0xc
  v_add_f32_dpp v83, v87, v87 row_ror:8 row_mask:0xf bank_mask:0xc
  v_add_f32_dpp v80, v80, v80 row_half_mirror row_mask:0xf bank_mask:0x5
  v_add_f32_dpp v81, v81, v81 row_half_mirror row_mask:0xf bank_mask:0x5
  s_nop 0
  v_add_f32_dpp v80, v82, v82 row_half_mirror row_mask:0xf bank_mask:0xa
  v_add_f32_dpp v81, v83, v83 row_half_mirror row_mask:0xf bank_mask:0xa
  v_cndmask_b32 v82, v80, v81, s[6:7]
  v_cndmask_b32 v83, v81, v80, s[6:7]
  s_nop 1
  v_add_f32_dpp v82, v83, v82 quad_perm:[1,0,3,2] row_mask:0xf bank_mask:0xf
  s_nop 1
  v_add_f32_dpp v12, v82, v82 quad_perm:[2,3,0,1] row_mask:0xf bank_mask:0xf
  v_cndmask_b32 v13, v12, 1.0, s[64:65]
  buffer_atomic_add_f32 v13, v251, s[20:23], s77 offen offset:1024 sc0 sc1
  v_pk_mul_f32 v[32:33], v[32:33], v[72:73]
  v_pk_mul_f32 v[34:35], v[34:35], v[74:75]
  v_pk_mul_f32 v[36:37], v[36:37], v[76:77]
  v_pk_mul_f32 v[38:39], v[38:39], v[78:79]
  v_pk_mul_f32 v[40:41], v[40:41], v[64:65]
  v_pk_mul_f32 v[42:43], v[42:43], v[66:67]
  v_pk_mul_f32 v[44:45], v[44:45], v[68:69]
  v_pk_mul_f32 v[46:47], v[46:47], v[70:71]
  v_pk_mul_f32 v[64:65], v[64:65], v[72:73]
  v_pk_mul_f32 v[66:67], v[66:67], v[74:75]
  v_pk_mul_f32 v[68:69], v[68:69], v[76:77]
  v_pk_mul_f32 v[70:71], v[70:71], v[78:79]
  v_rcp_f32 v64, v64
  s_add_u32 s47, s44, 0
  buffer_load_dwordx4 v[48:51], v248, s[20:23], s47 offen sc1
  v_rcp_f32 v65, v65
  v_rcp_f32 v66, v66
  s_add_u32 s47, s44, 6144
  buffer_load_dwordx4 v[52:55], v248, s[20:23], s47 offen sc1
  v_rcp_f32 v67, v67
  v_rcp_f32 v68, v68
  s_add_u32 s47, s44, 12288
  buffer_load_dwordx4 v[56:59], v248, s[20:23], s47 offen sc1
  v_rcp_f32 v69, v69
  v_rcp_f32 v70, v70
  s_add_u32 s47, s44, 18432
  buffer_load_dwordx4 v[60:63], v248, s[20:23], s47 offen sc1
  v_rcp_f32 v71, v71
  v_pk_mul_f32 v[32:33], v[32:33], v[64:65]
  v_pk_mul_f32 v[34:35], v[34:35], v[66:67]
  v_pk_mul_f32 v[36:37], v[36:37], v[68:69]
  v_pk_mul_f32 v[38:39], v[38:39], v[70:71]
  v_pk_mul_f32 v[40:41], v[40:41], v[64:65]
  v_pk_mul_f32 v[42:43], v[42:43], v[66:67]
  v_pk_mul_f32 v[44:45], v[44:45], v[68:69]
  v_pk_mul_f32 v[46:47], v[46:47], v[70:71]
  v_pk_fma_f32 v[96:97], v[32:33], v[32:33], v[96:97]
  v_pk_fma_f32 v[98:99], v[34:35], v[34:35], v[98:99]
  v_pk_fma_f32 v[100:101], v[36:37], v[36:37], v[100:101]
  v_pk_fma_f32 v[102:103], v[38:39], v[38:39], v[102:103]
  v_pk_fma_f32 v[104:105], v[40:41], v[40:41], v[104:105]
  v_pk_fma_f32 v[106:107], v[42:43], v[42:43], v[106:107]
  v_pk_fma_f32 v[108:109], v[44:45], v[44:45], v[108:109]
  v_pk_fma_f32 v[110:111], v[46:47], v[46:47], v[110:111]
  v_permlane16_swap_b32 v96, v104
  v_permlane16_swap_b32 v97, v105
  v_permlane16_swap_b32 v98, v106
  v_permlane16_swap_b32 v99, v107
  v_permlane16_swap_b32 v100, v108
  v_permlane16_swap_b32 v101, v109
  v_permlane16_swap_b32 v102, v110
  v_permlane16_swap_b32 v103, v111
  v_pk_add_f32 v[96:97], v[96:97], v[104:105]
  v_pk_add_f32 v[98:99], v[98:99], v[106:107]
  v_pk_add_f32 v[100:101], v[100:101], v[108:109]
  v_pk_add_f32 v[102:103], v[102:103], v[110:111]
  v_add_f32_dpp v96, v96, v96 row_ror:8 row_mask:0xf bank_mask:0x3
  v_add_f32_dpp v97, v97, v97 row_ror:8 row_mask:0xf bank_mask:0x3
  v_add_f32_dpp v98, v98, v98 row_ror:8 row_mask:0xf bank_mask:0x3
  v_add_f32_dpp v99, v99, v99 row_ror:8 row_mask:0xf bank_mask:0x3
  v_add_f32_dpp v96, v100, v100 row_ror:8 row_mask:0xf bank_mask:0xc
  v_add_f32_dpp v97, v101, v101 row_ror:8 row_mask:0xf bank_mask:0xc
  v_add_f32_dpp v98, v102, v102 row_ror:8 row_mask:0xf bank_mask:0xc
  v_add_f32_dpp v99, v103, v103 row_ror:8 row_mask:0xf bank_mask:0xc
  v_add_f32_dpp v96, v96, v96 row_half_mirror row_mask:0xf bank_mask:0x5
  v_add_f32_dpp v97, v97, v97 row_half_mirror row_mask:0xf bank_mask:0x5
  s_nop 0
  v_add_f32_dpp v96, v98, v98 row_half_mirror row_mask:0xf bank_mask:0xa
  v_add_f32_dpp v97, v99, v99 row_half_mirror row_mask:0xf bank_mask:0xa
  v_cndmask_b32 v98, v96, v97, s[6:7]
  v_cndmask_b32 v99, v97, v96, s[6:7]
  s_nop 1
  v_add_f32_dpp v98, v99, v98 quad_perm:[1,0,3,2] row_mask:0xf bank_mask:0xf
  s_nop 1
  v_add_f32_dpp v14, v98, v98 quad_perm:[2,3,0,1] row_mask:0xf bank_mask:0xf
  v_cndmask_b32 v15, v14, 1.0, s[64:65]
  buffer_atomic_add_f32 v15, v251, s[20:23], s77 offen offset:1280 sc0 sc1
  v_cvt_pk_bf16_f32 v16, v16, v17
  v_cvt_pk_bf16_f32 v17, v18, v19
  v_cvt_pk_bf16_f32 v18, v20, v21
  s_add_u32 s41, s79, 12288
  buffer_load_dwordx4 v[96:99], v248, s[20:23], s41 offen offset:0 sc1
  v_cvt_pk_bf16_f32 v19, v22, v23
  v_cvt_pk_bf16_f32 v20, v24, v25
  v_cvt_pk_bf16_f32 v21, v26, v27
  buffer_load_dwordx4 v[100:103], v248, s[20:23], s41 offen offset:1024 sc1
  v_cvt_pk_bf16_f32 v22, v28, v29
  v_cvt_pk_bf16_f32 v23, v30, v31
  v_cvt_pk_bf16_f32 v32, v32, v33
  s_add_u32 s41, s79, 14336
  buffer_load_dwordx4 v[104:107], v248, s[20:23], s41 offen offset:0 sc1
  v_cvt_pk_bf16_f32 v33, v34, v35
  v_cvt_pk_bf16_f32 v34, v36, v37
  v_cvt_pk_bf16_f32 v35, v38, v39
  buffer_load_dwordx4 v[108:111], v248, s[20:23], s41 offen offset:1024 sc1
  s_waitcnt vmcnt(9)
  v_mov_b32_dpp v8, v13 quad_perm:[2,3,0,1] row_mask:0xf bank_mask:0xf
  v_add_f32 v12, v12, v13
  v_cmp_eq_f32 vcc, s50, v8
  v_lshrrev_b32 v9, 1, v251
  s_andn2_b64 exec, vcc, s[64:65]
  s_cbranch_execz L_pub4
  buffer_store_dword v12, v9, s[20:23], s51 offen offset:0 sc1
L_pub4:
  s_mov_b64 exec, -1
  v_cvt_pk_bf16_f32 v36, v40, v41
  v_cvt_pk_bf16_f32 v37, v42, v43
  v_cvt_pk_bf16_f32 v38, v44, v45
  s_add_u32 s41, s79, 4096
  buffer_load_dwordx4 v[64:67], v248, s[20:23], s41 offen offset:0 sc1
  v_cvt_pk_bf16_f32 v39, v46, v47
  v_accvgpr_write_b32 a128, v32
  v_accvgpr_write_b32 a129, v33
  buffer_load_dwordx4 v[68:71], v248, s[20:23], s41 offen offset:1024 sc1
  v_accvgpr_write_b32 a130, v34
  v_accvgpr_write_b32 a131, v35
  v_accvgpr_write_b32 a132, v36
  s_add_u32 s41, s79, 6144
  buffer_load_dwordx4 v[72:75], v248, s[20:23], s41 offen offset:0 sc1
  v_accvgpr_write_b32 a133, v37
  v_accvgpr_write_b32 a134, v38
  v_accvgpr_write_b32 a135, v39
  buffer_load_dwordx4 v[76:79], v248, s[20:23], s41 offen offset:1024 sc1
  v_accvgpr_write_b32 a120, v16
  v_accvgpr_write_b32 a121, v17
  v_accvgpr_write_b32 a122, v18
  s_add_u32 s41, s79, 8192
  buffer_load_dwordx4 v[80:83], v248, s[20:23], s41 offen offset:0 sc1
  v_accvgpr_write_b32 a123, v19
  v_accvgpr_write_b32 a124, v20
  v_accvgpr_write_b32 a125, v21
  buffer_load_dwordx4 v[84:87], v248, s[20:23], s41 offen offset:1024 sc1
  s_waitcnt vmcnt(10)
  v_mov_b32_dpp v8, v15 quad_perm:[2,3,0,1] row_mask:0xf bank_mask:0xf
  v_add_f32 v14, v14, v15
  v_cmp_eq_f32 vcc, s50, v8
  v_lshrrev_b32 v9, 1, v251
  s_andn2_b64 exec, vcc, s[64:65]
  s_cbranch_execz L_pub5
  buffer_store_dword v14, v9, s[20:23], s51 offen offset:128 sc1
L_pub5:
  s_mov_b64 exec, -1
  v_accvgpr_write_b32 a126, v22
  v_accvgpr_write_b32 a127, v23
  v_accvgpr_write_b32 a112, v0
  s_add_u32 s41, s79, 10240
  buffer_load_dwordx4 v[88:91], v248, s[20:23], s41 offen offset:0 sc1
  v_accvgpr_write_b32 a113, v1
  v_accvgpr_write_b32 a114, v2
  v_accvgpr_write_b32 a115, v3
  buffer_load_dwordx4 v[92:95], v248, s[20:23], s41 offen offset:1024 sc1
  v_accvgpr_write_b32 a116, v4
  v_accvgpr_write_b32 a117, v5
  v_accvgpr_write_b32 a118, v6
  v_accvgpr_write_b32 a119, v7
  v_accvgpr_write_b32 a104, v112
  v_accvgpr_write_b32 a105, v113
  v_accvgpr_write_b32 a106, v114
  v_accvgpr_write_b32 a107, v115
  s_add_u32 s41, s79, 22528
  buffer_load_dwordx4 v[40:43], v248, s[20:23], s41 offen offset:0 sc1
  v_accvgpr_write_b32 a108, v116
  v_accvgpr_write_b32 a109, v117
  v_accvgpr_write_b32 a110, v118
  v_accvgpr_write_b32 a111, v119
  buffer_load_dwordx4 v[44:47], v248, s[20:23], s41 offen offset:1024 sc1
  v_accvgpr_write_b32 a72, v216
  v_accvgpr_write_b32 a73, v217
  v_accvgpr_write_b32 a74, v218
  v_accvgpr_write_b32 a75, v219
  s_add_u32 s41, s79, 16384
  buffer_load_dwordx4 v[112:115], v248, s[20:23], s41 offen offset:0 sc1
  v_accvgpr_write_b32 a76, v220
  v_accvgpr_write_b32 a77, v221
  v_accvgpr_write_b32 a78, v222
  v_accvgpr_write_b32 a79, v223
  buffer_load_dwordx4 v[116:119], v248, s[20:23], s41 offen offset:1024 sc1
  v_accvgpr_write_b32 a80, v224
  v_accvgpr_write_b32 a81, v225
  v_accvgpr_write_b32 a82, v226
  v_accvgpr_write_b32 a83, v227
  v_accvgpr_write_b32 a84, v228
  v_accvgpr_write_b32 a85, v229
  v_accvgpr_write_b32 a86, v230
  v_accvgpr_write_b32 a87, v231
  v_mov_b32 v31, v254
  v_lshrrev_b32 v28, 4, v248
  v_lshrrev_b32 v29, 9, v248
  s_add_u32 s41, s79, 18432
  buffer_load_dwordx4 v[216:219], v248, s[20:23], s41 offen offset:0 sc1
  v_bfe_u32 v30, v248, 4, 5
  v_and_b32 v25, 0xffff0000, v253
  v_lshlrev_b32 v24, 16, v253
  buffer_load_dwordx4 v[220:223], v248, s[20:23], s41 offen offset:1024 sc1
  v_and_b32 v27, 0xffff0000, v255
  v_lshlrev_b32 v26, 16, v255
  s_movk_i32 s42, 384
  s_add_u32 s41, s79, 20480
  buffer_load_dwordx4 v[224:227], v248, s[20:23], s41 offen offset:0 sc1
  s_lshl_b32 s43, s3, 4
  v_mul_u32_u24 v253, s42, v30
  v_lshlrev_b32 v34, 31, v29
  buffer_load_dwordx4 v[228:231], v248, s[20:23], s41 offen offset:1024 sc1
  v_add3_u32 v253, v253, s43, v34
  v_accvgpr_write_b32 a88, v232
  v_accvgpr_write_b32 a89, v233
  v_accvgpr_write_b32 a90, v234
  v_accvgpr_write_b32 a91, v235
  v_accvgpr_write_b32 a92, v236
  v_accvgpr_write_b32 a93, v237
  v_accvgpr_write_b32 a94, v238
  v_accvgpr_write_b32 a95, v239
  buffer_load_dwordx4 a[48:51], v253, s[8:11], s70 offen offset:0
  v_accvgpr_write_b32 a96, v240
  v_accvgpr_write_b32 a97, v241
  v_accvgpr_write_b32 a98, v242
  v_accvgpr_write_b32 a99, v243
  v_accvgpr_write_b32 a100, v244
  v_accvgpr_write_b32 a101, v245
  v_accvgpr_write_b32 a102, v246
  v_accvgpr_write_b32 a103, v247
  buffer_load_dwordx4 a[52:55], v253, s[8:11], s71 offen offset:0
  s_mul_i32 s47, s3, 4352
  s_add_u32 s47, s47, 8192
  s_movk_i32 s48, 544
  v_mul_u32_u24 v249, s48, v29
  v_lshl_add_u32 v249, v30, 4, v249
  v_add_u32 v249, s47, v249
  v_bfe_u32 v32, v28, 2, 3
  s_lshl_b32 s47, s3, 3
  s_add_u32 s40, s3, 2
  s_mul_i32 s40, s40, 86016
  s_add_u32 s40, s40, s70
  buffer_load_dword v0, v253, s[8:11], s40 offen offset:0
  v_add_u32 v32, s47, v32
  v_and_b32 v33, 3, v28
  v_lshl_add_u32 v34, v33, 1, v29
  v_mul_u32_u24 v250, s48, v34
  v_lshl_add_u32 v250, v32, 4, v250
  v_add_u32 v250, 8192, v250
  v_mul_u32_u24 v32, s42, v32
  v_lshl_add_u32 v32, v33, 4, v32
  buffer_load_dword v0, v253, s[8:11], s76 offen offset:0
  s_mov_b32 s47, 86016
  v_mad_u32_u24 v251, v29, s47, v32
  s_mov_b32 s47, 516032
  v_mul_u32_u24 v33, s47, v29
  v_sub_u32 v32, v32, v33
  v_add_u32 v255, 516096, v32
  s_lshl_b32 s47, s3, 10
  v_lshl_add_u32 v254, v29, 4, s47
  ds_read_b128 a[136:139], v252 offset:14336
  s_add_u32 s47, s47, 4096
  v_lshl_add_u32 v32, v28, 3, s47
  v_lshl_add_u32 v33, v30, 3, s47
  s_lshl_b32 s47, s3, 3
  v_subrev_u32 v35, s47, v28
  v_lshrrev_b32 v35, 1, v35
  v_and_b32 v30, 1, v28
  v_lshlrev_b32 v30, 4, v30
  ds_read_b128 a[140:143], v252 offset:15360
  v_mov_b32 v29, 0x3f80
  v_lshlrev_b32 v30, v30, v29
  v_cmp_eq_u32 vcc, 0, v35
  s_nop 1
  v_cndmask_b32 v29, 0, v30, vcc
  v_accvgpr_write_b32 a60, v29
  v_cmp_eq_u32 vcc, 1, v35
  s_nop 1
  v_cndmask_b32 v29, 0, v30, vcc
  v_accvgpr_write_b32 a61, v29
  ds_read_b128 a[64:67], v252 offset:0
  v_cmp_eq_u32 vcc, 2, v35
  s_nop 1
  v_cndmask_b32 v29, 0, v30, vcc
  v_accvgpr_write_b32 a62, v29
  v_cmp_eq_u32 vcc, 3, v35
  s_nop 1
  v_cndmask_b32 v29, 0, v30, vcc
  v_accvgpr_write_b32 a63, v29
  s_mov_b32 s48, 0x2291afa4
  s_mov_b32 s49, 0x42600000
  ds_read_b128 a[68:71], v252 offset:1024
  v_mov_b32 v29, 0x358637bd
  v_mov_b32 v30, 0x31088e99
  s_lshl_b32 s47, s3, 2
  s_add_u32 s47, s47, 768
  v_mov_b32 v28, s47
  v_mov_b32 v22, 768
  v_mov_b32 v23, 0x3aaaaaab
  ds_read_b128 a[32:35], v254 offset:0
  ds_read_b128 a[36:39], v254 offset:32
  ds_read_b128 a[40:43], v254 offset:64
  ds_read_b128 a[44:47], v254 offset:96
  v_min3_f32 v36, v49, v51, v53
  v_min3_f32 v37, v55, v57, v59
  v_min3_f32 v36, v36, v61, v63
  v_min_f32 v36, v36, v37
  v_cmp_neq_f32 vcc, s49, v36
  s_cbranch_vccnz L_slow2
L_back2:
  v_add_f32 v48, v48, v52
  v_add_f32 v56, v56, v60
  v_add_f32 v50, v50, v54
  v_add_f32 v58, v58, v62
  v_add_f32 v16, v48, v56
  v_add_f32 v18, v50, v58
  buffer_load_dwordx2 v[8:9], v31, s[20:23], s46 offen sc1
  buffer_load_dwordx2 v[10:11], v31, s[20:23], s46 offen offset:512 sc1
  v_fma_f32 v16, v16, s48, v29
  v_fma_f32 v18, v18, s48, v29
  s_add_u32 s41, s79, 0
  buffer_load_dwordx4 v[48:51], v248, s[20:23], s41 offen offset:0 sc1
  v_sqrt_f32 v16, v16
  v_sqrt_f32 v18, v18
  buffer_load_dwordx4 v[52:55], v248, s[20:23], s41 offen offset:1024 sc1
  v_add_f32 v20, v16, v18
  v_mul_f32 v24, v24, v16
  s_add_u32 s41, s79, 2048
  buffer_load_dwordx4 v[56:59], v248, s[20:23], s41 offen offset:0 sc1
  v_mul_f32 v25, v25, v18
  s_mov_b32 s4, 262144
  buffer_load_dwordx4 v[60:63], v248, s[20:23], s41 offen offset:1024 sc1
  s_add_u32 s52, s79, 24576
  s_add_u32 s53, s79, 28672
  s_add_u32 s54, s79, 32768
  s_add_u32 s55, s79, 36864
  s_add_u32 s56, s79, 40960
  s_add_u32 s57, s79, 45056
  s_mul_i32 s42, s3, 49152
  s_add_u32 s42, s42, 491520
  s_add_u32 s43, s42, 4096
  s_add_u32 s44, s42, 8192
  s_lshl_b32 s45, s3, 2
  v_subrev_u32 v12, 3648, v32
  s_mov_b32 exec_lo, 0
  s_mov_b32 exec_hi, 0xffff0000
  ds_write_b64 v12, v[24:25]
  s_mov_b64 exec, -1
  ds_read_b128 v[232:235], v254 offset:832
  ds_read_b128 v[236:239], v254 offset:864
  ds_read_b128 v[240:243], v254 offset:896
  ds_read_b128 v[244:247], v254 offset:928
  s_waitcnt vmcnt(4)
  s_branch L_chk
L_poll:
  buffer_load_dwordx2 v[8:9], v31, s[20:23], s46 offen sc1
  buffer_load_dwordx2 v[10:11], v31, s[20:23], s46 offen offset:512 sc1
  s_waitcnt vmcnt(0)
L_chk:
  v_max3_u32 v36, v8, v9, v10
  v_max_u32 v36, v36, v11
  v_cmp_eq_u32 vcc, -1, v36
  s_sub_u32 s4, s4, 1
  s_cbranch_scc1 L_polled
  s_cbranch_vccnz L_poll
L_polled:
  v_add_f32 v8, v8, v10
  v_add_f32 v10, v9, v11
  v_mov_b32 v9, v8
  v_mov_b32 v11, v10
  s_nop 0
  v_permlane32_swap_b32 v8, v9
  v_permlane32_swap_b32 v10, v11
  v_add_f32 v8, v8, v9
  v_add_f32 v10, v10, v11
  v_fma_f32 v8, v8, s48, v29
  v_fma_f32 v10, v10, s48, v29
  v_sqrt_f32 v8, v8
  v_sqrt_f32 v10, v10
  v_fma_f32 v20, v8, 0.5, v20
  v_fma_f32 v20, v10, 0.5, v20
  v_mul_f32 v26, v26, v8
  s_nop 0
  v_add_f32_dpp v20, v20, v20 quad_perm:[1,0,3,2] row_mask:0xf bank_mask:0xf
  v_mul_f32 v27, v27, v10
  s_nop 0
  v_add_f32_dpp v20, v20, v20 quad_perm:[2,3,0,1] row_mask:0xf bank_mask:0xf
  s_nop 1
  v_add_f32_dpp v20, v20, v20 row_half_mirror row_mask:0xf bank_mask:0xf
  s_nop 1
  v_add_f32_dpp v20, v20, v20 row_ror:8 row_mask:0xf bank_mask:0xf
  v_mov_b32 v21, v20
  s_nop 1
  v_permlane16_swap_b32 v20, v21
  v_add_f32 v20, v20, v21
  v_mov_b32 v21, v20
  s_nop 1
  v_permlane32_swap_b32 v20, v21
  v_add_f32 v20, v20, v21
  ds_write_b32 v28, v20
  s_waitcnt lgkmcnt(0)
  s_barrier
  ds_read_b128 v[0:3], v22
  s_waitcnt lgkmcnt(0)
  v_add_f32 v0, v0, v1
  v_add_f32 v2, v2, v3
  v_add_f32 v0, v0, v2
  v_fma_f32 v0, v0, v23, v29
  v_rcp_f32 v0, v0
  s_nop 0
  v_mul_f32_e64 v0, v0, v30
  v_fma_f32 v26, v26, v0, v30
  v_fma_f32 v27, v27, v0, v30
  ds_write_b64 v33, v[26:27] offset:512
  v_fma_f32 v24, v24, v0, v30
  v_fma_f32 v25, v25, v0, v30
  ds_write_b64 v32, v[24:25]
  v_pk_fma_f32 v[232:233], v[232:233], v[0:1], v[30:31] op_sel_hi:[1,0,0]
  v_pk_fma_f32 v[234:235], v[234:235], v[0:1], v[30:31] op_sel_hi:[1,0,0]
  v_pk_fma_f32 v[236:237], v[236:237], v[0:1], v[30:31] op_sel_hi:[1,0,0]
  v_pk_fma_f32 v[238:239], v[238:239], v[0:1], v[30:31] op_sel_hi:[1,0,0]
  v_pk_fma_f32 v[240:241], v[240:241], v[0:1], v[30:31] op_sel_hi:[1,0,0]
  v_pk_fma_f32 v[242:243], v[242:243], v[0:1], v[30:31] op_sel_hi:[1,0,0]
  v_pk_fma_f32 v[244:245], v[244:245], v[0:1], v[30:31] op_sel_hi:[1,0,0]
  v_pk_fma_f32 v[246:247], v[246:247], v[0:1], v[30:31] op_sel_hi:[1,0,0]
  ds_read_b128 v[20:23], v254 offset:4608
  ds_read_b128 v[36:39], v254 offset:4640
  ds_read_b128 v[0:3], v254 offset:4224
  ds_read_b128 v[4:7], v254 offset:4256
  v_pk_mul_f32 v[96:97], v[96:97], v[232:233]
  v_pk_mul_f32 v[98:99], v[98:99], v[234:235]
  v_cvt_pk_bf16_f32 v24, v96, v97
  v_cvt_pk_bf16_f32 v25, v98, v99
  v_pk_mul_f32 v[100:101], v[100:101], v[236:237]
  v_pk_mul_f32 v[102:103], v[102:103], v[238:239]
  v_cvt_pk_bf16_f32 v26, v100, v101
  v_cvt_pk_bf16_f32 v27, v102, v103
  ds_read_b128 v[232:235], v254 offset:4288
  ds_read_b128 v[236:239], v254 offset:4320
  buffer_load_dwordx4 v[96:99], v248, s[20:23], s57 offen offset:2048 sc1
  buffer_load_dwordx4 v[100:103], v248, s[20:23], s57 offen offset:3072 sc1
  v_pk_mul_f32 v[104:105], v[104:105], v[240:241]
  v_pk_mul_f32 v[106:107], v[106:107], v[242:243]
  v_cvt_pk_bf16_f32 v28, v104, v105
  v_cvt_pk_bf16_f32 v29, v106, v107
  v_pk_mul_f32 v[108:109], v[108:109], v[244:245]
  v_pk_mul_f32 v[110:111], v[110:111], v[246:247]
  v_cvt_pk_bf16_f32 v30, v108, v109
  v_cvt_pk_bf16_f32 v31, v110, v111
  ds_read_b128 v[240:243], v254 offset:4352
  ds_read_b128 v[244:247], v254 offset:4384
  buffer_load_dwordx4 v[104:107], v248, s[20:23], s55 offen offset:0 sc1
  buffer_load_dwordx4 v[108:111], v248, s[20:23], s55 offen offset:1024 sc1
  s_waitcnt lgkmcnt(6)
  v_pk_mul_f32 v[112:113], v[112:113], v[20:21]
  v_pk_mul_f32 v[114:115], v[114:115], v[22:23]
  v_cvt_pk_bf16_f32 v32, v112, v113
  v_cvt_pk_bf16_f32 v33, v114, v115
  v_pk_mul_f32 v[116:117], v[116:117], v[36:37]
  v_pk_mul_f32 v[118:119], v[118:119], v[38:39]
  v_cvt_pk_bf16_f32 v34, v116, v117
  v_cvt_pk_bf16_f32 v35, v118, v119
  ds_read_b128 v[20:23], v254 offset:4416
  ds_read_b128 v[36:39], v254 offset:4448
  buffer_load_dwordx4 v[112:115], v248, s[20:23], s55 offen offset:2048 sc1
  buffer_load_dwordx4 v[116:119], v248, s[20:23], s55 offen offset:3072 sc1
  s_waitcnt lgkmcnt(6)
  v_pk_mul_f32 v[64:65], v[64:65], v[0:1]
  v_pk_mul_f32 v[66:67], v[66:67], v[2:3]
  v_cvt_pk_bf16_f32 v8, v64, v65
  v_cvt_pk_bf16_f32 v9, v66, v67
  v_pk_mul_f32 v[68:69], v[68:69], v[4:5]
  v_pk_mul_f32 v[70:71], v[70:71], v[6:7]
  v_cvt_pk_bf16_f32 v10, v68, v69
  v_cvt_pk_bf16_f32 v11, v70, v71
  ds_read_b128 v[0:3], v254 offset:4800
  ds_read_b128 v[4:7], v254 offset:4832
  s_waitcnt lgkmcnt(6)
  v_pk_mul_f32 v[72:73], v[72:73], v[232:233]
  v_pk_mul_f32 v[74:75], v[74:75], v[234:235]
  v_cvt_pk_bf16_f32 v12, v72, v73
  v_cvt_pk_bf16_f32 v13, v74, v75
  v_pk_mul_f32 v[76:77], v[76:77], v[236:237]
  v_pk_mul_f32 v[78:79], v[78:79], v[238:239]
  v_cvt_pk_bf16_f32 v14, v76, v77
  v_cvt_pk_bf16_f32 v15, v78, v79
  ds_read_b128 v[64:67], v254 offset:4672
  ds_read_b128 v[68:71], v254 offset:4704
  s_waitcnt lgkmcnt(6)
  v_pk_mul_f32 v[80:81], v[80:81], v[240:241]
  v_pk_mul_f32 v[82:83], v[82:83], v[242:243]
  v_cvt_pk_bf16_f32 v16, v80, v81
  v_cvt_pk_bf16_f32 v17, v82, v83
  v_pk_mul_f32 v[84:85], v[84:85], v[244:245]
  v_pk_mul_f32 v[86:87], v[86:87], v[246:247]
  v_cvt_pk_bf16_f32 v18, v84, v85
  v_cvt_pk_bf16_f32 v19, v86, v87
  ds_read_b128 v[232:235], v254 offset:4736
  ds_read_b128 v[72:75], v254 offset:4768
  v_mfma_f32_32x32x16_bf16 a[0:15], v[24:27], a[200:203], a[32:47]
  ds_read_b128 v[236:239], v254 offset:4096
  s_waitcnt lgkmcnt(8)
  v_mul_f32 v88, v88, v20
  v_mul_f32 v89, v89, v21
  v_mul_f32 v90, v90, v22
  v_mul_f32 v91, v91, v23
  v_cvt_pk_bf16_f32 v20, v88, v89
  v_cvt_pk_bf16_f32 v21, v90, v91
  v_mfma_f32_32x32x16_bf16 a[0:15], v[28:31], a[204:207], a[0:15]
  ds_read_b128 v[76:79], v254 offset:4128
  s_waitcnt lgkmcnt(8)
  v_mul_f32 v92, v92, v36
  v_mul_f32 v93, v93, v37
  v_mul_f32 v94, v94, v38
  v_mul_f32 v95, v95, v39
  v_cvt_pk_bf16_f32 v22, v92, v93
  v_cvt_pk_bf16_f32 v23, v94, v95
  v_mfma_f32_32x32x16_bf16 a[0:15], v[32:35], v[152:155], a[0:15]
  ds_read_b128 v[240:243], v254 offset:4160
  s_waitcnt lgkmcnt(8)
  v_mul_f32 v40, v40, v0
  v_mul_f32 v41, v41, v1
  v_mul_f32 v42, v42, v2
  v_mul_f32 v43, v43, v3
  v_mfma_f32_32x32x16_bf16 a[0:15], v[8:11], a[136:139], a[0:15]
  ds_read_b128 v[80:83], v254 offset:4192
  s_waitcnt lgkmcnt(8)
  v_mul_f32 v44, v44, v4
  v_mul_f32 v45, v45, v5
  v_mul_f32 v46, v46, v6
  v_mul_f32 v47, v47, v7
  v_cvt_pk_bf16_f32 v47, v46, v47
  v_cvt_pk_bf16_f32 v46, v44, v45
  v_cvt_pk_bf16_f32 v45, v42, v43
  v_cvt_pk_bf16_f32 v44, v40, v41
  v_mfma_f32_32x32x16_bf16 a[0:15], v[12:15], a[140:143], a[0:15]
  s_waitcnt lgkmcnt(7)
  v_mul_f32 v216, v216, v64
  v_mul_f32 v217, v217, v65
  v_mul_f32 v218, v218, v66
  v_mul_f32 v219, v219, v67
  v_cvt_pk_bf16_f32 v36, v216, v217
  v_cvt_pk_bf16_f32 v37, v218, v219
  v_mfma_f32_32x32x16_bf16 a[0:15], v[16:19], a[192:195], a[0:15]
  s_waitcnt lgkmcnt(6)
  v_mul_f32 v220, v220, v68
  v_mul_f32 v221, v221, v69
  v_mul_f32 v222, v222, v70
  v_mul_f32 v223, v223, v71
  v_cvt_pk_bf16_f32 v38, v220, v221
  v_cvt_pk_bf16_f32 v39, v222, v223
  v_mfma_f32_32x32x16_bf16 a[0:15], a[60:63], a[48:51], a[0:15]
  buffer_load_dwordx4 a[56:59], v253, s[8:11], s72 offen offset:0
  buffer_load_dwordx4 a[48:51], v253, s[8:11], s73 offen offset:0
  s_waitcnt lgkmcnt(5)
  v_mul_f32 v224, v224, v232
  v_mul_f32 v225, v225, v233
  v_mul_f32 v226, v226, v234
  v_mul_f32 v227, v227, v235
  v_cvt_pk_bf16_f32 v40, v224, v225
  v_cvt_pk_bf16_f32 v41, v226, v227
  v_mfma_f32_32x32x16_bf16 a[0:15], v[20:23], a[196:199], a[0:15]
  s_waitcnt lgkmcnt(4)
  v_mul_f32 v228, v228, v72
  v_mul_f32 v229, v229, v73
  v_mul_f32 v230, v230, v74
  v_mul_f32 v231, v231, v75
  v_cvt_pk_bf16_f32 v42, v228, v229
  v_cvt_pk_bf16_f32 v43, v230, v231
  v_mfma_f32_32x32x16_bf16 a[0:15], v[44:47], v[164:167], a[0:15]
  s_waitcnt vmcnt(11) lgkmcnt(3)
  v_mul_f32 v48, v48, v236
  v_mul_f32 v49, v49, v237
  v_mul_f32 v50, v50, v238
  v_mul_f32 v51, v51, v239
  v_cvt_pk_bf16_f32 v0, v48, v49
  v_cvt_pk_bf16_f32 v1, v50, v51
  v_mfma_f32_32x32x16_bf16 a[0:15], v[36:39], v[156:159], a[0:15]
  ds_read_b128 v[232:235], v254 offset:4800
  s_waitcnt vmcnt(10) lgkmcnt(3)
  v_mul_f32 v52, v52, v76
  v_mul_f32 v53, v53, v77
  v_mul_f32 v54, v54, v78
  v_mul_f32 v55, v55, v79
  v_cvt_pk_bf16_f32 v2, v52, v53
  v_cvt_pk_bf16_f32 v3, v54, v55
  v_mfma_f32_32x32x16_bf16 a[0:15], v[40:43], v[160:163], a[0:15]
  ds_read_b128 v[236:239], v254 offset:4832
  s_waitcnt vmcnt(9) lgkmcnt(3)
  v_mul_f32 v56, v56, v240
  v_mul_f32 v57, v57, v241
  v_mul_f32 v58, v58, v242
  v_mul_f32 v59, v59, v243
  v_cvt_pk_bf16_f32 v4, v56, v57
  v_cvt_pk_bf16_f32 v5, v58, v59
  v_mfma_f32_32x32x16_bf16 a[0:15], v[0:3], a[64:67], a[0:15]
  ds_read_b128 v[240:243], v254 offset:4480
  s_waitcnt vmcnt(8) lgkmcnt(3)
  v_mul_f32 v60, v60, v80
  v_mul_f32 v61, v61, v81
  v_mul_f32 v62, v62, v82
  v_mul_f32 v63, v63, v83
  v_cvt_pk_bf16_f32 v6, v60, v61
  v_cvt_pk_bf16_f32 v7, v62, v63
  s_nop 1
  v_mfma_f32_32x32x16_bf16 a[0:15], v[4:7], a[68:71], a[0:15]
  v_mfma_f32_32x32x16_bf16 a[16:31], v[44:47], v[180:183], a[32:47]
  buffer_load_dwordx4 v[48:51], v248, s[20:23], s56 offen offset:0 sc1
  buffer_load_dwordx4 v[52:55], v248, s[20:23], s56 offen offset:1024 sc1
  v_mfma_f32_32x32x16_bf16 a[16:31], v[24:27], a[216:219], a[16:31]
  ds_write_b128 v249, a[0:3] offset:0
  buffer_load_dwordx4 v[56:59], v248, s[20:23], s56 offen offset:2048 sc1
  v_mfma_f32_32x32x16_bf16 a[16:31], v[28:31], a[220:223], a[16:31]
  s_waitcnt vmcnt(10) lgkmcnt(3)
  v_mul_f32 v96, v96, v232
  v_mul_f32 v97, v97, v233
  v_mul_f32 v98, v98, v234
  v_mul_f32 v99, v99, v235
  v_cvt_pk_bf16_f32 v92, v96, v97
  v_cvt_pk_bf16_f32 v93, v98, v99
  v_mfma_f32_32x32x16_bf16 a[16:31], v[32:35], v[168:171], a[16:31]
  ds_read_b128 v[232:235], v254 offset:4512
  s_waitcnt vmcnt(9) lgkmcnt(3)
  v_mul_f32 v100, v100, v236
  v_mul_f32 v101, v101, v237
  v_mul_f32 v102, v102, v238
  v_mul_f32 v103, v103, v239
  v_cvt_pk_bf16_f32 v94, v100, v101
  v_cvt_pk_bf16_f32 v95, v102, v103
  v_mfma_f32_32x32x16_bf16 a[16:31], v[36:39], v[172:175], a[16:31]
  ds_write_b128 v249, a[4:7] offset:1088
  buffer_load_dwordx4 v[60:63], v248, s[20:23], s56 offen offset:3072 sc1
  v_mfma_f32_32x32x16_bf16 a[16:31], v[40:43], v[176:179], a[16:31]
  s_waitcnt vmcnt(9) lgkmcnt(3)
  v_mul_f32 v104, v104, v240
  v_mul_f32 v105, v105, v241
  v_mul_f32 v106, v106, v242
  v_mul_f32 v107, v107, v243
  v_cvt_pk_bf16_f32 v72, v104, v105
  v_cvt_pk_bf16_f32 v73, v106, v107
  v_mfma_f32_32x32x16_bf16 a[16:31], a[60:63], a[52:55], a[16:31]
  ds_read_b128 a[64:67], v252 offset:2048
  ds_read_b128 v[236:239], v254 offset:4544
  v_mfma_f32_32x32x16_bf16 a[16:31], v[16:19], a[208:211], a[16:31]
  ds_write_b128 v249, a[8:11] offset:2176
  buffer_load_dwordx4 a[52:55], v253, s[8:11], s74 offen offset:0
  v_mfma_f32_32x32x16_bf16 a[16:31], v[20:23], a[212:215], a[16:31]
  s_waitcnt vmcnt(9) lgkmcnt(4)
  v_mul_f32 v108, v108, v232
  v_mul_f32 v109, v109, v233
  v_mul_f32 v110, v110, v234
  v_mul_f32 v111, v111, v235
  v_cvt_pk_bf16_f32 v74, v108, v109
  v_cvt_pk_bf16_f32 v75, v110, v111
  v_mfma_f32_32x32x16_bf16 a[16:31], v[8:11], a[144:147], a[16:31]
  ds_read_b128 a[68:71], v252 offset:3072
  ds_read_b128 v[240:243], v254 offset:4576
  s_waitcnt vmcnt(8) lgkmcnt(3)
  v_mul_f32 v112, v112, v236
  v_mul_f32 v113, v113, v237
  v_mul_f32 v114, v114, v238
  v_mul_f32 v115, v115, v239
  v_cvt_pk_bf16_f32 v76, v112, v113
  v_cvt_pk_bf16_f32 v77, v114, v115
  v_mfma_f32_32x32x16_bf16 a[16:31], v[12:15], a[148:151], a[16:31]
  ds_write_b128 v249, a[12:15] offset:3264
  buffer_load_dwordx4 v[64:67], v248, s[20:23], s57 offen offset:0 sc1
  v_mfma_f32_32x32x16_bf16 a[16:31], v[0:3], a[64:67], a[16:31]
  s_waitcnt vmcnt(8) lgkmcnt(1)
  v_mul_f32 v116, v116, v240
  v_mul_f32 v117, v117, v241
  v_mul_f32 v118, v118, v242
  v_mul_f32 v119, v119, v243
  v_cvt_pk_bf16_f32 v78, v116, v117
  v_cvt_pk_bf16_f32 v79, v118, v119
  v_mfma_f32_32x32x16_bf16 a[16:31], v[4:7], a[68:71], a[16:31]
  ds_read_b128 v[232:235], v254 offset:4608
  ds_read_b128 v[236:239], v254 offset:4640
  buffer_load_dwordx4 v[68:71], v248, s[20:23], s57 offen offset:1024 sc1
  s_waitcnt lgkmcnt(2)
  v_mfma_f32_32x32x16_bf16 a[0:15], v[44:47], v[196:199], a[32:47]
  s_barrier
  ds_read_b128 v[240:243], v254 offset:4672
  v_mfma_f32_32x32x16_bf16 a[0:15], v[24:27], a[232:235], a[0:15]
  ds_write_b128 v249, a[16:19] offset:17408
  buffer_load_dwordx4 v[96:99], v248, s[20:23], s54 offen offset:0 sc1
  v_mfma_f32_32x32x16_bf16 a[0:15], v[28:31], a[236:239], a[0:15]
  s_waitcnt vmcnt(7) lgkmcnt(3)
  v_mul_f32 v48, v48, v232
  v_mul_f32 v49, v49, v233
  v_mul_f32 v50, v50, v234
  v_mul_f32 v51, v51, v235
  v_cvt_pk_bf16_f32 v80, v48, v49
  v_cvt_pk_bf16_f32 v81, v50, v51
  v_mfma_f32_32x32x16_bf16 a[0:15], v[32:35], v[184:187], a[0:15]
  ds_read_b128 v[232:235], v254 offset:4704
  s_waitcnt vmcnt(6) lgkmcnt(3)
  v_mul_f32 v52, v52, v236
  v_mul_f32 v53, v53, v237
  v_mul_f32 v54, v54, v238
  v_mul_f32 v55, v55, v239
  v_cvt_pk_bf16_f32 v82, v52, v53
  v_cvt_pk_bf16_f32 v83, v54, v55
  v_mfma_f32_32x32x16_bf16 a[0:15], v[36:39], v[188:191], a[0:15]
  ds_write_b128 v249, a[20:23] offset:18496
  buffer_load_dwordx4 v[100:103], v248, s[20:23], s54 offen offset:1024 sc1
  v_mfma_f32_32x32x16_bf16 a[0:15], v[40:43], v[192:195], a[0:15]
  s_waitcnt vmcnt(6) lgkmcnt(3)
  v_mul_f32 v56, v56, v240
  v_mul_f32 v57, v57, v241
  v_mul_f32 v58, v58, v242
  v_mul_f32 v59, v59, v243
  v_cvt_pk_bf16_f32 v84, v56, v57
  v_cvt_pk_bf16_f32 v85, v58, v59
  v_mfma_f32_32x32x16_bf16 a[0:15], a[60:63], a[56:59], a[0:15]
  ds_read_b128 a[64:67], v252 offset:4096
  ds_read_b128 v[236:239], v254 offset:4736
  v_mfma_f32_32x32x16_bf16 a[0:15], v[16:19], a[224:227], a[0:15]
  ds_write_b128 v249, a[24:27] offset:19584
  buffer_load_dwordx4 a[56:59], v253, s[8:11], s75 offen offset:0
  v_mfma_f32_32x32x16_bf16 a[0:15], v[20:23], a[228:231], a[0:15]
  s_waitcnt vmcnt(6) lgkmcnt(4)
  v_mul_f32 v60, v60, v232
  v_mul_f32 v61, v61, v233
  v_mul_f32 v62, v62, v234
  v_mul_f32 v63, v63, v235
  v_cvt_pk_bf16_f32 v86, v60, v61
  v_cvt_pk_bf16_f32 v87, v62, v63
  v_mfma_f32_32x32x16_bf16 a[0:15], v[8:11], a[152:155], a[0:15]
  ds_read_b128 a[68:71], v252 offset:5120
  ds_read_b128 v[240:243], v254 offset:4768
  s_waitcnt vmcnt(4) lgkmcnt(3)
  v_mul_f32 v64, v64, v236
  v_mul_f32 v65, v65, v237
  v_mul_f32 v66, v66, v238
  v_mul_f32 v67, v67, v239
  v_cvt_pk_bf16_f32 v88, v64, v65
  v_cvt_pk_bf16_f32 v89, v66, v67
  v_mfma_f32_32x32x16_bf16 a[0:15], v[12:15], a[156:159], a[0:15]
  ds_write_b128 v249, a[28:31] offset:20672
  buffer_load_dwordx4 v[104:107], v248, s[20:23], s54 offen offset:2048 sc1
  v_mfma_f32_32x32x16_bf16 a[0:15], v[0:3], a[64:67], a[0:15]
  s_waitcnt lgkmcnt(2)
  v_mfma_f32_32x32x16_bf16 a[0:15], v[4:7], a[68:71], a[0:15]
  ds_read_b128 v[232:235], v254 offset:4352
  ds_read_b128 v[236:239], v254 offset:4384
  buffer_load_dwordx4 v[108:111], v248, s[20:23], s54 offen offset:3072 sc1
  v_mfma_f32_32x32x16_bf16 a[16:31], v[44:47], v[212:215], a[32:47]
  ds_read_b128 v[216:219], v250 offset:0
  ds_read_b128 v[220:223], v250 offset:4352
  buffer_load_dwordx4 v[112:115], v248, s[20:23], s53 offen offset:0 sc1
  buffer_load_dwordx4 v[116:119], v248, s[20:23], s53 offen offset:1024 sc1
  v_mfma_f32_32x32x16_bf16 a[16:31], v[24:27], a[248:251], a[16:31]
  ds_write_b128 v249, a[0:3] offset:34816
  v_mfma_f32_32x32x16_bf16 a[16:31], v[28:31], a[252:255], a[16:31]
  s_waitcnt vmcnt(7) lgkmcnt(6)
  v_mul_f32 v68, v68, v240
  v_mul_f32 v69, v69, v241
  v_mul_f32 v70, v70, v242
  v_mul_f32 v71, v71, v243
  v_cvt_pk_bf16_f32 v90, v68, v69
  v_cvt_pk_bf16_f32 v91, v70, v71
  v_mfma_f32_32x32x16_bf16 a[16:31], v[32:35], v[200:203], a[16:31]
  ds_read_b128 v[224:227], v250 offset:8704
  ds_read_b128 v[228:231], v250 offset:13056
  s_waitcnt lgkmcnt(3)
  v_add_f32 v216, v216, v220
  v_add_f32 v217, v217, v221
  v_add_f32 v218, v218, v222
  v_add_f32 v219, v219, v223
  v_mfma_f32_32x32x16_bf16 a[16:31], v[36:39], v[204:207], a[16:31]
  ds_write_b128 v249, a[4:7] offset:35904
  v_mfma_f32_32x32x16_bf16 a[16:31], v[40:43], v[208:211], a[16:31]
  s_waitcnt vmcnt(6)
  v_mul_f32 v96, v96, v232
  v_mul_f32 v97, v97, v233
  v_mul_f32 v98, v98, v234
  v_mul_f32 v99, v99, v235
  v_cvt_pk_bf16_f32 v64, v96, v97
  v_cvt_pk_bf16_f32 v65, v98, v99
  v_mfma_f32_32x32x16_bf16 a[16:31], a[60:63], a[48:51], a[16:31]
  ds_read_b128 a[64:67], v252 offset:6144
  ds_read_b128 v[240:243], v254 offset:4416
  s_waitcnt lgkmcnt(3)
  v_add_f32 v224, v224, v228
  v_add_f32 v225, v225, v229
  v_add_f32 v226, v226, v230
  v_add_f32 v227, v227, v231
  v_mfma_f32_32x32x16_bf16 a[16:31], v[16:19], a[240:243], a[16:31]
  ds_write_b128 v249, a[8:11] offset:36992
  buffer_load_dwordx4 a[48:51], v253, s[8:11], s76 offen offset:0
  v_mfma_f32_32x32x16_bf16 a[16:31], v[20:23], a[244:247], a[16:31]
  s_waitcnt vmcnt(6)
  v_mul_f32 v100, v100, v236
  v_mul_f32 v101, v101, v237
  v_mul_f32 v102, v102, v238
  v_mul_f32 v103, v103, v239
  v_cvt_pk_bf16_f32 v66, v100, v101
  v_cvt_pk_bf16_f32 v67, v102, v103
  v_mfma_f32_32x32x16_bf16 a[16:31], v[8:11], a[160:163], a[16:31]
  ds_read_b128 a[68:71], v252 offset:7168
  ds_read_b128 v[232:235], v254 offset:4448
  v_add_f32 v216, v216, v224
  v_add_f32 v217, v217, v225
  v_add_f32 v218, v218, v226
  v_add_f32 v219, v219, v227
  v_mfma_f32_32x32x16_bf16 a[16:31], v[12:15], a[164:167], a[16:31]
  ds_write_b128 v249, a[12:15] offset:38080
  buffer_load_dwordx4 v[96:99], v248, s[20:23], s53 offen offset:2048 sc1
  s_waitcnt lgkmcnt(5)
  v_mfma_f32_32x32x16_bf16 a[16:31], v[0:3], a[64:67], a[16:31]
  s_waitcnt lgkmcnt(2)
  v_mfma_f32_32x32x16_bf16 a[16:31], v[4:7], a[68:71], a[16:31]
  ds_read_b128 v[236:239], v254 offset:4224
  buffer_load_dwordx4 v[100:103], v248, s[20:23], s53 offen offset:3072 sc1
  v_cvt_pk_bf16_f32 v244, v216, v217
  v_cvt_pk_bf16_f32 v245, v218, v219
  s_waitcnt lgkmcnt(1)
  v_mfma_f32_32x32x16_bf16 a[0:15], v[44:47], a[100:103], a[32:47]
  s_barrier
  ds_read_b128 v[216:219], v250 offset:17408
  ds_read_b128 v[220:223], v250 offset:21760
  v_mfma_f32_32x32x16_bf16 a[0:15], v[24:27], a[80:83], a[0:15]
  ds_write_b128 v249, a[16:19] offset:52224
  v_mfma_f32_32x32x16_bf16 a[0:15], v[28:31], a[84:87], a[0:15]
  s_waitcnt vmcnt(6)
  v_mul_f32 v104, v104, v240
  v_mul_f32 v105, v105, v241
  v_mul_f32 v106, v106, v242
  v_mul_f32 v107, v107, v243
  v_cvt_pk_bf16_f32 v68, v104, v105
  v_cvt_pk_bf16_f32 v69, v106, v107
  v_mfma_f32_32x32x16_bf16 a[0:15], v[32:35], a[88:91], a[0:15]
  ds_read_b128 v[224:227], v250 offset:26112
  ds_read_b128 v[228:231], v250 offset:30464
  s_waitcnt lgkmcnt(3)
  v_add_f32 v216, v216, v220
  v_add_f32 v217, v217, v221
  v_add_f32 v218, v218, v222
  v_add_f32 v219, v219, v223
  v_mfma_f32_32x32x16_bf16 a[0:15], v[36:39], a[92:95], a[0:15]
  ds_write_b128 v249, a[20:23] offset:53312
  buffer_load_dwordx4 v[104:107], v248, s[20:23], s52 offen offset:0 sc1
  v_mfma_f32_32x32x16_bf16 a[0:15], v[40:43], a[96:99], a[0:15]
  s_waitcnt vmcnt(6)
  v_mul_f32 v108, v108, v232
  v_mul_f32 v109, v109, v233
  v_mul_f32 v110, v110, v234
  v_mul_f32 v111, v111, v235
  v_cvt_pk_bf16_f32 v70, v108, v109
  v_cvt_pk_bf16_f32 v71, v110, v111
  v_mfma_f32_32x32x16_bf16 a[0:15], a[60:63], a[52:55], a[0:15]
  ds_read_b128 a[64:67], v252 offset:8192
  ds_read_b128 v[240:243], v254 offset:4256
  s_waitcnt lgkmcnt(3)
  v_add_f32 v224, v224, v228
  v_add_f32 v225, v225, v229
  v_add_f32 v226, v226, v230
  v_add_f32 v227, v227, v231
  v_mfma_f32_32x32x16_bf16 a[0:15], v[16:19], a[72:75], a[0:15]
  ds_write_b128 v249, a[24:27] offset:54400
  buffer_load_dwordx4 v[108:111], v248, s[20:23], s52 offen offset:1024 sc1
  v_mfma_f32_32x32x16_bf16 a[0:15], v[20:23], a[76:79], a[0:15]
  s_waitcnt vmcnt(6)
  v_mul_f32 v112, v112, v236
  v_mul_f32 v113, v113, v237
  v_mul_f32 v114, v114, v238
  v_mul_f32 v115, v115, v239
  v_cvt_pk_bf16_f32 v56, v112, v113
  v_cvt_pk_bf16_f32 v57, v114, v115
  v_mfma_f32_32x32x16_bf16 a[0:15], v[8:11], a[168:171], a[0:15]
  ds_read_b128 a[68:71], v252 offset:9216
  ds_read_b128 v[232:235], v254 offset:4288
  v_add_f32 v216, v216, v224
  v_add_f32 v217, v217, v225
  v_add_f32 v218, v218, v226
  v_add_f32 v219, v219, v227
  v_mfma_f32_32x32x16_bf16 a[0:15], v[12:15], a[172:175], a[0:15]
  ds_write_b128 v249, a[28:31] offset:55488
  buffer_load_dwordx4 v[112:115], v248, s[20:23], s52 offen offset:2048 sc1
  s_waitcnt lgkmcnt(5)
  v_mfma_f32_32x32x16_bf16 a[0:15], v[0:3], a[64:67], a[0:15]
  s_waitcnt vmcnt(6) lgkmcnt(4)
  v_mul_f32 v116, v116, v240
  v_mul_f32 v117, v117, v241
  v_mul_f32 v118, v118, v242
  v_mul_f32 v119, v119, v243
  v_cvt_pk_bf16_f32 v58, v116, v117
  v_cvt_pk_bf16_f32 v59, v118, v119
  s_waitcnt lgkmcnt(2)
  v_mfma_f32_32x32x16_bf16 a[0:15], v[4:7], a[68:71], a[0:15]
  ds_read_b128 v[236:239], v254 offset:4320
  ds_read_b128 v[240:243], v254 offset:4096
  buffer_load_dwordx4 v[116:119], v248, s[20:23], s52 offen offset:3072 sc1
  v_cvt_pk_bf16_f32 v246, v216, v217
  v_cvt_pk_bf16_f32 v247, v218, v219
  v_mfma_f32_32x32x16_bf16 a[16:31], v[44:47], a[116:119], a[32:47]
  ds_read_b128 v[216:219], v250 offset:34816
  ds_read_b128 v[220:223], v250 offset:39168
  v_mfma_f32_32x32x16_bf16 a[16:31], v[24:27], v[128:131], a[16:31]
  ds_write_b128 v249, a[0:3] offset:0
  v_mfma_f32_32x32x16_bf16 a[16:31], v[28:31], v[132:135], a[16:31]
  s_waitcnt vmcnt(5) lgkmcnt(6)
  v_mul_f32 v96, v96, v232
  v_mul_f32 v97, v97, v233
  v_mul_f32 v98, v98, v234
  v_mul_f32 v99, v99, v235
  v_cvt_pk_bf16_f32 v60, v96, v97
  v_cvt_pk_bf16_f32 v61, v98, v99
  v_mfma_f32_32x32x16_bf16 a[16:31], v[32:35], a[104:107], a[16:31]
  ds_read_b128 v[224:227], v250 offset:43520
  ds_read_b128 v[228:231], v250 offset:47872
  s_waitcnt lgkmcnt(3)
  v_add_f32 v216, v216, v220
  v_add_f32 v217, v217, v221
  v_add_f32 v218, v218, v222
  v_add_f32 v219, v219, v223
  v_mfma_f32_32x32x16_bf16 a[16:31], v[36:39], a[108:111], a[16:31]
  ds_write_b128 v249, a[4:7] offset:1088
  v_mfma_f32_32x32x16_bf16 a[16:31], v[40:43], a[112:115], a[16:31]
  s_waitcnt vmcnt(4)
  v_mul_f32 v100, v100, v236
  v_mul_f32 v101, v101, v237
  v_mul_f32 v102, v102, v238
  v_mul_f32 v103, v103, v239
  v_cvt_pk_bf16_f32 v62, v100, v101
  v_cvt_pk_bf16_f32 v63, v102, v103
  v_mfma_f32_32x32x16_bf16 a[16:31], a[60:63], a[56:59], a[16:31]
  ds_read_b128 a[64:67], v252 offset:10240
  ds_read_b128 v[232:235], v254 offset:4128
  s_waitcnt lgkmcnt(3)
  v_add_f32 v224, v224, v228
  v_add_f32 v225, v225, v229
  v_add_f32 v226, v226, v230
  v_add_f32 v227, v227, v231
  v_mfma_f32_32x32x16_bf16 a[16:31], v[16:19], v[120:123], a[16:31]
  ds_write_b128 v249, a[8:11] offset:2176
  v_mfma_f32_32x32x16_bf16 a[16:31], v[20:23], v[124:127], a[16:31]
  v_permlane32_swap_b32 v244, v246
  v_permlane32_swap_b32 v245, v247
  buffer_store_dwordx4 v[244:247], v251, s[24:27], s70 offen offset:0 sc1
  v_mfma_f32_32x32x16_bf16 a[16:31], v[8:11], a[176:179], a[16:31]
  ds_read_b128 a[68:71], v252 offset:11264
  ds_read_b128 v[236:239], v254 offset:4160
  v_add_f32 v216, v216, v224
  v_add_f32 v217, v217, v225
  v_add_f32 v218, v218, v226
  v_add_f32 v219, v219, v227
  v_mfma_f32_32x32x16_bf16 a[16:31], v[12:15], a[180:183], a[16:31]
  ds_write_b128 v249, a[12:15] offset:3264
  s_waitcnt lgkmcnt(5)
  v_mfma_f32_32x32x16_bf16 a[16:31], v[0:3], a[64:67], a[16:31]
  s_waitcnt vmcnt(4)
  v_mul_f32 v104, v104, v240
  v_mul_f32 v105, v105, v241
  v_mul_f32 v106, v106, v242
  v_mul_f32 v107, v107, v243
  v_cvt_pk_bf16_f32 v48, v104, v105
  v_cvt_pk_bf16_f32 v49, v106, v107
  s_waitcnt lgkmcnt(2)
  v_mfma_f32_32x32x16_bf16 a[16:31], v[4:7], a[68:71], a[16:31]
  ds_read_b128 v[240:243], v254 offset:4192
  v_cvt_pk_bf16_f32 v244, v216, v217
  v_cvt_pk_bf16_f32 v245, v218, v219
  s_waitcnt lgkmcnt(1)
  v_mfma_f32_32x32x16_bf16 a[0:15], v[44:47], a[132:135], a[32:47]
  s_barrier
  ds_read_b128 v[216:219], v250 offset:52224
  ds_read_b128 v[220:223], v250 offset:56576
  v_mfma_f32_32x32x16_bf16 a[0:15], v[24:27], v[144:147], a[0:15]
  ds_write_b128 v249, a[16:19] offset:17408
  v_mfma_f32_32x32x16_bf16 a[0:15], v[28:31], v[148:151], a[0:15]
  s_waitcnt vmcnt(3)
  v_mul_f32 v108, v108, v232
  v_mul_f32 v109, v109, v233
  v_mul_f32 v110, v110, v234
  v_mul_f32 v111, v111, v235
  v_cvt_pk_bf16_f32 v50, v108, v109
  v_cvt_pk_bf16_f32 v51, v110, v111
  v_mfma_f32_32x32x16_bf16 a[0:15], v[32:35], a[120:123], a[0:15]
  ds_read_b128 v[224:227], v250 offset:60928
  ds_read_b128 v[228:231], v250 offset:65280
  ds_read_b128 a[32:35], v254 offset:128
  s_waitcnt lgkmcnt(4)
  v_add_f32 v216, v216, v220
  v_add_f32 v217, v217, v221
  v_add_f32 v218, v218, v222
  v_add_f32 v219, v219, v223
  v_mfma_f32_32x32x16_bf16 a[0:15], v[36:39], a[124:127], a[0:15]
  ds_write_b128 v249, a[20:23] offset:18496
  v_mfma_f32_32x32x16_bf16 a[0:15], v[40:43], a[128:131], a[0:15]
  s_waitcnt vmcnt(2)
  v_mul_f32 v112, v112, v236
  v_mul_f32 v113, v113, v237
  v_mul_f32 v114, v114, v238
  v_mul_f32 v115, v115, v239
  v_cvt_pk_bf16_f32 v52, v112, v113
  v_cvt_pk_bf16_f32 v53, v114, v115
  v_mfma_f32_32x32x16_bf16 a[0:15], a[60:63], a[48:51], a[0:15]
  ds_read_b128 a[64:67], v252 offset:12288
  ds_read_b128 a[36:39], v254 offset:160
  s_waitcnt lgkmcnt(4)
  v_add_f32 v224, v224, v228
  v_add_f32 v225, v225, v229
  v_add_f32 v226, v226, v230
  v_add_f32 v227, v227, v231
  v_mfma_f32_32x32x16_bf16 a[0:15], v[16:19], v[136:139], a[0:15]
  ds_write_b128 v249, a[24:27] offset:19584
  v_mfma_f32_32x32x16_bf16 a[0:15], v[20:23], v[140:143], a[0:15]
  s_waitcnt vmcnt(1)
  v_mul_f32 v116, v116, v240
  v_mul_f32 v117, v117, v241
  v_mul_f32 v118, v118, v242
  v_mul_f32 v119, v119, v243
  v_cvt_pk_bf16_f32 v54, v116, v117
  v_cvt_pk_bf16_f32 v55, v118, v119
  v_mfma_f32_32x32x16_bf16 a[0:15], v[8:11], a[184:187], a[0:15]
  ds_read_b128 a[68:71], v252 offset:13312
  ds_read_b128 a[40:43], v254 offset:192
  ds_read_b128 a[44:47], v254 offset:224
  v_add_f32 v216, v216, v224
  v_add_f32 v217, v217, v225
  v_add_f32 v218, v218, v226
  v_add_f32 v219, v219, v227
  v_mfma_f32_32x32x16_bf16 a[0:15], v[12:15], a[188:191], a[0:15]
  ds_write_b128 v249, a[28:31] offset:20672
  s_waitcnt lgkmcnt(6)
  v_mfma_f32_32x32x16_bf16 a[0:15], v[0:3], a[64:67], a[0:15]
  s_waitcnt lgkmcnt(3)
  v_mfma_f32_32x32x16_bf16 a[0:15], v[4:7], a[68:71], a[0:15]
  v_cvt_pk_bf16_f32 v246, v216, v217
  v_cvt_pk_bf16_f32 v247, v218, v219
  v_lshrrev_b32 v253, 9, v248
  s_mov_b32 s47, -86008
  v_and_b32 v232, 16, v248
  s_movk_i32 s48, 0x3f80
  v_mad_i32_i24 v253, v253, s47, v251
  v_lshlrev_b32 v232, v232, s48
  v_bfe_i32 v233, v248, 5, 1
  v_and_b32 v233, v233, v232
  v_xor_b32 v232, v232, v233
  s_waitcnt lgkmcnt(1)
  v_mfma_f32_32x32x16_bf16 a[16:31], v[92:95], v[164:167], a[32:47]
  ds_read_b128 v[216:219], v250 offset:0
  ds_read_b128 v[220:223], v250 offset:4352
  buffer_load_dwordx2 a[52:53], v253, s[8:11], s73 offen offset:64
  v_mfma_f32_32x32x16_bf16 a[16:31], v[72:75], a[200:203], a[16:31]
  ds_write_b128 v249, a[0:3] offset:34816
  v_mfma_f32_32x32x16_bf16 a[16:31], v[76:79], a[204:207], a[16:31]
  buffer_load_dwordx2 a[50:51], v253, s[8:11], s72 offen offset:64
  v_mfma_f32_32x32x16_bf16 a[16:31], v[80:83], v[152:155], a[16:31]
  ds_read_b128 v[224:227], v250 offset:8704
  ds_read_b128 v[228:231], v250 offset:13056
  buffer_load_dwordx2 a[48:49], v253, s[8:11], s71 offen offset:64
  s_waitcnt lgkmcnt(3)
  v_permlane32_swap_b32 v244, v246
  v_permlane32_swap_b32 v245, v247
  v_mfma_f32_32x32x16_bf16 a[16:31], v[84:87], v[156:159], a[16:31]
  ds_write_b128 v249, a[4:7] offset:35904
  v_mfma_f32_32x32x16_bf16 a[16:31], v[88:91], v[160:163], a[16:31]
  v_add_f32 v216, v216, v220
  v_add_f32 v217, v217, v221
  v_add_f32 v218, v218, v222
  v_add_f32 v219, v219, v223
  v_mfma_f32_32x32x16_bf16 a[16:31], v[64:67], a[192:195], a[16:31]
  ds_read_b128 a[64:67], v252 offset:0
  ds_read_b128 a[68:71], v252 offset:1024
  buffer_load_dwordx2 a[62:63], v253, s[8:11], s70 offen offset:64
  v_mfma_f32_32x32x16_bf16 a[16:31], v[68:71], a[196:199], a[16:31]
  ds_write_b128 v249, a[8:11] offset:36992
  v_mfma_f32_32x32x16_bf16 a[16:31], v[56:59], a[136:139], a[16:31]
  s_waitcnt lgkmcnt(4)
  v_add_f32 v224, v224, v228
  v_add_f32 v225, v225, v229
  v_add_f32 v226, v226, v230
  v_add_f32 v227, v227, v231
  v_mfma_f32_32x32x16_bf16 a[16:31], v[60:63], a[140:143], a[16:31]
  buffer_store_dwordx4 v[244:247], v251, s[24:27], s72 offen offset:0 sc1
  s_waitcnt lgkmcnt(1)
  v_mfma_f32_32x32x16_bf16 a[16:31], v[48:51], a[64:67], a[16:31]
  ds_write_b128 v249, a[12:15] offset:38080
  v_mfma_f32_32x32x16_bf16 a[16:31], v[52:55], a[68:71], a[16:31]
  v_add_f32 v224, v224, v216
  v_add_f32 v225, v225, v217
  v_add_f32 v226, v226, v218
  v_add_f32 v227, v227, v219
  s_waitcnt lgkmcnt(0)
  v_mfma_f32_32x32x16_bf16 a[0:15], v[92:95], v[180:183], a[32:47]
  s_barrier
  ds_read_b128 v[216:219], v250 offset:17408
  ds_read_b128 v[220:223], v250 offset:21760
  v_mfma_f32_32x32x16_bf16 a[0:15], v[72:75], a[216:219], a[0:15]
  ds_write_b128 v249, a[16:19] offset:52224
  v_mfma_f32_32x32x16_bf16 a[0:15], v[76:79], a[220:223], a[0:15]
  v_cvt_pk_bf16_f32 v244, v224, v225
  v_cvt_pk_bf16_f32 v245, v226, v227
  v_mfma_f32_32x32x16_bf16 a[0:15], v[80:83], v[168:171], a[0:15]
  ds_read_b128 v[224:227], v250 offset:26112
  ds_read_b128 v[228:231], v250 offset:30464
  buffer_load_dword v96, off, s[32:35], s45 offset:192 sc1
  s_waitcnt lgkmcnt(3)
  v_mfma_f32_32x32x16_bf16 a[0:15], v[84:87], v[172:175], a[0:15]
  ds_write_b128 v249, a[20:23] offset:53312
  v_mfma_f32_32x32x16_bf16 a[0:15], v[88:91], v[176:179], a[0:15]
  v_add_f32 v216, v216, v220
  v_add_f32 v217, v217, v221
  v_add_f32 v218, v218, v222
  v_add_f32 v219, v219, v223
  v_mfma_f32_32x32x16_bf16 a[0:15], v[64:67], a[208:211], a[0:15]
  ds_read_b128 a[64:67], v252 offset:2048
  ds_read_b128 a[68:71], v252 offset:3072
  v_mfma_f32_32x32x16_bf16 a[0:15], v[68:71], a[212:215], a[0:15]
  ds_write_b128 v249, a[24:27] offset:54400
  v_mfma_f32_32x32x16_bf16 a[0:15], v[56:59], a[144:147], a[0:15]
  s_waitcnt lgkmcnt(4)
  v_add_f32 v224, v224, v228
  v_add_f32 v225, v225, v229
  v_add_f32 v226, v226, v230
  v_add_f32 v227, v227, v231
  v_mfma_f32_32x32x16_bf16 a[0:15], v[60:63], a[148:151], a[0:15]
  buffer_load_dwordx2 a[54:55], v253, s[8:11], s74 offen offset:64
  s_waitcnt lgkmcnt(1)
  v_mfma_f32_32x32x16_bf16 a[0:15], v[48:51], a[64:67], a[0:15]
  ds_write_b128 v249, a[28:31] offset:55488
  v_mfma_f32_32x32x16_bf16 a[0:15], v[52:55], a[68:71], a[0:15]
  v_add_f32 v224, v224, v216
  v_add_f32 v225, v225, v217
  v_add_f32 v226, v226, v218
  v_add_f32 v227, v227, v219
  v_mfma_f32_32x32x16_bf16 a[16:31], v[92:95], v[196:199], a[32:47]
  ds_read_b128 v[216:219], v250 offset:34816
  ds_read_b128 v[220:223], v250 offset:39168
  v_mfma_f32_32x32x16_bf16 a[16:31], v[72:75], a[232:235], a[16:31]
  ds_write_b128 v249, a[0:3] offset:0
  v_mfma_f32_32x32x16_bf16 a[16:31], v[76:79], a[236:239], a[16:31]
  v_cvt_pk_bf16_f32 v246, v224, v225
  v_cvt_pk_bf16_f32 v247, v226, v227
  v_mfma_f32_32x32x16_bf16 a[16:31], v[80:83], v[184:187], a[16:31]
  ds_read_b128 v[224:227], v250 offset:43520
  ds_read_b128 v[228:231], v250 offset:47872
  s_waitcnt lgkmcnt(3)
  v_permlane32_swap_b32 v244, v246
  v_permlane32_swap_b32 v245, v247
  v_mfma_f32_32x32x16_bf16 a[16:31], v[84:87], v[188:191], a[16:31]
  ds_write_b128 v249, a[4:7] offset:1088
  v_mfma_f32_32x32x16_bf16 a[16:31], v[88:91], v[192:195], a[16:31]
  v_add_f32 v216, v216, v220
  v_add_f32 v217, v217, v221
  v_add_f32 v218, v218, v222
  v_add_f32 v219, v219, v223
  v_mfma_f32_32x32x16_bf16 a[16:31], v[64:67], a[224:227], a[16:31]
  ds_read_b128 a[64:67], v252 offset:4096
  ds_read_b128 a[68:71], v252 offset:5120
  buffer_load_dwordx2 a[56:57], v253, s[8:11], s75 offen offset:64
  v_mfma_f32_32x32x16_bf16 a[16:31], v[68:71], a[228:231], a[16:31]
  ds_write_b128 v249, a[8:11] offset:2176
  v_mfma_f32_32x32x16_bf16 a[16:31], v[56:59], a[152:155], a[16:31]
  s_waitcnt lgkmcnt(4)
  v_add_f32 v224, v224, v228
  v_add_f32 v225, v225, v229
  v_add_f32 v226, v226, v230
  v_add_f32 v227, v227, v231
  v_mfma_f32_32x32x16_bf16 a[16:31], v[60:63], a[156:159], a[16:31]
  buffer_store_dwordx4 v[244:247], v251, s[24:27], s74 offen offset:0 sc1
  s_waitcnt lgkmcnt(1)
  v_mfma_f32_32x32x16_bf16 a[16:31], v[48:51], a[64:67], a[16:31]
  ds_write_b128 v249, a[12:15] offset:3264
  v_mfma_f32_32x32x16_bf16 a[16:31], v[52:55], a[68:71], a[16:31]
  v_add_f32 v224, v224, v216
  v_add_f32 v225, v225, v217
  v_add_f32 v226, v226, v218
  v_add_f32 v227, v227, v219
  s_waitcnt lgkmcnt(0)
  v_mfma_f32_32x32x16_bf16 a[0:15], v[92:95], v[212:215], a[32:47]
  s_barrier
  ds_read_b128 v[216:219], v250 offset:52224
  ds_read_b128 v[220:223], v250 offset:56576
  v_mfma_f32_32x32x16_bf16 a[0:15], v[72:75], a[248:251], a[0:15]
  ds_write_b128 v249, a[16:19] offset:17408
  v_mfma_f32_32x32x16_bf16 a[0:15], v[76:79], a[252:255], a[0:15]
  v_cvt_pk_bf16_f32 v244, v224, v225
  v_cvt_pk_bf16_f32 v245, v226, v227
  s_waitcnt vmcnt(3)
  v_readfirstlane_b32 s4, v96
  s_cmp_lt_u32 s4, 6
  s_cbranch_scc1 L_slow3
L_back3:
  v_mfma_f32_32x32x16_bf16 a[0:15], v[80:83], v[200:203], a[0:15]
  ds_read_b128 v[224:227], v250 offset:60928
  ds_read_b128 v[228:231], v250 offset:65280
  buffer_load_dwordx4 v[44:47], v248, s[20:23], s44 offen offset:3072 sc1
  s_waitcnt lgkmcnt(3)
  v_mfma_f32_4x4x4_16b_bf16 v[216:219], v[232:233], a[62:63], v[216:219]
  v_mfma_f32_32x32x16_bf16 a[0:15], v[84:87], v[204:207], a[0:15]
  ds_write_b128 v249, a[20:23] offset:18496
  v_mfma_f32_32x32x16_bf16 a[0:15], v[88:91], v[208:211], a[0:15]
  v_add_f32 v216, v216, v220
  v_add_f32 v217, v217, v221
  v_add_f32 v218, v218, v222
  v_add_f32 v219, v219, v223
  v_mfma_f32_32x32x16_bf16 a[0:15], v[64:67], a[240:243], a[0:15]
  ds_read_b128 a[64:67], v252 offset:6144
  ds_read_b128 a[68:71], v252 offset:7168
  buffer_load_dwordx4 v[24:27], v248, s[20:23], s43 offen offset:2048 sc1
  v_mfma_f32_32x32x16_bf16 a[0:15], v[68:71], a[244:247], a[0:15]
  ds_write_b128 v249, a[24:27] offset:19584
  v_mfma_f32_32x32x16_bf16 a[0:15], v[56:59], a[160:163], a[0:15]
  s_waitcnt lgkmcnt(4)
  v_add_f32 v224, v224, v228
  v_add_f32 v225, v225, v229
  v_add_f32 v226, v226, v230
  v_add_f32 v227, v227, v231
  v_mfma_f32_32x32x16_bf16 a[0:15], v[60:63], a[164:167], a[0:15]
  buffer_load_dwordx2 a[58:59], v253, s[8:11], s76 offen offset:64
  buffer_load_dwordx4 v[28:31], v248, s[20:23], s43 offen offset:3072 sc1
  s_waitcnt lgkmcnt(1)
  v_mfma_f32_32x32x16_bf16 a[0:15], v[48:51], a[64:67], a[0:15]
  ds_write_b128 v249, a[28:31] offset:20672
  v_mfma_f32_32x32x16_bf16 a[0:15], v[52:55], a[68:71], a[0:15]
  v_add_f32 v224, v224, v216
  v_add_f32 v225, v225, v217
  v_add_f32 v226, v226, v218
  v_add_f32 v227, v227, v219
  v_mfma_f32_32x32x16_bf16 a[16:31], v[92:95], a[100:103], a[32:47]
  ds_read_b128 v[216:219], v250 offset:0
  ds_read_b128 v[220:223], v250 offset:4352
  buffer_load_dwordx4 v[32:35], v248, s[20:23], s44 offen offset:0 sc1
  v_mfma_f32_32x32x16_bf16 a[16:31], v[72:75], a[80:83], a[16:31]
  ds_write_b128 v249, a[0:3] offset:34816
  v_mfma_f32_32x32x16_bf16 a[16:31], v[76:79], a[84:87], a[16:31]
  buffer_load_dwordx4 v[36:39], v248, s[20:23], s44 offen offset:1024 sc1
  v_cvt_pk_bf16_f32 v246, v224, v225
  v_cvt_pk_bf16_f32 v247, v226, v227
  v_mfma_f32_32x32x16_bf16 a[16:31], v[80:83], a[88:91], a[16:31]
  ds_read_b128 v[224:227], v250 offset:8704
  ds_read_b128 v[228:231], v250 offset:13056
  buffer_load_dwordx4 v[40:43], v248, s[20:23], s44 offen offset:2048 sc1
  s_add_u32 s44, s44, 12288
  s_waitcnt lgkmcnt(3)
  v_mfma_f32_4x4x4_16b_bf16 v[216:219], v[232:233], a[48:49], v[216:219]
  v_permlane32_swap_b32 v244, v246
  v_permlane32_swap_b32 v245, v247
  v_mfma_f32_32x32x16_bf16 a[16:31], v[84:87], a[92:95], a[16:31]
  ds_write_b128 v249, a[4:7] offset:35904
  v_mfma_f32_32x32x16_bf16 a[16:31], v[88:91], a[96:99], a[16:31]
  v_add_f32 v216, v216, v220
  v_add_f32 v217, v217, v221
  v_add_f32 v218, v218, v222
  v_add_f32 v219, v219, v223
  v_mfma_f32_32x32x16_bf16 a[16:31], v[64:67], a[72:75], a[16:31]
  ds_read_b128 a[64:67], v252 offset:8192
  ds_read_b128 a[68:71], v252 offset:9216
  buffer_load_dwordx2 a[60:61], v253, s[8:11], s70 offen offset:128
  v_mfma_f32_32x32x16_bf16 a[16:31], v[68:71], a[76:79], a[16:31]
  ds_write_b128 v249, a[8:11] offset:36992
  v_mfma_f32_32x32x16_bf16 a[16:31], v[56:59], a[168:171], a[16:31]
  s_waitcnt lgkmcnt(4)
  v_add_f32 v224, v224, v228
  v_add_f32 v225, v225, v229
  v_add_f32 v226, v226, v230
  v_add_f32 v227, v227, v231
  v_mfma_f32_32x32x16_bf16 a[16:31], v[60:63], a[172:175], a[16:31]
  buffer_store_dwordx4 v[244:247], v255, s[24:27], s70 offen offset:0 sc1
  s_waitcnt lgkmcnt(1)
  v_mfma_f32_32x32x16_bf16 a[16:31], v[48:51], a[64:67], a[16:31]
  ds_write_b128 v249, a[12:15] offset:38080
  v_mfma_f32_32x32x16_bf16 a[16:31], v[52:55], a[68:71], a[16:31]
  v_add_f32 v224, v224, v216
  v_add_f32 v225, v225, v217
  v_add_f32 v226, v226, v218
  v_add_f32 v227, v227, v219
  s_waitcnt lgkmcnt(0)
  v_mfma_f32_32x32x16_bf16 a[0:15], v[92:95], a[116:119], a[32:47]
  s_barrier
  ds_read_b128 v[216:219], v250 offset:17408
  ds_read_b128 v[220:223], v250 offset:21760
  v_mfma_f32_32x32x16_bf16 a[0:15], v[72:75], v[128:131], a[0:15]
  ds_write_b128 v249, a[16:19] offset:52224
  v_mfma_f32_32x32x16_bf16 a[0:15], v[76:79], v[132:135], a[0:15]
  buffer_load_dwordx4 v[16:19], v248, s[20:23], s43 offen offset:0 sc1
  v_cvt_pk_bf16_f32 v244, v224, v225
  v_cvt_pk_bf16_f32 v245, v226, v227
  v_mfma_f32_32x32x16_bf16 a[0:15], v[80:83], a[104:107], a[0:15]
  ds_read_b128 v[224:227], v250 offset:26112
  ds_read_b128 v[228:231], v250 offset:30464
  buffer_load_dwordx4 v[20:23], v248, s[20:23], s43 offen offset:1024 sc1
  s_add_u32 s43, s43, 12288
  s_waitcnt lgkmcnt(3)
  v_mfma_f32_4x4x4_16b_bf16 v[216:219], v[232:233], a[50:51], v[216:219]
  v_mfma_f32_32x32x16_bf16 a[0:15], v[84:87], a[108:111], a[0:15]
  ds_write_b128 v249, a[20:23] offset:53312
  v_mfma_f32_32x32x16_bf16 a[0:15], v[88:91], a[112:115], a[0:15]
  v_add_f32 v216, v216, v220
  v_add_f32 v217, v217, v221
  v_add_f32 v218, v218, v222
  v_add_f32 v219, v219, v223
  v_mfma_f32_32x32x16_bf16 a[0:15], v[64:67], v[120:123], a[0:15]
  ds_read_b128 a[64:67], v252 offset:10240
  ds_read_b128 a[68:71], v252 offset:11264
  buffer_load_dwordx4 v[8:11], v248, s[20:23], s42 offen offset:2048 sc1
  v_mfma_f32_32x32x16_bf16 a[0:15], v[68:71], v[124:127], a[0:15]
  ds_write_b128 v249, a[24:27] offset:54400
  v_mfma_f32_32x32x16_bf16 a[0:15], v[56:59], a[176:179], a[0:15]
  s_waitcnt lgkmcnt(4)
  v_add_f32 v224, v224, v228
  v_add_f32 v225, v225, v229
  v_add_f32 v226, v226, v230
  v_add_f32 v227, v227, v231
  v_mfma_f32_32x32x16_bf16 a[0:15], v[60:63], a[180:183], a[0:15]
  buffer_load_dwordx2 a[62:63], v253, s[8:11], s71 offen offset:128
  buffer_load_dwordx4 v[12:15], v248, s[20:23], s42 offen offset:3072 sc1
  s_waitcnt lgkmcnt(1)
  v_mfma_f32_32x32x16_bf16 a[0:15], v[48:51], a[64:67], a[0:15]
  ds_write_b128 v249, a[28:31] offset:55488
  v_mfma_f32_32x32x16_bf16 a[0:15], v[52:55], a[68:71], a[0:15]
  v_add_f32 v224, v224, v216
  v_add_f32 v225, v225, v217
  v_add_f32 v226, v226, v218
  v_add_f32 v227, v227, v219
  v_mfma_f32_32x32x16_bf16 a[16:31], v[92:95], a[132:135], a[32:47]
  ds_read_b128 v[216:219], v250 offset:34816
  ds_read_b128 v[220:223], v250 offset:39168
  buffer_load_dwordx4 v[0:3], v248, s[20:23], s42 offen offset:0 sc1
  v_mfma_f32_32x32x16_bf16 a[16:31], v[72:75], v[144:147], a[16:31]
  ds_write_b128 v249, a[0:3] offset:0
  v_mfma_f32_32x32x16_bf16 a[16:31], v[76:79], v[148:151], a[16:31]
  buffer_load_dwordx4 v[4:7], v248, s[20:23], s42 offen offset:1024 sc1
  s_add_u32 s42, s42, 12288
  v_cvt_pk_bf16_f32 v246, v224, v225
  v_cvt_pk_bf16_f32 v247, v226, v227
  v_mfma_f32_32x32x16_bf16 a[16:31], v[80:83], a[120:123], a[16:31]
  ds_read_b128 v[224:227], v250 offset:43520
  ds_read_b128 v[228:231], v250 offset:47872
  ds_read_b128 a[32:35], v254 offset:256
  s_waitcnt lgkmcnt(4)
  v_mfma_f32_4x4x4_16b_bf16 v[216:219], v[232:233], a[52:53], v[216:219]
  v_permlane32_swap_b32 v244, v246
  v_permlane32_swap_b32 v245, v247
  v_mfma_f32_32x32x16_bf16 a[16:31], v[84:87], a[124:127], a[16:31]
  ds_write_b128 v249, a[4:7] offset:1088
  v_mfma_f32_32x32x16_bf16 a[16:31], v[88:91], a[128:131], a[16:31]
  v_add_f32 v216, v216, v220
  v_add_f32 v217, v217, v221
  v_add_f32 v218, v218, v222
  v_add_f32 v219, v219, v223
  v_mfma_f32_32x32x16_bf16 a[16:31], v[64:67], v[136:139], a[16:31]
  ds_read_b128 a[64:67], v252 offset:12288
  ds_read_b128 a[68:71], v252 offset:13312
  ds_read_b128 a[36:39], v254 offset:288
  buffer_load_dwordx2 a[48:49], v253, s[8:11], s72 offen offset:128
  v_mfma_f32_32x32x16_bf16 a[16:31], v[68:71], v[140:143], a[16:31]
  ds_write_b128 v249, a[8:11] offset:2176
  v_mfma_f32_32x32x16_bf16 a[16:31], v[56:59], a[184:187], a[16:31]
  s_waitcnt lgkmcnt(6)
  v_add_f32 v224, v224, v228
  v_add_f32 v225, v225, v229
  v_add_f32 v226, v226, v230
  v_add_f32 v227, v227, v231
  v_mfma_f32_32x32x16_bf16 a[16:31], v[60:63], a[188:191], a[16:31]
  ds_read_b128 a[40:43], v254 offset:320
  ds_read_b128 a[44:47], v254 offset:352
  buffer_store_dwordx4 v[244:247], v251, s[24:27], s71 offen offset:64 sc1
  s_waitcnt lgkmcnt(4)
  v_mfma_f32_32x32x16_bf16 a[16:31], v[48:51], a[64:67], a[16:31]
  ds_write_b128 v249, a[12:15] offset:3264
  v_mfma_f32_32x32x16_bf16 a[16:31], v[52:55], a[68:71], a[16:31]
  v_add_f32 v224, v224, v216
  v_add_f32 v225, v225, v217
  v_add_f32 v226, v226, v218
  v_add_f32 v227, v227, v219
  s_waitcnt lgkmcnt(0)
  s_waitcnt vmcnt(17)
  v_mfma_f32_32x32x16_bf16 a[0:15], v[44:47], v[164:167], a[32:47]
  s_barrier
  ds_read_b128 v[216:219], v250 offset:52224
  ds_read_b128 v[220:223], v250 offset:56576
  s_waitcnt vmcnt(16)
  v_mfma_f32_32x32x16_bf16 a[0:15], v[24:27], a[200:203], a[0:15]
  ds_write_b128 v249, a[16:19] offset:17408
  s_waitcnt vmcnt(14)
  v_mfma_f32_32x32x16_bf16 a[0:15], v[28:31], a[204:207], a[0:15]
  buffer_load_dwordx4 v[92:95], v248, s[20:23], s44 offen offset:3072 sc1
  v_cvt_pk_bf16_f32 v244, v224, v225
  v_cvt_pk_bf16_f32 v245, v226, v227
  s_waitcnt vmcnt(14)
  v_mfma_f32_32x32x16_bf16 a[0:15], v[32:35], v[152:155], a[0:15]
  ds_read_b128 v[224:227], v250 offset:60928
  ds_read_b128 v[228:231], v250 offset:65280
  buffer_load_dwordx4 v[72:75], v248, s[20:23], s43 offen offset:2048 sc1
  s_waitcnt lgkmcnt(3)
  v_mfma_f32_4x4x4_16b_bf16 v[216:219], v[232:233], a[54:55], v[216:219]
  s_waitcnt vmcnt(14)
  v_mfma_f32_32x32x16_bf16 a[0:15], v[36:39], v[156:159], a[0:15]
  ds_write_b128 v249, a[20:23] offset:18496
  s_waitcnt vmcnt(13)
  v_mfma_f32_32x32x16_bf16 a[0:15], v[40:43], v[160:163], a[0:15]
  v_add_f32 v216, v216, v220
  v_add_f32 v217, v217, v221
  v_add_f32 v218, v218, v222
  v_add_f32 v219, v219, v223
  s_waitcnt vmcnt(10)
  v_mfma_f32_32x32x16_bf16 a[0:15], v[16:19], a[192:195], a[0:15]
  ds_read_b128 a[64:67], v252 offset:0
  ds_read_b128 a[68:71], v252 offset:1024
  s_waitcnt vmcnt(9)
  v_mfma_f32_32x32x16_bf16 a[0:15], v[20:23], a[196:199], a[0:15]
  ds_write_b128 v249, a[24:27] offset:19584
  s_waitcnt vmcnt(8)
  v_mfma_f32_32x32x16_bf16 a[0:15], v[8:11], a[136:139], a[0:15]
  s_waitcnt lgkmcnt(4)
  v_add_f32 v224, v224, v228
  v_add_f32 v225, v225, v229
  v_add_f32 v226, v226, v230
  v_add_f32 v227, v227, v231
  s_waitcnt vmcnt(6)
  v_mfma_f32_32x32x16_bf16 a[0:15], v[12:15], a[140:143], a[0:15]
  buffer_load_dwordx2 a[50:51], v253, s[8:11], s73 offen offset:128
  s_waitcnt lgkmcnt(1)
  s_waitcnt vmcnt(6)
  v_mfma_f32_32x32x16_bf16 a[0:15], v[0:3], a[64:67], a[0:15]
  ds_write_b128 v249, a[28:31] offset:20672
  s_waitcnt vmcnt(5)
  v_mfma_f32_32x32x16_bf16 a[0:15], v[4:7], a[68:71], a[0:15]
  v_add_f32 v224, v224, v216
  v_add_f32 v225, v225, v217
  v_add_f32 v226, v226, v218
  v_add_f32 v227, v227, v219
  v_mfma_f32_32x32x16_bf16 a[16:31], v[44:47], v[180:183], a[32:47]
  ds_read_b128 v[216:219], v250 offset:0
  ds_read_b128 v[220:223], v250 offset:4352
  buffer_load_dwordx4 v[76:79], v248, s[20:23], s43 offen offset:3072 sc1
  v_mfma_f32_32x32x16_bf16 a[16:31], v[24:27], a[216:219], a[16:31]
  ds_write_b128 v249, a[0:3] offset:34816
  v_mfma_f32_32x32x16_bf16 a[16:31], v[28:31], a[220:223], a[16:31]
  buffer_load_dwordx4 v[80:83], v248, s[20:23], s44 offen offset:0 sc1
  v_cvt_pk_bf16_f32 v246, v224, v225
  v_cvt_pk_bf16_f32 v247, v226, v227
  v_mfma_f32_32x32x16_bf16 a[16:31], v[32:35], v[168:171], a[16:31]
  ds_read_b128 v[224:227], v250 offset:8704
  ds_read_b128 v[228:231], v250 offset:13056
  s_waitcnt lgkmcnt(3)
  v_mfma_f32_4x4x4_16b_bf16 v[216:219], v[232:233], a[56:57], v[216:219]
  v_permlane32_swap_b32 v244, v246
  v_permlane32_swap_b32 v245, v247
  v_mfma_f32_32x32x16_bf16 a[16:31], v[36:39], v[172:175], a[16:31]
  ds_write_b128 v249, a[4:7] offset:35904
  v_mfma_f32_32x32x16_bf16 a[16:31], v[40:43], v[176:179], a[16:31]
  v_add_f32 v216, v216, v220
  v_add_f32 v217, v217, v221
  v_add_f32 v218, v218, v222
  v_add_f32 v219, v219, v223
  v_mfma_f32_32x32x16_bf16 a[16:31], v[16:19], a[208:211], a[16:31]
  ds_read_b128 a[64:67], v252 offset:2048
  ds_read_b128 a[68:71], v252 offset:3072
  buffer_load_dwordx2 a[52:53], v253, s[8:11], s74 offen offset:128
  v_mfma_f32_32x32x16_bf16 a[16:31], v[20:23], a[212:215], a[16:31]
  ds_write_b128 v249, a[8:11] offset:36992
  v_mfma_f32_32x32x16_bf16 a[16:31], v[8:11], a[144:147], a[16:31]
  s_waitcnt lgkmcnt(4)
  v_add_f32 v224, v224, v228
  v_add_f32 v225, v225, v229
  v_add_f32 v226, v226, v230
  v_add_f32 v227, v227, v231
  v_mfma_f32_32x32x16_bf16 a[16:31], v[12:15], a[148:151], a[16:31]
  buffer_store_dwordx4 v[244:247], v251, s[24:27], s73 offen offset:64 sc1
  s_waitcnt lgkmcnt(1)
  v_mfma_f32_32x32x16_bf16 a[16:31], v[0:3], a[64:67], a[16:31]
  ds_write_b128 v249, a[12:15] offset:38080
  v_mfma_f32_32x32x16_bf16 a[16:31], v[4:7], a[68:71], a[16:31]
  v_add_f32 v224, v224, v216
  v_add_f32 v225, v225, v217
  v_add_f32 v226, v226, v218
  v_add_f32 v227, v227, v219
  s_waitcnt lgkmcnt(0)
  v_mfma_f32_32x32x16_bf16 a[0:15], v[44:47], v[196:199], a[32:47]
  s_barrier
  ds_read_b128 v[216:219], v250 offset:17408
  ds_read_b128 v[220:223], v250 offset:21760
  v_mfma_f32_32x32x16_bf16 a[0:15], v[24:27], a[232:235], a[0:15]
  ds_write_b128 v249, a[16:19] offset:52224
  v_mfma_f32_32x32x16_bf16 a[0:15], v[28:31], a[236:239], a[0:15]
  buffer_load_dwordx4 v[84:87], v248, s[20:23], s44 offen offset:1024 sc1
  v_cvt_pk_bf16_f32 v244, v224, v225
  v_cvt_pk_bf16_f32 v245, v226, v227
  v_mfma_f32_32x32x16_bf16 a[0:15], v[32:35], v[184:187], a[0:15]
  ds_read_b128 v[224:227], v250 offset:26112
  ds_read_b128 v[228:231], v250 offset:30464
  buffer_load_dwordx4 v[88:91], v248, s[20:23], s44 offen offset:2048 sc1
  s_add_u32 s44, s44, 12288
  s_waitcnt lgkmcnt(3)
  v_mfma_f32_4x4x4_16b_bf16 v[216:219], v[232:233], a[58:59], v[216:219]
  v_mfma_f32_32x32x16_bf16 a[0:15], v[36:39], v[188:191], a[0:15]
  ds_write_b128 v249, a[20:23] offset:53312
  v_mfma_f32_32x32x16_bf16 a[0:15], v[40:43], v[192:195], a[0:15]
  v_add_f32 v216, v216, v220
  v_add_f32 v217, v217, v221
  v_add_f32 v218, v218, v222
  v_add_f32 v219, v219, v223
  v_mfma_f32_32x32x16_bf16 a[0:15], v[16:19], a[224:227], a[0:15]
  ds_read_b128 a[64:67], v252 offset:4096
  ds_read_b128 a[68:71], v252 offset:5120
  v_mfma_f32_32x32x16_bf16 a[0:15], v[20:23], a[228:231], a[0:15]
  ds_write_b128 v249, a[24:27] offset:54400
  v_mfma_f32_32x32x16_bf16 a[0:15], v[8:11], a[152:155], a[0:15]
  s_waitcnt lgkmcnt(4)
  v_add_f32 v224, v224, v228
  v_add_f32 v225, v225, v229
  v_add_f32 v226, v226, v230
  v_add_f32 v227, v227, v231
  v_mfma_f32_32x32x16_bf16 a[0:15], v[12:15], a[156:159], a[0:15]
  buffer_load_dwordx2 a[54:55], v253, s[8:11], s75 offen offset:128
  s_waitcnt lgkmcnt(1)
  v_mfma_f32_32x32x16_bf16 a[0:15], v[0:3], a[64:67], a[0:15]
  ds_write_b128 v249, a[28:31] offset:55488
  v_mfma_f32_32x32x16_bf16 a[0:15], v[4:7], a[68:71], a[0:15]
  v_add_f32 v224, v224, v216
  v_add_f32 v225, v225, v217
  v_add_f32 v226, v226, v218
  v_add_f32 v227, v227, v219
  v_mfma_f32_32x32x16_bf16 a[16:31], v[44:47], v[212:215], a[32:47]
  ds_read_b128 v[216:219], v250 offset:34816
  ds_read_b128 v[220:223], v250 offset:39168
  buffer_load_dwordx4 v[64:67], v248, s[20:23], s43 offen offset:0 sc1
  v_mfma_f32_32x32x16_bf16 a[16:31], v[24:27], a[248:251], a[16:31]
  ds_write_b128 v249, a[0:3] offset:0
  v_mfma_f32_32x32x16_bf16 a[16:31], v[28:31], a[252:255], a[16:31]
  buffer_load_dwordx4 v[68:71], v248, s[20:23], s43 offen offset:1024 sc1
  s_add_u32 s43, s43, 12288
  v_cvt_pk_bf16_f32 v246, v224, v225
  v_cvt_pk_bf16_f32 v247, v226, v227
  v_mfma_f32_32x32x16_bf16 a[16:31], v[32:35], v[200:203], a[16:31]
  ds_read_b128 v[224:227], v250 offset:43520
  ds_read_b128 v[228:231], v250 offset:47872
  s_waitcnt lgkmcnt(3)
  v_mfma_f32_4x4x4_16b_bf16 v[216:219], v[232:233], a[60:61], v[216:219]
  v_permlane32_swap_b32 v244, v246
  v_permlane32_swap_b32 v245, v247
  v_mfma_f32_32x32x16_bf16 a[16:31], v[36:39], v[204:207], a[16:31]
  ds_write_b128 v249, a[4:7] offset:1088
  v_mfma_f32_32x32x16_bf16 a[16:31], v[40:43], v[208:211], a[16:31]
  v_add_f32 v216, v216, v220
  v_add_f32 v217, v217, v221
  v_add_f32 v218, v218, v222
  v_add_f32 v219, v219, v223
  v_mfma_f32_32x32x16_bf16 a[16:31], v[16:19], a[240:243], a[16:31]
  ds_read_b128 a[64:67], v252 offset:6144
  ds_read_b128 a[68:71], v252 offset:7168
  buffer_load_dwordx2 a[56:57], v253, s[8:11], s76 offen offset:128
  v_mfma_f32_32x32x16_bf16 a[16:31], v[20:23], a[244:247], a[16:31]
  ds_write_b128 v249, a[8:11] offset:2176
  v_mfma_f32_32x32x16_bf16 a[16:31], v[8:11], a[160:163], a[16:31]
  s_waitcnt lgkmcnt(4)
  v_add_f32 v224, v224, v228
  v_add_f32 v225, v225, v229
  v_add_f32 v226, v226, v230
  v_add_f32 v227, v227, v231
  v_mfma_f32_32x32x16_bf16 a[16:31], v[12:15], a[164:167], a[16:31]
  buffer_store_dwordx4 v[244:247], v251, s[24:27], s75 offen offset:64 sc1
  s_waitcnt lgkmcnt(1)
  v_mfma_f32_32x32x16_bf16 a[16:31], v[0:3], a[64:67], a[16:31]
  ds_write_b128 v249, a[12:15] offset:3264
  v_mfma_f32_32x32x16_bf16 a[16:31], v[4:7], a[68:71], a[16:31]
  v_add_f32 v224, v224, v216
  v_add_f32 v225, v225, v217
  v_add_f32 v226, v226, v218
  v_add_f32 v227, v227, v219
  s_waitcnt lgkmcnt(0)
  v_mfma_f32_32x32x16_bf16 a[0:15], v[44:47], a[100:103], a[32:47]
  s_barrier
  ds_read_b128 v[216:219], v250 offset:52224
  ds_read_b128 v[220:223], v250 offset:56576
  v_mfma_f32_32x32x16_bf16 a[0:15], v[24:27], a[80:83], a[0:15]
  ds_write_b128 v249, a[16:19] offset:17408
  v_mfma_f32_32x32x16_bf16 a[0:15], v[28:31], a[84:87], a[0:15]
  buffer_load_dwordx4 v[56:59], v248, s[20:23], s42 offen offset:2048 sc1
  v_cvt_pk_bf16_f32 v244, v224, v225
  v_cvt_pk_bf16_f32 v245, v226, v227
  v_mfma_f32_32x32x16_bf16 a[0:15], v[32:35], a[88:91], a[0:15]
  ds_read_b128 v[224:227], v250 offset:60928
  ds_read_b128 v[228:231], v250 offset:65280
  buffer_load_dwordx4 v[60:63], v248, s[20:23], s42 offen offset:3072 sc1
  s_waitcnt lgkmcnt(3)
  v_mfma_f32_4x4x4_16b_bf16 v[216:219], v[232:233], a[62:63], v[216:219]
  v_mfma_f32_32x32x16_bf16 a[0:15], v[36:39], a[92:95], a[0:15]
  ds_write_b128 v249, a[20:23] offset:18496
  v_mfma_f32_32x32x16_bf16 a[0:15], v[40:43], a[96:99], a[0:15]
  v_add_f32 v216, v216, v220
  v_add_f32 v217, v217, v221
  v_add_f32 v218, v218, v222
  v_add_f32 v219, v219, v223
  v_mfma_f32_32x32x16_bf16 a[0:15], v[16:19], a[72:75], a[0:15]
  ds_read_b128 a[64:67], v252 offset:8192
  ds_read_b128 a[68:71], v252 offset:9216
  v_mfma_f32_32x32x16_bf16 a[0:15], v[20:23], a[76:79], a[0:15]
  ds_write_b128 v249, a[24:27] offset:19584
  v_mfma_f32_32x32x16_bf16 a[0:15], v[8:11], a[168:171], a[0:15]
  s_waitcnt lgkmcnt(4)
  v_add_f32 v224, v224, v228
  v_add_f32 v225, v225, v229
  v_add_f32 v226, v226, v230
  v_add_f32 v227, v227, v231
  v_mfma_f32_32x32x16_bf16 a[0:15], v[12:15], a[172:175], a[0:15]
  buffer_load_dwordx2 a[58:59], v253, s[8:11], s70 offen offset:192
  s_waitcnt lgkmcnt(1)
  v_mfma_f32_32x32x16_bf16 a[0:15], v[0:3], a[64:67], a[0:15]
  ds_write_b128 v249, a[28:31] offset:20672
  v_mfma_f32_32x32x16_bf16 a[0:15], v[4:7], a[68:71], a[0:15]
  v_add_f32 v224, v224, v216
  v_add_f32 v225, v225, v217
  v_add_f32 v226, v226, v218
  v_add_f32 v227, v227, v219
  v_mfma_f32_32x32x16_bf16 a[16:31], v[44:47], a[116:119], a[32:47]
  ds_read_b128 v[216:219], v250 offset:0
  ds_read_b128 v[220:223], v250 offset:4352
  buffer_load_dwordx4 v[48:51], v248, s[20:23], s42 offen offset:0 sc1
  v_mfma_f32_32x32x16_bf16 a[16:31], v[24:27], v[128:131], a[16:31]
  ds_write_b128 v249, a[0:3] offset:34816
  v_mfma_f32_32x32x16_bf16 a[16:31], v[28:31], v[132:135], a[16:31]
  buffer_load_dwordx4 v[52:55], v248, s[20:23], s42 offen offset:1024 sc1
  s_add_u32 s42, s42, 12288
  v_cvt_pk_bf16_f32 v246, v224, v225
  v_cvt_pk_bf16_f32 v247, v226, v227
  v_mfma_f32_32x32x16_bf16 a[16:31], v[32:35], a[104:107], a[16:31]
  ds_read_b128 v[224:227], v250 offset:8704
  ds_read_b128 v[228:231], v250 offset:13056
  s_waitcnt vmcnt(20) lgkmcnt(3)
  v_mfma_f32_4x4x4_16b_bf16 v[216:219], v[232:233], a[48:49], v[216:219]
  v_permlane32_swap_b32 v244, v246
  v_permlane32_swap_b32 v245, v247
  v_mfma_f32_32x32x16_bf16 a[16:31], v[36:39], a[108:111], a[16:31]
  ds_write_b128 v249, a[4:7] offset:35904
  v_mfma_f32_32x32x16_bf16 a[16:31], v[40:43], a[112:115], a[16:31]
  v_add_f32 v216, v216, v220
  v_add_f32 v217, v217, v221
  v_add_f32 v218, v218, v222
  v_add_f32 v219, v219, v223
  v_mfma_f32_32x32x16_bf16 a[16:31], v[16:19], v[120:123], a[16:31]
  ds_read_b128 a[64:67], v252 offset:10240
  ds_read_b128 a[68:71], v252 offset:11264
  buffer_load_dwordx2 a[60:61], v253, s[8:11], s71 offen offset:192
  v_mfma_f32_32x32x16_bf16 a[16:31], v[20:23], v[124:127], a[16:31]
  ds_write_b128 v249, a[8:11] offset:36992
  v_mfma_f32_32x32x16_bf16 a[16:31], v[8:11], a[176:179], a[16:31]
  s_waitcnt lgkmcnt(4)
  v_add_f32 v224, v224, v228
  v_add_f32 v225, v225, v229
  v_add_f32 v226, v226, v230
  v_add_f32 v227, v227, v231
  v_mfma_f32_32x32x16_bf16 a[16:31], v[12:15], a[180:183], a[16:31]
  buffer_store_dwordx4 v[244:247], v251, s[24:27], s70 offen offset:128 sc1
  s_waitcnt lgkmcnt(1)
  v_mfma_f32_32x32x16_bf16 a[16:31], v[0:3], a[64:67], a[16:31]
  ds_write_b128 v249, a[12:15] offset:38080
  v_mfma_f32_32x32x16_bf16 a[16:31], v[4:7], a[68:71], a[16:31]
  v_add_f32 v224, v224, v216
  v_add_f32 v225, v225, v217
  v_add_f32 v226, v226, v218
  v_add_f32 v227, v227, v219
  s_waitcnt lgkmcnt(0)
  v_mfma_f32_32x32x16_bf16 a[0:15], v[44:47], a[132:135], a[32:47]
  s_barrier
  ds_read_b128 v[216:219], v250 offset:17408
  ds_read_b128 v[220:223], v250 offset:21760
  v_mfma_f32_32x32x16_bf16 a[0:15], v[24:27], v[144:147], a[0:15]
  ds_write_b128 v249, a[16:19] offset:52224
  v_mfma_f32_32x32x16_bf16 a[0:15], v[28:31], v[148:151], a[0:15]
  v_cvt_pk_bf16_f32 v244, v224, v225
  v_cvt_pk_bf16_f32 v245, v226, v227
  v_mfma_f32_32x32x16_bf16 a[0:15], v[32:35], a[120:123], a[0:15]
  ds_read_b128 v[224:227], v250 offset:26112
  ds_read_b128 v[228:231], v250 offset:30464
  ds_read_b128 a[32:35], v254 offset:384
  s_waitcnt vmcnt(18) lgkmcnt(4)
  v_mfma_f32_4x4x4_16b_bf16 v[216:219], v[232:233], a[50:51], v[216:219]
  v_mfma_f32_32x32x16_bf16 a[0:15], v[36:39], a[124:127], a[0:15]
  ds_write_b128 v249, a[20:23] offset:53312
  v_mfma_f32_32x32x16_bf16 a[0:15], v[40:43], a[128:131], a[0:15]
  v_add_f32 v216, v216, v220
  v_add_f32 v217, v217, v221
  v_add_f32 v218, v218, v222
  v_add_f32 v219, v219, v223
  v_mfma_f32_32x32x16_bf16 a[0:15], v[16:19], v[136:139], a[0:15]
  ds_read_b128 a[64:67], v252 offset:12288
  ds_read_b128 a[68:71], v252 offset:13312
  ds_read_b128 a[36:39], v254 offset:416
  v_mfma_f32_32x32x16_bf16 a[0:15], v[20:23], v[140:143], a[0:15]
  ds_write_b128 v249, a[24:27] offset:54400
  v_mfma_f32_32x32x16_bf16 a[0:15], v[8:11], a[184:187], a[0:15]
  s_waitcnt lgkmcnt(6)
  v_add_f32 v224, v224, v228
  v_add_f32 v225, v225, v229
  v_add_f32 v226, v226, v230
  v_add_f32 v227, v227, v231
  v_mfma_f32_32x32x16_bf16 a[0:15], v[12:15], a[188:191], a[0:15]
  ds_read_b128 a[40:43], v254 offset:448
  ds_read_b128 a[44:47], v254 offset:480
  buffer_load_dwordx2 a[62:63], v253, s[8:11], s72 offen offset:192
  s_waitcnt lgkmcnt(4)
  v_mfma_f32_32x32x16_bf16 a[0:15], v[0:3], a[64:67], a[0:15]
  ds_write_b128 v249, a[28:31] offset:55488
  v_mfma_f32_32x32x16_bf16 a[0:15], v[4:7], a[68:71], a[0:15]
  v_add_f32 v224, v224, v216
  v_add_f32 v225, v225, v217
  v_add_f32 v226, v226, v218
  v_add_f32 v227, v227, v219
  s_waitcnt lgkmcnt(1)
  v_mfma_f32_32x32x16_bf16 a[16:31], v[92:95], v[164:167], a[32:47]
  ds_read_b128 v[216:219], v250 offset:34816
  ds_read_b128 v[220:223], v250 offset:39168
  buffer_load_dwordx4 v[44:47], v248, s[20:23], s44 offen offset:3072 sc1
  v_mfma_f32_32x32x16_bf16 a[16:31], v[72:75], a[200:203], a[16:31]
  ds_write_b128 v249, a[0:3] offset:0
  s_waitcnt vmcnt(19)
  v_mfma_f32_32x32x16_bf16 a[16:31], v[76:79], a[204:207], a[16:31]
  buffer_load_dwordx4 v[24:27], v248, s[20:23], s43 offen offset:2048 sc1
  v_cvt_pk_bf16_f32 v246, v224, v225
  v_cvt_pk_bf16_f32 v247, v226, v227
  s_waitcnt vmcnt(19)
  v_mfma_f32_32x32x16_bf16 a[16:31], v[80:83], v[152:155], a[16:31]
  ds_read_b128 v[224:227], v250 offset:43520
  ds_read_b128 v[228:231], v250 offset:47872
  s_waitcnt vmcnt(18) lgkmcnt(3)
  v_mfma_f32_4x4x4_16b_bf16 v[216:219], v[232:233], a[52:53], v[216:219]
  v_permlane32_swap_b32 v244, v246
  v_permlane32_swap_b32 v245, v247
  s_waitcnt vmcnt(16)
  v_mfma_f32_32x32x16_bf16 a[16:31], v[84:87], v[156:159], a[16:31]
  ds_write_b128 v249, a[4:7] offset:1088
  s_waitcnt vmcnt(15)
  v_mfma_f32_32x32x16_bf16 a[16:31], v[88:91], v[160:163], a[16:31]
  v_add_f32 v216, v216, v220
  v_add_f32 v217, v217, v221
  v_add_f32 v218, v218, v222
  v_add_f32 v219, v219, v223
  s_waitcnt vmcnt(13)
  v_mfma_f32_32x32x16_bf16 a[16:31], v[64:67], a[192:195], a[16:31]
  ds_read_b128 a[64:67], v252 offset:0
  ds_read_b128 a[68:71], v252 offset:1024
  buffer_load_dwordx2 a[48:49], v253, s[8:11], s73 offen offset:192
  s_waitcnt vmcnt(13)
  v_mfma_f32_32x32x16_bf16 a[16:31], v[68:71], a[196:199], a[16:31]
  ds_write_b128 v249, a[8:11] offset:2176
  s_waitcnt vmcnt(10)
  v_mfma_f32_32x32x16_bf16 a[16:31], v[56:59], a[136:139], a[16:31]
  s_waitcnt lgkmcnt(4)
  v_add_f32 v224, v224, v228
  v_add_f32 v225, v225, v229
  v_add_f32 v226, v226, v230
  v_add_f32 v227, v227, v231
  s_waitcnt vmcnt(9)
  v_mfma_f32_32x32x16_bf16 a[16:31], v[60:63], a[140:143], a[16:31]
  buffer_store_dwordx4 v[244:247], v251, s[24:27], s72 offen offset:128 sc1
  s_waitcnt lgkmcnt(1)
  s_waitcnt vmcnt(8)
  v_mfma_f32_32x32x16_bf16 a[16:31], v[48:51], a[64:67], a[16:31]
  ds_write_b128 v249, a[12:15] offset:3264
  s_waitcnt vmcnt(7)
  v_mfma_f32_32x32x16_bf16 a[16:31], v[52:55], a[68:71], a[16:31]
  v_add_f32 v224, v224, v216
  v_add_f32 v225, v225, v217
  v_add_f32 v226, v226, v218
  v_add_f32 v227, v227, v219
  s_waitcnt lgkmcnt(0)
  v_mfma_f32_32x32x16_bf16 a[0:15], v[92:95], v[180:183], a[32:47]
  s_barrier
  ds_read_b128 v[216:219], v250 offset:52224
  ds_read_b128 v[220:223], v250 offset:56576
  v_mfma_f32_32x32x16_bf16 a[0:15], v[72:75], a[216:219], a[0:15]
  ds_write_b128 v249, a[16:19] offset:17408
  v_mfma_f32_32x32x16_bf16 a[0:15], v[76:79], a[220:223], a[0:15]
  buffer_load_dwordx4 v[28:31], v248, s[20:23], s43 offen offset:3072 sc1
  v_cvt_pk_bf16_f32 v244, v224, v225
  v_cvt_pk_bf16_f32 v245, v226, v227
  v_mfma_f32_32x32x16_bf16 a[0:15], v[80:83], v[168:171], a[0:15]
  ds_read_b128 v[224:227], v250 offset:60928
  ds_read_b128 v[228:231], v250 offset:65280
  buffer_load_dwordx4 v[32:35], v248, s[20:23], s44 offen offset:0 sc1
  s_waitcnt lgkmcnt(3)
  v_mfma_f32_4x4x4_16b_bf16 v[216:219], v[232:233], a[54:55], v[216:219]
  v_mfma_f32_32x32x16_bf16 a[0:15], v[84:87], v[172:175], a[0:15]
  ds_write_b128 v249, a[20:23] offset:18496
  v_mfma_f32_32x32x16_bf16 a[0:15], v[88:91], v[176:179], a[0:15]
  v_add_f32 v216, v216, v220
  v_add_f32 v217, v217, v221
  v_add_f32 v218, v218, v222
  v_add_f32 v219, v219, v223
  v_mfma_f32_32x32x16_bf16 a[0:15], v[64:67], a[208:211], a[0:15]
  ds_read_b128 a[64:67], v252 offset:2048
  ds_read_b128 a[68:71], v252 offset:3072
  v_mfma_f32_32x32x16_bf16 a[0:15], v[68:71], a[212:215], a[0:15]
  ds_write_b128 v249, a[24:27] offset:19584
  v_mfma_f32_32x32x16_bf16 a[0:15], v[56:59], a[144:147], a[0:15]
  s_waitcnt lgkmcnt(4)
  v_add_f32 v224, v224, v228
  v_add_f32 v225, v225, v229
  v_add_f32 v226, v226, v230
  v_add_f32 v227, v227, v231
  v_mfma_f32_32x32x16_bf16 a[0:15], v[60:63], a[148:151], a[0:15]
  buffer_load_dwordx2 a[50:51], v253, s[8:11], s74 offen offset:192
  s_waitcnt lgkmcnt(1)
  v_mfma_f32_32x32x16_bf16 a[0:15], v[48:51], a[64:67], a[0:15]
  ds_write_b128 v249, a[28:31] offset:20672
  v_mfma_f32_32x32x16_bf16 a[0:15], v[52:55], a[68:71], a[0:15]
  v_add_f32 v224, v224, v216
  v_add_f32 v225, v225, v217
  v_add_f32 v226, v226, v218
  v_add_f32 v227, v227, v219
  v_mfma_f32_32x32x16_bf16 a[16:31], v[92:95], v[196:199], a[32:47]
  ds_read_b128 v[216:219], v250 offset:0
  ds_read_b128 v[220:223], v250 offset:4352
  buffer_load_dwordx4 v[36:39], v248, s[20:23], s44 offen offset:1024 sc1
  v_mfma_f32_32x32x16_bf16 a[16:31], v[72:75], a[232:235], a[16:31]
  ds_write_b128 v249, a[0:3] offset:34816
  v_mfma_f32_32x32x16_bf16 a[16:31], v[76:79], a[236:239], a[16:31]
  buffer_load_dwordx4 v[40:43], v248, s[20:23], s44 offen offset:2048 sc1
  s_add_u32 s44, s44, 12288
  v_cvt_pk_bf16_f32 v246, v224, v225
  v_cvt_pk_bf16_f32 v247, v226, v227
  v_mfma_f32_32x32x16_bf16 a[16:31], v[80:83], v[184:187], a[16:31]
  ds_read_b128 v[224:227], v250 offset:8704
  ds_read_b128 v[228:231], v250 offset:13056
  s_waitcnt lgkmcnt(3)
  v_mfma_f32_4x4x4_16b_bf16 v[216:219], v[232:233], a[56:57], v[216:219]
  v_permlane32_swap_b32 v244, v246
  v_permlane32_swap_b32 v245, v247
  v_mfma_f32_32x32x16_bf16 a[16:31], v[84:87], v[188:191], a[16:31]
  ds_write_b128 v249, a[4:7] offset:35904
  v_mfma_f32_32x32x16_bf16 a[16:31], v[88:91], v[192:195], a[16:31]
  v_add_f32 v216, v216, v220
  v_add_f32 v217, v217, v221
  v_add_f32 v218, v218, v222
  v_add_f32 v219, v219, v223
  v_mfma_f32_32x32x16_bf16 a[16:31], v[64:67], a[224:227], a[16:31]
  ds_read_b128 a[64:67], v252 offset:4096
  ds_read_b128 a[68:71], v252 offset:5120
  buffer_load_dwordx2 a[52:53], v253, s[8:11], s75 offen offset:192
  v_mfma_f32_32x32x16_bf16 a[16:31], v[68:71], a[228:231], a[16:31]
  ds_write_b128 v249, a[8:11] offset:36992
  v_mfma_f32_32x32x16_bf16 a[16:31], v[56:59], a[152:155], a[16:31]
  s_waitcnt lgkmcnt(4)
  v_add_f32 v224, v224, v228
  v_add_f32 v225, v225, v229
  v_add_f32 v226, v226, v230
  v_add_f32 v227, v227, v231
  v_mfma_f32_32x32x16_bf16 a[16:31], v[60:63], a[156:159], a[16:31]
  buffer_store_dwordx4 v[244:247], v251, s[24:27], s74 offen offset:128 sc1
  s_waitcnt lgkmcnt(1)
  v_mfma_f32_32x32x16_bf16 a[16:31], v[48:51], a[64:67], a[16:31]
  ds_write_b128 v249, a[12:15] offset:38080
  v_mfma_f32_32x32x16_bf16 a[16:31], v[52:55], a[68:71], a[16:31]
  v_add_f32 v224, v224, v216
  v_add_f32 v225, v225, v217
  v_add_f32 v226, v226, v218
  v_add_f32 v227, v227, v219
  s_waitcnt lgkmcnt(0)
  v_mfma_f32_32x32x16_bf16 a[0:15], v[92:95], v[212:215], a[32:47]
  s_barrier
  ds_read_b128 v[216:219], v250 offset:17408
  ds_read_b128 v[220:223], v250 offset:21760
  v_mfma_f32_32x32x16_bf16 a[0:15], v[72:75], a[248:251], a[0:15]
  ds_write_b128 v249, a[16:19] offset:52224
  v_mfma_f32_32x32x16_bf16 a[0:15], v[76:79], a[252:255], a[0:15]
  buffer_load_dwordx4 v[16:19], v248, s[20:23], s43 offen offset:0 sc1
  v_cvt_pk_bf16_f32 v244, v224, v225
  v_cvt_pk_bf16_f32 v245, v226, v227
  v_mfma_f32_32x32x16_bf16 a[0:15], v[80:83], v[200:203], a[0:15]
  ds_read_b128 v[224:227], v250 offset:26112
  ds_read_b128 v[228:231], v250 offset:30464
  buffer_load_dwordx4 v[20:23], v248, s[20:23], s43 offen offset:1024 sc1
  s_add_u32 s43, s43, 12288
  s_waitcnt lgkmcnt(3)
  v_mfma_f32_4x4x4_16b_bf16 v[216:219], v[232:233], a[58:59], v[216:219]
  v_mfma_f32_32x32x16_bf16 a[0:15], v[84:87], v[204:207], a[0:15]
  ds_write_b128 v249, a[20:23] offset:53312
  v_mfma_f32_32x32x16_bf16 a[0:15], v[88:91], v[208:211], a[0:15]
  v_add_f32 v216, v216, v220
  v_add_f32 v217, v217, v221
  v_add_f32 v218, v218, v222
  v_add_f32 v219, v219, v223
  v_mfma_f32_32x32x16_bf16 a[0:15], v[64:67], a[240:243], a[0:15]
  ds_read_b128 a[64:67], v252 offset:6144
  ds_read_b128 a[68:71], v252 offset:7168
  v_mfma_f32_32x32x16_bf16 a[0:15], v[68:71], a[244:247], a[0:15]
  ds_write_b128 v249, a[24:27] offset:54400
  v_mfma_f32_32x32x16_bf16 a[0:15], v[56:59], a[160:163], a[0:15]
  s_waitcnt lgkmcnt(4)
  v_add_f32 v224, v224, v228
  v_add_f32 v225, v225, v229
  v_add_f32 v226, v226, v230
  v_add_f32 v227, v227, v231
  v_mfma_f32_32x32x16_bf16 a[0:15], v[60:63], a[164:167], a[0:15]
  buffer_load_dwordx2 a[54:55], v253, s[8:11], s76 offen offset:192
  s_waitcnt lgkmcnt(1)
  v_mfma_f32_32x32x16_bf16 a[0:15], v[48:51], a[64:67], a[0:15]
  ds_write_b128 v249, a[28:31] offset:55488
  v_mfma_f32_32x32x16_bf16 a[0:15], v[52:55], a[68:71], a[0:15]
  v_add_f32 v224, v224, v216
  v_add_f32 v225, v225, v217
  v_add_f32 v226, v226, v218
  v_add_f32 v227, v227, v219
  v_mfma_f32_32x32x16_bf16 a[16:31], v[92:95], a[100:103], a[32:47]
  ds_read_b128 v[216:219], v250 offset:34816
  ds_read_b128 v[220:223], v250 offset:39168
  buffer_load_dwordx4 v[8:11], v248, s[20:23], s42 offen offset:2048 sc1
  v_mfma_f32_32x32x16_bf16 a[16:31], v[72:75], a[80:83], a[16:31]
  ds_write_b128 v249, a[0:3] offset:0
  v_mfma_f32_32x32x16_bf16 a[16:31], v[76:79], a[84:87], a[16:31]
  buffer_load_dwordx4 v[12:15], v248, s[20:23], s42 offen offset:3072 sc1
  v_cvt_pk_bf16_f32 v246, v224, v225
  v_cvt_pk_bf16_f32 v247, v226, v227
  v_mfma_f32_32x32x16_bf16 a[16:31], v[80:83], a[88:91], a[16:31]
  ds_read_b128 v[224:227], v250 offset:43520
  ds_read_b128 v[228:231], v250 offset:47872
  s_waitcnt vmcnt(18) lgkmcnt(3)
  v_mfma_f32_4x4x4_16b_bf16 v[216:219], v[232:233], a[60:61], v[216:219]
  v_permlane32_swap_b32 v244, v246
  v_permlane32_swap_b32 v245, v247
  v_mfma_f32_32x32x16_bf16 a[16:31], v[84:87], a[92:95], a[16:31]
  ds_write_b128 v249, a[4:7] offset:1088
  v_mfma_f32_32x32x16_bf16 a[16:31], v[88:91], a[96:99], a[16:31]
  v_add_f32 v216, v216, v220
  v_add_f32 v217, v217, v221
  v_add_f32 v218, v218, v222
  v_add_f32 v219, v219, v223
  v_mfma_f32_32x32x16_bf16 a[16:31], v[64:67], a[72:75], a[16:31]
  ds_read_b128 a[64:67], v252 offset:8192
  ds_read_b128 a[68:71], v252 offset:9216
  buffer_load_dwordx2 a[56:57], v253, s[8:11], s70 offen offset:256
  v_mfma_f32_32x32x16_bf16 a[16:31], v[68:71], a[76:79], a[16:31]
  ds_write_b128 v249, a[8:11] offset:2176
  v_mfma_f32_32x32x16_bf16 a[16:31], v[56:59], a[168:171], a[16:31]
  s_waitcnt lgkmcnt(4)
  v_add_f32 v224, v224, v228
  v_add_f32 v225, v225, v229
  v_add_f32 v226, v226, v230
  v_add_f32 v227, v227, v231
  v_mfma_f32_32x32x16_bf16 a[16:31], v[60:63], a[172:175], a[16:31]
  buffer_store_dwordx4 v[244:247], v255, s[24:27], s70 offen offset:128 sc1
  s_waitcnt lgkmcnt(1)
  v_mfma_f32_32x32x16_bf16 a[16:31], v[48:51], a[64:67], a[16:31]
  ds_write_b128 v249, a[12:15] offset:3264
  v_mfma_f32_32x32x16_bf16 a[16:31], v[52:55], a[68:71], a[16:31]
  v_add_f32 v224, v224, v216
  v_add_f32 v225, v225, v217
  v_add_f32 v226, v226, v218
  v_add_f32 v227, v227, v219
  s_waitcnt lgkmcnt(0)
  v_mfma_f32_32x32x16_bf16 a[0:15], v[92:95], a[116:119], a[32:47]
  s_barrier
  ds_read_b128 v[216:219], v250 offset:52224
  ds_read_b128 v[220:223], v250 offset:56576
  v_mfma_f32_32x32x16_bf16 a[0:15], v[72:75], v[128:131], a[0:15]
  ds_write_b128 v249, a[16:19] offset:17408
  v_mfma_f32_32x32x16_bf16 a[0:15], v[76:79], v[132:135], a[0:15]
  buffer_load_dwordx4 v[0:3], v248, s[20:23], s42 offen offset:0 sc1
  v_cvt_pk_bf16_f32 v244, v224, v225
  v_cvt_pk_bf16_f32 v245, v226, v227
  v_mfma_f32_32x32x16_bf16 a[0:15], v[80:83], a[104:107], a[0:15]
  ds_read_b128 v[224:227], v250 offset:60928
  ds_read_b128 v[228:231], v250 offset:65280
  buffer_load_dwordx4 v[4:7], v248, s[20:23], s42 offen offset:1024 sc1
  s_add_u32 s42, s42, 12288
  s_waitcnt vmcnt(20) lgkmcnt(3)
  v_mfma_f32_4x4x4_16b_bf16 v[216:219], v[232:233], a[62:63], v[216:219]
  v_mfma_f32_32x32x16_bf16 a[0:15], v[84:87], a[108:111], a[0:15]
  ds_write_b128 v249, a[20:23] offset:18496
  v_mfma_f32_32x32x16_bf16 a[0:15], v[88:91], a[112:115], a[0:15]
  v_add_f32 v216, v216, v220
  v_add_f32 v217, v217, v221
  v_add_f32 v218, v218, v222
  v_add_f32 v219, v219, v223
  v_mfma_f32_32x32x16_bf16 a[0:15], v[64:67], v[120:123], a[0:15]
  ds_read_b128 a[64:67], v252 offset:10240
  ds_read_b128 a[68:71], v252 offset:11264
  v_mfma_f32_32x32x16_bf16 a[0:15], v[68:71], v[124:127], a[0:15]
  ds_write_b128 v249, a[24:27] offset:19584
  v_mfma_f32_32x32x16_bf16 a[0:15], v[56:59], a[176:179], a[0:15]
  s_waitcnt lgkmcnt(4)
  v_add_f32 v224, v224, v228
  v_add_f32 v225, v225, v229
  v_add_f32 v226, v226, v230
  v_add_f32 v227, v227, v231
  v_mfma_f32_32x32x16_bf16 a[0:15], v[60:63], a[180:183], a[0:15]
  buffer_load_dwordx2 a[58:59], v253, s[8:11], s71 offen offset:256
  s_waitcnt lgkmcnt(1)
  v_mfma_f32_32x32x16_bf16 a[0:15], v[48:51], a[64:67], a[0:15]
  ds_write_b128 v249, a[28:31] offset:20672
  v_mfma_f32_32x32x16_bf16 a[0:15], v[52:55], a[68:71], a[0:15]
  v_add_f32 v224, v224, v216
  v_add_f32 v225, v225, v217
  v_add_f32 v226, v226, v218
  v_add_f32 v227, v227, v219
  v_mfma_f32_32x32x16_bf16 a[16:31], v[92:95], a[132:135], a[32:47]
  ds_read_b128 v[216:219], v250 offset:0
  ds_read_b128 v[220:223], v250 offset:4352
  v_mfma_f32_32x32x16_bf16 a[16:31], v[72:75], v[144:147], a[16:31]
  ds_write_b128 v249, a[0:3] offset:34816
  v_mfma_f32_32x32x16_bf16 a[16:31], v[76:79], v[148:151], a[16:31]
  v_cvt_pk_bf16_f32 v246, v224, v225
  v_cvt_pk_bf16_f32 v247, v226, v227
  v_mfma_f32_32x32x16_bf16 a[16:31], v[80:83], a[120:123], a[16:31]
  ds_read_b128 v[224:227], v250 offset:8704
  ds_read_b128 v[228:231], v250 offset:13056
  ds_read_b128 a[32:35], v254 offset:512
  s_waitcnt vmcnt(18) lgkmcnt(4)
  v_mfma_f32_4x4x4_16b_bf16 v[216:219], v[232:233], a[48:49], v[216:219]
  v_permlane32_swap_b32 v244, v246
  v_permlane32_swap_b32 v245, v247
  v_mfma_f32_32x32x16_bf16 a[16:31], v[84:87], a[124:127], a[16:31]
  ds_write_b128 v249, a[4:7] offset:35904
  v_mfma_f32_32x32x16_bf16 a[16:31], v[88:91], a[128:131], a[16:31]
  v_add_f32 v216, v216, v220
  v_add_f32 v217, v217, v221
  v_add_f32 v218, v218, v222
  v_add_f32 v219, v219, v223
  v_mfma_f32_32x32x16_bf16 a[16:31], v[64:67], v[136:139], a[16:31]
  ds_read_b128 a[64:67], v252 offset:12288
  ds_read_b128 a[68:71], v252 offset:13312
  ds_read_b128 a[36:39], v254 offset:544
  buffer_load_dwordx2 a[60:61], v253, s[8:11], s72 offen offset:256
  v_mfma_f32_32x32x16_bf16 a[16:31], v[68:71], v[140:143], a[16:31]
  ds_write_b128 v249, a[8:11] offset:36992
  v_mfma_f32_32x32x16_bf16 a[16:31], v[56:59], a[184:187], a[16:31]
  s_waitcnt lgkmcnt(6)
  v_add_f32 v224, v224, v228
  v_add_f32 v225, v225, v229
  v_add_f32 v226, v226, v230
  v_add_f32 v227, v227, v231
  v_mfma_f32_32x32x16_bf16 a[16:31], v[60:63], a[188:191], a[16:31]
  ds_read_b128 a[40:43], v254 offset:576
  ds_read_b128 a[44:47], v254 offset:608
  buffer_store_dwordx4 v[244:247], v251, s[24:27], s71 offen offset:192 sc1
  s_waitcnt lgkmcnt(4)
  v_mfma_f32_32x32x16_bf16 a[16:31], v[48:51], a[64:67], a[16:31]
  ds_write_b128 v249, a[12:15] offset:38080
  v_mfma_f32_32x32x16_bf16 a[16:31], v[52:55], a[68:71], a[16:31]
  v_add_f32 v224, v224, v216
  v_add_f32 v225, v225, v217
  v_add_f32 v226, v226, v218
  v_add_f32 v227, v227, v219
  s_waitcnt lgkmcnt(0)
  v_mfma_f32_32x32x16_bf16 a[0:15], v[44:47], v[164:167], a[32:47]
  s_barrier
  ds_read_b128 v[216:219], v250 offset:17408
  ds_read_b128 v[220:223], v250 offset:21760
  v_mfma_f32_32x32x16_bf16 a[0:15], v[24:27], a[200:203], a[0:15]
  ds_write_b128 v249, a[16:19] offset:52224
  s_waitcnt vmcnt(18)
  v_mfma_f32_32x32x16_bf16 a[0:15], v[28:31], a[204:207], a[0:15]
  buffer_load_dwordx4 v[92:95], v248, s[20:23], s44 offen offset:3072 sc1
  v_cvt_pk_bf16_f32 v244, v224, v225
  v_cvt_pk_bf16_f32 v245, v226, v227
  s_waitcnt vmcnt(18)
  v_mfma_f32_32x32x16_bf16 a[0:15], v[32:35], v[152:155], a[0:15]
  ds_read_b128 v[224:227], v250 offset:26112
  ds_read_b128 v[228:231], v250 offset:30464
  buffer_load_dwordx4 v[72:75], v248, s[20:23], s43 offen offset:2048 sc1
  s_waitcnt vmcnt(18) lgkmcnt(3)
  v_mfma_f32_4x4x4_16b_bf16 v[216:219], v[232:233], a[50:51], v[216:219]
  s_waitcnt vmcnt(17)
  v_mfma_f32_32x32x16_bf16 a[0:15], v[36:39], v[156:159], a[0:15]
  ds_write_b128 v249, a[20:23] offset:53312
  s_waitcnt vmcnt(16)
  v_mfma_f32_32x32x16_bf16 a[0:15], v[40:43], v[160:163], a[0:15]
  v_add_f32 v216, v216, v220
  v_add_f32 v217, v217, v221
  v_add_f32 v218, v218, v222
  v_add_f32 v219, v219, v223
  s_waitcnt vmcnt(13)
  v_mfma_f32_32x32x16_bf16 a[0:15], v[16:19], a[192:195], a[0:15]
  ds_read_b128 a[64:67], v252 offset:0
  ds_read_b128 a[68:71], v252 offset:1024
  s_waitcnt vmcnt(12)
  v_mfma_f32_32x32x16_bf16 a[0:15], v[20:23], a[196:199], a[0:15]
  ds_write_b128 v249, a[24:27] offset:54400
  s_waitcnt vmcnt(10)
  v_mfma_f32_32x32x16_bf16 a[0:15], v[8:11], a[136:139], a[0:15]
  s_waitcnt lgkmcnt(4)
  v_add_f32 v224, v224, v228
  v_add_f32 v225, v225, v229
  v_add_f32 v226, v226, v230
  v_add_f32 v227, v227, v231
  s_waitcnt vmcnt(9)
  v_mfma_f32_32x32x16_bf16 a[0:15], v[12:15], a[140:143], a[0:15]
  buffer_load_dwordx2 a[62:63], v253, s[8:11], s73 offen offset:256
  s_waitcnt lgkmcnt(1)
  s_waitcnt vmcnt(7)
  v_mfma_f32_32x32x16_bf16 a[0:15], v[0:3], a[64:67], a[0:15]
  ds_write_b128 v249, a[28:31] offset:55488
  s_waitcnt vmcnt(6)
  v_mfma_f32_32x32x16_bf16 a[0:15], v[4:7], a[68:71], a[0:15]
  v_add_f32 v224, v224, v216
  v_add_f32 v225, v225, v217
  v_add_f32 v226, v226, v218
  v_add_f32 v227, v227, v219
  v_mfma_f32_32x32x16_bf16 a[16:31], v[44:47], v[180:183], a[32:47]
  ds_read_b128 v[216:219], v250 offset:34816
  ds_read_b128 v[220:223], v250 offset:39168
  buffer_load_dwordx4 v[76:79], v248, s[20:23], s43 offen offset:3072 sc1
  v_mfma_f32_32x32x16_bf16 a[16:31], v[24:27], a[216:219], a[16:31]
  ds_write_b128 v249, a[0:3] offset:0
  v_mfma_f32_32x32x16_bf16 a[16:31], v[28:31], a[220:223], a[16:31]
  buffer_load_dwordx4 v[80:83], v248, s[20:23], s44 offen offset:0 sc1
  v_cvt_pk_bf16_f32 v246, v224, v225
  v_cvt_pk_bf16_f32 v247, v226, v227
  v_mfma_f32_32x32x16_bf16 a[16:31], v[32:35], v[168:171], a[16:31]
  ds_read_b128 v[224:227], v250 offset:43520
  ds_read_b128 v[228:231], v250 offset:47872
  s_waitcnt lgkmcnt(3)
  v_mfma_f32_4x4x4_16b_bf16 v[216:219], v[232:233], a[52:53], v[216:219]
  v_permlane32_swap_b32 v244, v246
  v_permlane32_swap_b32 v245, v247
  v_mfma_f32_32x32x16_bf16 a[16:31], v[36:39], v[172:175], a[16:31]
  ds_write_b128 v249, a[4:7] offset:1088
  v_mfma_f32_32x32x16_bf16 a[16:31], v[40:43], v[176:179], a[16:31]
  v_add_f32 v216, v216, v220
  v_add_f32 v217, v217, v221
  v_add_f32 v218, v218, v222
  v_add_f32 v219, v219, v223
  v_mfma_f32_32x32x16_bf16 a[16:31], v[16:19], a[208:211], a[16:31]
  ds_read_b128 a[64:67], v252 offset:2048
  ds_read_b128 a[68:71], v252 offset:3072
  buffer_load_dwordx2 a[48:49], v253, s[8:11], s74 offen offset:256
  v_mfma_f32_32x32x16_bf16 a[16:31], v[20:23], a[212:215], a[16:31]
  ds_write_b128 v249, a[8:11] offset:2176
  v_mfma_f32_32x32x16_bf16 a[16:31], v[8:11], a[144:147], a[16:31]
  s_waitcnt lgkmcnt(4)
  v_add_f32 v224, v224, v228
  v_add_f32 v225, v225, v229
  v_add_f32 v226, v226, v230
  v_add_f32 v227, v227, v231
  v_mfma_f32_32x32x16_bf16 a[16:31], v[12:15], a[148:151], a[16:31]
  buffer_store_dwordx4 v[244:247], v251, s[24:27], s73 offen offset:192 sc1
  s_waitcnt lgkmcnt(1)
  v_mfma_f32_32x32x16_bf16 a[16:31], v[0:3], a[64:67], a[16:31]
  ds_write_b128 v249, a[12:15] offset:3264
  v_mfma_f32_32x32x16_bf16 a[16:31], v[4:7], a[68:71], a[16:31]
  v_add_f32 v224, v224, v216
  v_add_f32 v225, v225, v217
  v_add_f32 v226, v226, v218
  v_add_f32 v227, v227, v219
  s_waitcnt lgkmcnt(0)
  v_mfma_f32_32x32x16_bf16 a[0:15], v[44:47], v[196:199], a[32:47]
  s_barrier
  ds_read_b128 v[216:219], v250 offset:52224
  ds_read_b128 v[220:223], v250 offset:56576
  v_mfma_f32_32x32x16_bf16 a[0:15], v[24:27], a[232:235], a[0:15]
  ds_write_b128 v249, a[16:19] offset:17408
  v_mfma_f32_32x32x16_bf16 a[0:15], v[28:31], a[236:239], a[0:15]
  buffer_load_dwordx4 v[84:87], v248, s[20:23], s44 offen offset:1024 sc1
  v_cvt_pk_bf16_f32 v244, v224, v225
  v_cvt_pk_bf16_f32 v245, v226, v227
  v_mfma_f32_32x32x16_bf16 a[0:15], v[32:35], v[184:187], a[0:15]
  ds_read_b128 v[224:227], v250 offset:60928
  ds_read_b128 v[228:231], v250 offset:65280
  buffer_load_dwordx4 v[88:91], v248, s[20:23], s44 offen offset:2048 sc1
  s_waitcnt lgkmcnt(3)
  v_mfma_f32_4x4x4_16b_bf16 v[216:219], v[232:233], a[54:55], v[216:219]
  v_mfma_f32_32x32x16_bf16 a[0:15], v[36:39], v[188:191], a[0:15]
  ds_write_b128 v249, a[20:23] offset:18496
  v_mfma_f32_32x32x16_bf16 a[0:15], v[40:43], v[192:195], a[0:15]
  v_add_f32 v216, v216, v220
  v_add_f32 v217, v217, v221
  v_add_f32 v218, v218, v222
  v_add_f32 v219, v219, v223
  v_mfma_f32_32x32x16_bf16 a[0:15], v[16:19], a[224:227], a[0:15]
  ds_read_b128 a[64:67], v252 offset:4096
  ds_read_b128 a[68:71], v252 offset:5120
  v_mfma_f32_32x32x16_bf16 a[0:15], v[20:23], a[228:231], a[0:15]
  ds_write_b128 v249, a[24:27] offset:19584
  v_mfma_f32_32x32x16_bf16 a[0:15], v[8:11], a[152:155], a[0:15]
  s_waitcnt lgkmcnt(4)
  v_add_f32 v224, v224, v228
  v_add_f32 v225, v225, v229
  v_add_f32 v226, v226, v230
  v_add_f32 v227, v227, v231
  v_mfma_f32_32x32x16_bf16 a[0:15], v[12:15], a[156:159], a[0:15]
  buffer_load_dwordx2 a[50:51], v253, s[8:11], s75 offen offset:256
  s_waitcnt lgkmcnt(1)
  v_mfma_f32_32x32x16_bf16 a[0:15], v[0:3], a[64:67], a[0:15]
  ds_write_b128 v249, a[28:31] offset:20672
  v_mfma_f32_32x32x16_bf16 a[0:15], v[4:7], a[68:71], a[0:15]
  v_add_f32 v224, v224, v216
  v_add_f32 v225, v225, v217
  v_add_f32 v226, v226, v218
  v_add_f32 v227, v227, v219
  v_mfma_f32_32x32x16_bf16 a[16:31], v[44:47], v[212:215], a[32:47]
  ds_read_b128 v[216:219], v250 offset:0
  ds_read_b128 v[220:223], v250 offset:4352
  buffer_load_dwordx4 v[64:67], v248, s[20:23], s43 offen offset:0 sc1
  v_mfma_f32_32x32x16_bf16 a[16:31], v[24:27], a[248:251], a[16:31]
  ds_write_b128 v249, a[0:3] offset:34816
  v_mfma_f32_32x32x16_bf16 a[16:31], v[28:31], a[252:255], a[16:31]
  buffer_load_dwordx4 v[68:71], v248, s[20:23], s43 offen offset:1024 sc1
  v_cvt_pk_bf16_f32 v246, v224, v225
  v_cvt_pk_bf16_f32 v247, v226, v227
  v_mfma_f32_32x32x16_bf16 a[16:31], v[32:35], v[200:203], a[16:31]
  ds_read_b128 v[224:227], v250 offset:8704
  ds_read_b128 v[228:231], v250 offset:13056
  s_waitcnt lgkmcnt(3)
  v_mfma_f32_4x4x4_16b_bf16 v[216:219], v[232:233], a[56:57], v[216:219]
  v_permlane32_swap_b32 v244, v246
  v_permlane32_swap_b32 v245, v247
  v_mfma_f32_32x32x16_bf16 a[16:31], v[36:39], v[204:207], a[16:31]
  ds_write_b128 v249, a[4:7] offset:35904
  v_mfma_f32_32x32x16_bf16 a[16:31], v[40:43], v[208:211], a[16:31]
  v_add_f32 v216, v216, v220
  v_add_f32 v217, v217, v221
  v_add_f32 v218, v218, v222
  v_add_f32 v219, v219, v223
  v_mfma_f32_32x32x16_bf16 a[16:31], v[16:19], a[240:243], a[16:31]
  ds_read_b128 a[64:67], v252 offset:6144
  ds_read_b128 a[68:71], v252 offset:7168
  buffer_load_dwordx2 a[52:53], v253, s[8:11], s76 offen offset:256
  v_mfma_f32_32x32x16_bf16 a[16:31], v[20:23], a[244:247], a[16:31]
  ds_write_b128 v249, a[8:11] offset:36992
  v_mfma_f32_32x32x16_bf16 a[16:31], v[8:11], a[160:163], a[16:31]
  s_waitcnt lgkmcnt(4)
  v_add_f32 v224, v224, v228
  v_add_f32 v225, v225, v229
  v_add_f32 v226, v226, v230
  v_add_f32 v227, v227, v231
  v_mfma_f32_32x32x16_bf16 a[16:31], v[12:15], a[164:167], a[16:31]
  buffer_store_dwordx4 v[244:247], v251, s[24:27], s75 offen offset:192 sc1
  s_waitcnt lgkmcnt(1)
  v_mfma_f32_32x32x16_bf16 a[16:31], v[0:3], a[64:67], a[16:31]
  ds_write_b128 v249, a[12:15] offset:38080
  v_mfma_f32_32x32x16_bf16 a[16:31], v[4:7], a[68:71], a[16:31]
  v_add_f32 v224, v224, v216
  v_add_f32 v225, v225, v217
  v_add_f32 v226, v226, v218
  v_add_f32 v227, v227, v219
  s_waitcnt lgkmcnt(0)
  v_mfma_f32_32x32x16_bf16 a[0:15], v[44:47], a[100:103], a[32:47]
  s_barrier
  ds_read_b128 v[216:219], v250 offset:17408
  ds_read_b128 v[220:223], v250 offset:21760
  v_mfma_f32_32x32x16_bf16 a[0:15], v[24:27], a[80:83], a[0:15]
  ds_write_b128 v249, a[16:19] offset:52224
  v_mfma_f32_32x32x16_bf16 a[0:15], v[28:31], a[84:87], a[0:15]
  buffer_load_dwordx4 v[56:59], v248, s[20:23], s42 offen offset:2048 sc1
  v_cvt_pk_bf16_f32 v244, v224, v225
  v_cvt_pk_bf16_f32 v245, v226, v227
  v_mfma_f32_32x32x16_bf16 a[0:15], v[32:35], a[88:91], a[0:15]
  ds_read_b128 v[224:227], v250 offset:26112
  ds_read_b128 v[228:231], v250 offset:30464
  buffer_load_dwordx4 v[60:63], v248, s[20:23], s42 offen offset:3072 sc1
  s_waitcnt vmcnt(18) lgkmcnt(3)
  v_mfma_f32_4x4x4_16b_bf16 v[216:219], v[232:233], a[58:59], v[216:219]
  v_mfma_f32_32x32x16_bf16 a[0:15], v[36:39], a[92:95], a[0:15]
  ds_write_b128 v249, a[20:23] offset:53312
  v_mfma_f32_32x32x16_bf16 a[0:15], v[40:43], a[96:99], a[0:15]
  v_add_f32 v216, v216, v220
  v_add_f32 v217, v217, v221
  v_add_f32 v218, v218, v222
  v_add_f32 v219, v219, v223
  v_mfma_f32_32x32x16_bf16 a[0:15], v[16:19], a[72:75], a[0:15]
  ds_read_b128 a[64:67], v252 offset:8192
  ds_read_b128 a[68:71], v252 offset:9216
  v_mfma_f32_32x32x16_bf16 a[0:15], v[20:23], a[76:79], a[0:15]
  ds_write_b128 v249, a[24:27] offset:54400
  v_mfma_f32_32x32x16_bf16 a[0:15], v[8:11], a[168:171], a[0:15]
  s_waitcnt lgkmcnt(4)
  v_add_f32 v224, v224, v228
  v_add_f32 v225, v225, v229
  v_add_f32 v226, v226, v230
  v_add_f32 v227, v227, v231
  v_mfma_f32_32x32x16_bf16 a[0:15], v[12:15], a[172:175], a[0:15]
  buffer_load_dwordx2 a[54:55], v253, s[8:11], s70 offen offset:320
  s_waitcnt lgkmcnt(1)
  v_mfma_f32_32x32x16_bf16 a[0:15], v[0:3], a[64:67], a[0:15]
  ds_write_b128 v249, a[28:31] offset:55488
  v_mfma_f32_32x32x16_bf16 a[0:15], v[4:7], a[68:71], a[0:15]
  v_add_f32 v224, v224, v216
  v_add_f32 v225, v225, v217
  v_add_f32 v226, v226, v218
  v_add_f32 v227, v227, v219
  v_mfma_f32_32x32x16_bf16 a[16:31], v[44:47], a[116:119], a[32:47]
  ds_read_b128 v[216:219], v250 offset:34816
  ds_read_b128 v[220:223], v250 offset:39168
  buffer_load_dwordx4 v[48:51], v248, s[20:23], s42 offen offset:0 sc1
  v_mfma_f32_32x32x16_bf16 a[16:31], v[24:27], v[128:131], a[16:31]
  ds_write_b128 v249, a[0:3] offset:0
  v_mfma_f32_32x32x16_bf16 a[16:31], v[28:31], v[132:135], a[16:31]
  buffer_load_dwordx4 v[52:55], v248, s[20:23], s42 offen offset:1024 sc1
  v_cvt_pk_bf16_f32 v246, v224, v225
  v_cvt_pk_bf16_f32 v247, v226, v227
  v_mfma_f32_32x32x16_bf16 a[16:31], v[32:35], a[104:107], a[16:31]
  ds_read_b128 v[224:227], v250 offset:43520
  ds_read_b128 v[228:231], v250 offset:47872
  s_waitcnt vmcnt(20) lgkmcnt(3)
  v_mfma_f32_4x4x4_16b_bf16 v[216:219], v[232:233], a[60:61], v[216:219]
  v_permlane32_swap_b32 v244, v246
  v_permlane32_swap_b32 v245, v247
  v_mfma_f32_32x32x16_bf16 a[16:31], v[36:39], a[108:111], a[16:31]
  ds_write_b128 v249, a[4:7] offset:1088
  v_mfma_f32_32x32x16_bf16 a[16:31], v[40:43], a[112:115], a[16:31]
  v_add_f32 v216, v216, v220
  v_add_f32 v217, v217, v221
  v_add_f32 v218, v218, v222
  v_add_f32 v219, v219, v223
  v_mfma_f32_32x32x16_bf16 a[16:31], v[16:19], v[120:123], a[16:31]
  ds_read_b128 a[64:67], v252 offset:10240
  ds_read_b128 a[68:71], v252 offset:11264
  buffer_load_dwordx2 a[56:57], v253, s[8:11], s71 offen offset:320
  v_mfma_f32_32x32x16_bf16 a[16:31], v[20:23], v[124:127], a[16:31]
  ds_write_b128 v249, a[8:11] offset:2176
  v_mfma_f32_32x32x16_bf16 a[16:31], v[8:11], a[176:179], a[16:31]
  s_waitcnt lgkmcnt(4)
  v_add_f32 v224, v224, v228
  v_add_f32 v225, v225, v229
  v_add_f32 v226, v226, v230
  v_add_f32 v227, v227, v231
  v_mfma_f32_32x32x16_bf16 a[16:31], v[12:15], a[180:183], a[16:31]
  buffer_store_dwordx4 v[244:247], v251, s[24:27], s70 offen offset:256 sc1
  s_waitcnt lgkmcnt(1)
  v_mfma_f32_32x32x16_bf16 a[16:31], v[0:3], a[64:67], a[16:31]
  ds_write_b128 v249, a[12:15] offset:3264
  v_mfma_f32_32x32x16_bf16 a[16:31], v[4:7], a[68:71], a[16:31]
  v_add_f32 v224, v224, v216
  v_add_f32 v225, v225, v217
  v_add_f32 v226, v226, v218
  v_add_f32 v227, v227, v219
  s_waitcnt lgkmcnt(0)
  v_mfma_f32_32x32x16_bf16 a[0:15], v[44:47], a[132:135], a[32:47]
  s_barrier
  ds_read_b128 v[216:219], v250 offset:52224
  ds_read_b128 v[220:223], v250 offset:56576
  v_mfma_f32_32x32x16_bf16 a[0:15], v[24:27], v[144:147], a[0:15]
  ds_write_b128 v249, a[16:19] offset:17408
  v_mfma_f32_32x32x16_bf16 a[0:15], v[28:31], v[148:151], a[0:15]
  v_cvt_pk_bf16_f32 v244, v224, v225
  v_cvt_pk_bf16_f32 v245, v226, v227
  v_mfma_f32_32x32x16_bf16 a[0:15], v[32:35], a[120:123], a[0:15]
  ds_read_b128 v[224:227], v250 offset:60928
  ds_read_b128 v[228:231], v250 offset:65280
  ds_read_b128 a[32:35], v254 offset:640
  s_waitcnt vmcnt(18) lgkmcnt(4)
  v_mfma_f32_4x4x4_16b_bf16 v[216:219], v[232:233], a[62:63], v[216:219]
  v_mfma_f32_32x32x16_bf16 a[0:15], v[36:39], a[124:127], a[0:15]
  ds_write_b128 v249, a[20:23] offset:18496
  v_mfma_f32_32x32x16_bf16 a[0:15], v[40:43], a[128:131], a[0:15]
  v_add_f32 v216, v216, v220
  v_add_f32 v217, v217, v221
  v_add_f32 v218, v218, v222
  v_add_f32 v219, v219, v223
  v_mfma_f32_32x32x16_bf16 a[0:15], v[16:19], v[136:139], a[0:15]
  ds_read_b128 a[64:67], v252 offset:12288
  ds_read_b128 a[68:71], v252 offset:13312
  ds_read_b128 a[36:39], v254 offset:672
  v_mfma_f32_32x32x16_bf16 a[0:15], v[20:23], v[140:143], a[0:15]
  ds_write_b128 v249, a[24:27] offset:19584
  v_mfma_f32_32x32x16_bf16 a[0:15], v[8:11], a[184:187], a[0:15]
  s_waitcnt lgkmcnt(6)
  v_add_f32 v224, v224, v228
  v_add_f32 v225, v225, v229
  v_add_f32 v226, v226, v230
  v_add_f32 v227, v227, v231
  v_mfma_f32_32x32x16_bf16 a[0:15], v[12:15], a[188:191], a[0:15]
  ds_read_b128 a[40:43], v254 offset:704
  ds_read_b128 a[44:47], v254 offset:736
  buffer_load_dwordx2 a[58:59], v253, s[8:11], s72 offen offset:320
  s_waitcnt lgkmcnt(4)
  v_mfma_f32_32x32x16_bf16 a[0:15], v[0:3], a[64:67], a[0:15]
  ds_write_b128 v249, a[28:31] offset:20672
  v_mfma_f32_32x32x16_bf16 a[0:15], v[4:7], a[68:71], a[0:15]
  v_add_f32 v224, v224, v216
  v_add_f32 v225, v225, v217
  v_add_f32 v226, v226, v218
  v_add_f32 v227, v227, v219
  s_waitcnt lgkmcnt(1)
  v_mfma_f32_32x32x16_bf16 a[16:31], v[92:95], v[164:167], a[32:47]
  ds_read_b128 v[216:219], v250 offset:0
  ds_read_b128 v[220:223], v250 offset:4352
  v_mfma_f32_32x32x16_bf16 a[16:31], v[72:75], a[200:203], a[16:31]
  ds_write_b128 v249, a[0:3] offset:34816
  s_waitcnt vmcnt(18)
  v_mfma_f32_32x32x16_bf16 a[16:31], v[76:79], a[204:207], a[16:31]
  v_cvt_pk_bf16_f32 v246, v224, v225
  v_cvt_pk_bf16_f32 v247, v226, v227
  s_waitcnt vmcnt(17)
  v_mfma_f32_32x32x16_bf16 a[16:31], v[80:83], v[152:155], a[16:31]
  ds_read_b128 v[224:227], v250 offset:8704
  ds_read_b128 v[228:231], v250 offset:13056
  s_waitcnt vmcnt(16) lgkmcnt(3)
  v_mfma_f32_4x4x4_16b_bf16 v[216:219], v[232:233], a[48:49], v[216:219]
  v_permlane32_swap_b32 v244, v246
  v_permlane32_swap_b32 v245, v247
  s_waitcnt vmcnt(14)
  v_mfma_f32_32x32x16_bf16 a[16:31], v[84:87], v[156:159], a[16:31]
  ds_write_b128 v249, a[4:7] offset:35904
  s_waitcnt vmcnt(13)
  v_mfma_f32_32x32x16_bf16 a[16:31], v[88:91], v[160:163], a[16:31]
  v_add_f32 v216, v216, v220
  v_add_f32 v217, v217, v221
  v_add_f32 v218, v218, v222
  v_add_f32 v219, v219, v223
  s_waitcnt vmcnt(11)
  v_mfma_f32_32x32x16_bf16 a[16:31], v[64:67], a[192:195], a[16:31]
  ds_read_b128 a[64:67], v252 offset:0
  ds_read_b128 a[68:71], v252 offset:1024
  buffer_load_dwordx2 a[60:61], v253, s[8:11], s73 offen offset:320
  s_waitcnt vmcnt(11)
  v_mfma_f32_32x32x16_bf16 a[16:31], v[68:71], a[196:199], a[16:31]
  ds_write_b128 v249, a[8:11] offset:36992
  s_waitcnt vmcnt(8)
  v_mfma_f32_32x32x16_bf16 a[16:31], v[56:59], a[136:139], a[16:31]
  s_waitcnt lgkmcnt(4)
  v_add_f32 v224, v224, v228
  v_add_f32 v225, v225, v229
  v_add_f32 v226, v226, v230
  v_add_f32 v227, v227, v231
  s_waitcnt vmcnt(7)
  v_mfma_f32_32x32x16_bf16 a[16:31], v[60:63], a[140:143], a[16:31]
  buffer_store_dwordx4 v[244:247], v251, s[24:27], s72 offen offset:256 sc1
  s_waitcnt lgkmcnt(1)
  s_waitcnt vmcnt(6)
  v_mfma_f32_32x32x16_bf16 a[16:31], v[48:51], a[64:67], a[16:31]
  ds_write_b128 v249, a[12:15] offset:38080
  s_waitcnt vmcnt(5)
  v_mfma_f32_32x32x16_bf16 a[16:31], v[52:55], a[68:71], a[16:31]
  v_add_f32 v224, v224, v216
  v_add_f32 v225, v225, v217
  v_add_f32 v226, v226, v218
  v_add_f32 v227, v227, v219
  s_waitcnt lgkmcnt(0)
  v_mfma_f32_32x32x16_bf16 a[0:15], v[92:95], v[180:183], a[32:47]
  s_barrier
  ds_read_b128 v[216:219], v250 offset:17408
  ds_read_b128 v[220:223], v250 offset:21760
  v_mfma_f32_32x32x16_bf16 a[0:15], v[72:75], a[216:219], a[0:15]
  ds_write_b128 v249, a[16:19] offset:52224
  v_mfma_f32_32x32x16_bf16 a[0:15], v[76:79], a[220:223], a[0:15]
  v_cvt_pk_bf16_f32 v244, v224, v225
  v_cvt_pk_bf16_f32 v245, v226, v227
  v_mfma_f32_32x32x16_bf16 a[0:15], v[80:83], v[168:171], a[0:15]
  ds_read_b128 v[224:227], v250 offset:26112
  ds_read_b128 v[228:231], v250 offset:30464
  s_waitcnt lgkmcnt(3)
  v_mfma_f32_4x4x4_16b_bf16 v[216:219], v[232:233], a[50:51], v[216:219]
  v_mfma_f32_32x32x16_bf16 a[0:15], v[84:87], v[172:175], a[0:15]
  ds_write_b128 v249, a[20:23] offset:53312
  v_mfma_f32_32x32x16_bf16 a[0:15], v[88:91], v[176:179], a[0:15]
  v_add_f32 v216, v216, v220
  v_add_f32 v217, v217, v221
  v_add_f32 v218, v218, v222
  v_add_f32 v219, v219, v223
  v_mfma_f32_32x32x16_bf16 a[0:15], v[64:67], a[208:211], a[0:15]
  ds_read_b128 a[64:67], v252 offset:2048
  ds_read_b128 a[68:71], v252 offset:3072
  v_mfma_f32_32x32x16_bf16 a[0:15], v[68:71], a[212:215], a[0:15]
  ds_write_b128 v249, a[24:27] offset:54400
  v_mfma_f32_32x32x16_bf16 a[0:15], v[56:59], a[144:147], a[0:15]
  s_waitcnt lgkmcnt(4)
  v_add_f32 v224, v224, v228
  v_add_f32 v225, v225, v229
  v_add_f32 v226, v226, v230
  v_add_f32 v227, v227, v231
  v_mfma_f32_32x32x16_bf16 a[0:15], v[60:63], a[148:151], a[0:15]
  buffer_load_dwordx2 a[62:63], v253, s[8:11], s74 offen offset:320
  s_waitcnt lgkmcnt(1)
  v_mfma_f32_32x32x16_bf16 a[0:15], v[48:51], a[64:67], a[0:15]
  ds_write_b128 v249, a[28:31] offset:55488
  v_mfma_f32_32x32x16_bf16 a[0:15], v[52:55], a[68:71], a[0:15]
  v_add_f32 v224, v224, v216
  v_add_f32 v225, v225, v217
  v_add_f32 v226, v226, v218
  v_add_f32 v227, v227, v219
  v_mfma_f32_32x32x16_bf16 a[16:31], v[92:95], v[196:199], a[32:47]
  ds_read_b128 v[216:219], v250 offset:34816
  ds_read_b128 v[220:223], v250 offset:39168
  v_mfma_f32_32x32x16_bf16 a[16:31], v[72:75], a[232:235], a[16:31]
  ds_write_b128 v249, a[0:3] offset:0
  v_mfma_f32_32x32x16_bf16 a[16:31], v[76:79], a[236:239], a[16:31]
  v_cvt_pk_bf16_f32 v246, v224, v225
  v_cvt_pk_bf16_f32 v247, v226, v227
  v_mfma_f32_32x32x16_bf16 a[16:31], v[80:83], v[184:187], a[16:31]
  ds_read_b128 v[224:227], v250 offset:43520
  ds_read_b128 v[228:231], v250 offset:47872
  s_waitcnt lgkmcnt(3)
  v_mfma_f32_4x4x4_16b_bf16 v[216:219], v[232:233], a[52:53], v[216:219]
  v_permlane32_swap_b32 v244, v246
  v_permlane32_swap_b32 v245, v247
  v_mfma_f32_32x32x16_bf16 a[16:31], v[84:87], v[188:191], a[16:31]
  ds_write_b128 v249, a[4:7] offset:1088
  v_mfma_f32_32x32x16_bf16 a[16:31], v[88:91], v[192:195], a[16:31]
  v_add_f32 v216, v216, v220
  v_add_f32 v217, v217, v221
  v_add_f32 v218, v218, v222
  v_add_f32 v219, v219, v223
  v_mfma_f32_32x32x16_bf16 a[16:31], v[64:67], a[224:227], a[16:31]
  ds_read_b128 a[64:67], v252 offset:4096
  ds_read_b128 a[68:71], v252 offset:5120
  buffer_load_dwordx2 a[48:49], v253, s[8:11], s75 offen offset:320
  v_mfma_f32_32x32x16_bf16 a[16:31], v[68:71], a[228:231], a[16:31]
  ds_write_b128 v249, a[8:11] offset:2176
  v_mfma_f32_32x32x16_bf16 a[16:31], v[56:59], a[152:155], a[16:31]
  s_waitcnt lgkmcnt(4)
  v_add_f32 v224, v224, v228
  v_add_f32 v225, v225, v229
  v_add_f32 v226, v226, v230
  v_add_f32 v227, v227, v231
  v_mfma_f32_32x32x16_bf16 a[16:31], v[60:63], a[156:159], a[16:31]
  buffer_store_dwordx4 v[244:247], v251, s[24:27], s74 offen offset:256 sc1
  s_waitcnt lgkmcnt(1)
  v_mfma_f32_32x32x16_bf16 a[16:31], v[48:51], a[64:67], a[16:31]
  ds_write_b128 v249, a[12:15] offset:3264
  v_mfma_f32_32x32x16_bf16 a[16:31], v[52:55], a[68:71], a[16:31]
  v_add_f32 v224, v224, v216
  v_add_f32 v225, v225, v217
  v_add_f32 v226, v226, v218
  v_add_f32 v227, v227, v219
  s_waitcnt lgkmcnt(0)
  v_mfma_f32_32x32x16_bf16 a[0:15], v[92:95], v[212:215], a[32:47]
  s_barrier
  ds_read_b128 v[216:219], v250 offset:52224
  ds_read_b128 v[220:223], v250 offset:56576
  v_mfma_f32_32x32x16_bf16 a[0:15], v[72:75], a[248:251], a[0:15]
  ds_write_b128 v249, a[16:19] offset:17408
  v_mfma_f32_32x32x16_bf16 a[0:15], v[76:79], a[252:255], a[0:15]
  v_cvt_pk_bf16_f32 v244, v224, v225
  v_cvt_pk_bf16_f32 v245, v226, v227
  v_mfma_f32_32x32x16_bf16 a[0:15], v[80:83], v[200:203], a[0:15]
  ds_read_b128 v[224:227], v250 offset:60928
  ds_read_b128 v[228:231], v250 offset:65280
  s_waitcnt lgkmcnt(3)
  v_mfma_f32_4x4x4_16b_bf16 v[216:219], v[232:233], a[54:55], v[216:219]
  v_mfma_f32_32x32x16_bf16 a[0:15], v[84:87], v[204:207], a[0:15]
  ds_write_b128 v249, a[20:23] offset:18496
  v_mfma_f32_32x32x16_bf16 a[0:15], v[88:91], v[208:211], a[0:15]
  v_add_f32 v216, v216, v220
  v_add_f32 v217, v217, v221
  v_add_f32 v218, v218, v222
  v_add_f32 v219, v219, v223
  v_mfma_f32_32x32x16_bf16 a[0:15], v[64:67], a[240:243], a[0:15]
  ds_read_b128 a[64:67], v252 offset:6144
  ds_read_b128 a[68:71], v252 offset:7168
  v_mfma_f32_32x32x16_bf16 a[0:15], v[68:71], a[244:247], a[0:15]
  ds_write_b128 v249, a[24:27] offset:19584
  v_mfma_f32_32x32x16_bf16 a[0:15], v[56:59], a[160:163], a[0:15]
  s_waitcnt lgkmcnt(4)
  v_add_f32 v224, v224, v228
  v_add_f32 v225, v225, v229
  v_add_f32 v226, v226, v230
  v_add_f32 v227, v227, v231
  v_mfma_f32_32x32x16_bf16 a[0:15], v[60:63], a[164:167], a[0:15]
  buffer_load_dwordx2 a[50:51], v253, s[8:11], s76 offen offset:320
  s_waitcnt lgkmcnt(1)
  v_mfma_f32_32x32x16_bf16 a[0:15], v[48:51], a[64:67], a[0:15]
  ds_write_b128 v249, a[28:31] offset:20672
  v_mfma_f32_32x32x16_bf16 a[0:15], v[52:55], a[68:71], a[0:15]
  v_add_f32 v224, v224, v216
  v_add_f32 v225, v225, v217
  v_add_f32 v226, v226, v218
  v_add_f32 v227, v227, v219
  v_mfma_f32_32x32x16_bf16 a[16:31], v[92:95], a[100:103], a[32:47]
  ds_read_b128 v[216:219], v250 offset:0
  ds_read_b128 v[220:223], v250 offset:4352
  v_mfma_f32_32x32x16_bf16 a[16:31], v[72:75], a[80:83], a[16:31]
  ds_write_b128 v249, a[0:3] offset:34816
  v_mfma_f32_32x32x16_bf16 a[16:31], v[76:79], a[84:87], a[16:31]
  v_cvt_pk_bf16_f32 v246, v224, v225
  v_cvt_pk_bf16_f32 v247, v226, v227
  v_mfma_f32_32x32x16_bf16 a[16:31], v[80:83], a[88:91], a[16:31]
  ds_read_b128 v[224:227], v250 offset:8704
  ds_read_b128 v[228:231], v250 offset:13056
  s_waitcnt vmcnt(8) lgkmcnt(3)
  v_mfma_f32_4x4x4_16b_bf16 v[216:219], v[232:233], a[56:57], v[216:219]
  v_permlane32_swap_b32 v244, v246
  v_permlane32_swap_b32 v245, v247
  v_mfma_f32_32x32x16_bf16 a[16:31], v[84:87], a[92:95], a[16:31]
  ds_write_b128 v249, a[4:7] offset:35904
  v_mfma_f32_32x32x16_bf16 a[16:31], v[88:91], a[96:99], a[16:31]
  v_add_f32 v216, v216, v220
  v_add_f32 v217, v217, v221
  v_add_f32 v218, v218, v222
  v_add_f32 v219, v219, v223
  v_mfma_f32_32x32x16_bf16 a[16:31], v[64:67], a[72:75], a[16:31]
  ds_read_b128 a[64:67], v252 offset:8192
  ds_read_b128 a[68:71], v252 offset:9216
  v_mfma_f32_32x32x16_bf16 a[16:31], v[68:71], a[76:79], a[16:31]
  ds_write_b128 v249, a[8:11] offset:36992
  v_mfma_f32_32x32x16_bf16 a[16:31], v[56:59], a[168:171], a[16:31]
  s_waitcnt lgkmcnt(4)
  v_add_f32 v224, v224, v228
  v_add_f32 v225, v225, v229
  v_add_f32 v226, v226, v230
  v_add_f32 v227, v227, v231
  v_mfma_f32_32x32x16_bf16 a[16:31], v[60:63], a[172:175], a[16:31]
  buffer_store_dwordx4 v[244:247], v255, s[24:27], s70 offen offset:256 sc1
  s_waitcnt lgkmcnt(1)
  v_mfma_f32_32x32x16_bf16 a[16:31], v[48:51], a[64:67], a[16:31]
  ds_write_b128 v249, a[12:15] offset:38080
  v_mfma_f32_32x32x16_bf16 a[16:31], v[52:55], a[68:71], a[16:31]
  v_add_f32 v224, v224, v216
  v_add_f32 v225, v225, v217
  v_add_f32 v226, v226, v218
  v_add_f32 v227, v227, v219
  s_waitcnt lgkmcnt(0)
  v_mfma_f32_32x32x16_bf16 a[0:15], v[92:95], a[116:119], a[32:47]
  s_barrier
  ds_read_b128 v[216:219], v250 offset:17408
  ds_read_b128 v[220:223], v250 offset:21760
  v_mfma_f32_32x32x16_bf16 a[0:15], v[72:75], v[128:131], a[0:15]
  ds_write_b128 v249, a[16:19] offset:52224
  v_mfma_f32_32x32x16_bf16 a[0:15], v[76:79], v[132:135], a[0:15]
  v_cvt_pk_bf16_f32 v244, v224, v225
  v_cvt_pk_bf16_f32 v245, v226, v227
  v_mfma_f32_32x32x16_bf16 a[0:15], v[80:83], a[104:107], a[0:15]
  ds_read_b128 v[224:227], v250 offset:26112
  ds_read_b128 v[228:231], v250 offset:30464
  s_waitcnt vmcnt(7) lgkmcnt(3)
  v_mfma_f32_4x4x4_16b_bf16 v[216:219], v[232:233], a[58:59], v[216:219]
  v_mfma_f32_32x32x16_bf16 a[0:15], v[84:87], a[108:111], a[0:15]
  ds_write_b128 v249, a[20:23] offset:53312
  v_mfma_f32_32x32x16_bf16 a[0:15], v[88:91], a[112:115], a[0:15]
  v_add_f32 v216, v216, v220
  v_add_f32 v217, v217, v221
  v_add_f32 v218, v218, v222
  v_add_f32 v219, v219, v223
  v_mfma_f32_32x32x16_bf16 a[0:15], v[64:67], v[120:123], a[0:15]
  ds_read_b128 a[64:67], v252 offset:10240
  ds_read_b128 a[68:71], v252 offset:11264
  ds_read_b128 v[96:99], v250 offset:34816
  ds_read_b128 v[100:103], v250 offset:39168
  v_mfma_f32_32x32x16_bf16 a[0:15], v[68:71], v[124:127], a[0:15]
  ds_write_b128 v249, a[24:27] offset:54400
  v_mfma_f32_32x32x16_bf16 a[0:15], v[56:59], a[176:179], a[0:15]
  s_waitcnt lgkmcnt(6)
  v_add_f32 v224, v224, v228
  v_add_f32 v225, v225, v229
  v_add_f32 v226, v226, v230
  v_add_f32 v227, v227, v231
  v_mfma_f32_32x32x16_bf16 a[0:15], v[60:63], a[180:183], a[0:15]
  ds_read_b128 v[104:107], v250 offset:43520
  ds_read_b128 v[108:111], v250 offset:47872
  v_add_f32 v224, v224, v216
  v_add_f32 v225, v225, v217
  v_add_f32 v226, v226, v218
  v_add_f32 v227, v227, v219
  s_waitcnt vmcnt(6) lgkmcnt(3)
  v_mfma_f32_4x4x4_16b_bf16 v[96:99], v[232:233], a[60:61], v[96:99]
  v_mfma_f32_32x32x16_bf16 a[0:15], v[48:51], a[64:67], a[0:15]
  ds_write_b128 v249, a[28:31] offset:55488
  v_mfma_f32_32x32x16_bf16 a[0:15], v[52:55], a[68:71], a[0:15]
  v_cvt_pk_bf16_f32 v246, v224, v225
  v_cvt_pk_bf16_f32 v247, v226, v227
  v_add_f32 v96, v96, v100
  v_add_f32 v97, v97, v101
  v_add_f32 v98, v98, v102
  v_add_f32 v99, v99, v103
  v_mfma_f32_32x32x16_bf16 a[16:31], v[92:95], a[132:135], a[32:47]
  ds_read_b128 a[64:67], v252 offset:12288
  ds_read_b128 a[68:71], v252 offset:13312
  v_permlane32_swap_b32 v244, v246
  v_permlane32_swap_b32 v245, v247
  v_mfma_f32_32x32x16_bf16 a[16:31], v[72:75], v[144:147], a[16:31]
  ds_write_b128 v249, a[0:3] offset:0
  v_mfma_f32_32x32x16_bf16 a[16:31], v[76:79], v[148:151], a[16:31]
  s_waitcnt lgkmcnt(4)
  v_add_f32 v104, v104, v108
  v_add_f32 v105, v105, v109
  v_add_f32 v106, v106, v110
  v_add_f32 v107, v107, v111
  v_mfma_f32_32x32x16_bf16 a[16:31], v[80:83], a[120:123], a[16:31]
  ds_write_b128 v249, a[4:7] offset:1088
  v_mfma_f32_32x32x16_bf16 a[16:31], v[84:87], a[124:127], a[16:31]
  buffer_store_dwordx4 v[244:247], v251, s[24:27], s71 offen offset:320 sc1
  v_add_f32 v104, v104, v96
  v_add_f32 v105, v105, v97
  v_add_f32 v106, v106, v98
  v_add_f32 v107, v107, v99
  v_mfma_f32_32x32x16_bf16 a[16:31], v[88:91], a[128:131], a[16:31]
  ds_write_b128 v249, a[8:11] offset:2176
  v_mfma_f32_32x32x16_bf16 a[16:31], v[64:67], v[136:139], a[16:31]
  v_cvt_pk_bf16_f32 v32, v104, v105
  v_cvt_pk_bf16_f32 v33, v106, v107
  v_mfma_f32_32x32x16_bf16 a[16:31], v[68:71], v[140:143], a[16:31]
  ds_write_b128 v249, a[12:15] offset:3264
  v_mfma_f32_32x32x16_bf16 a[16:31], v[56:59], a[184:187], a[16:31]
  v_mfma_f32_32x32x16_bf16 a[16:31], v[60:63], a[188:191], a[16:31]
  s_waitcnt lgkmcnt(0)
  s_barrier
  ds_read_b128 v[216:219], v250 offset:52224
  ds_read_b128 v[220:223], v250 offset:56576
  ds_read_b128 v[224:227], v250 offset:60928
  ds_read_b128 v[228:231], v250 offset:65280
  v_mfma_f32_32x32x16_bf16 a[16:31], v[48:51], a[64:67], a[16:31]
  ds_read_b128 v[0:3], v250 offset:0
  ds_read_b128 v[4:7], v250 offset:4352
  ds_read_b128 v[8:11], v250 offset:8704
  ds_read_b128 v[12:15], v250 offset:13056
  v_mfma_f32_32x32x16_bf16 a[16:31], v[52:55], a[68:71], a[16:31]
  s_waitcnt vmcnt(2) lgkmcnt(3)
  v_mfma_f32_4x4x4_16b_bf16 v[216:219], v[232:233], a[62:63], v[216:219]
  v_mfma_f32_4x4x4_16b_bf16 v[236:239], v[232:233], a[50:51], 0
  s_nop 8
  ds_write_b128 v249, a[16:19] offset:17408
  v_add_f32 v224, v224, v228
  v_add_f32 v225, v225, v229
  v_add_f32 v226, v226, v230
  v_add_f32 v227, v227, v231
  ds_write_b128 v249, a[20:23] offset:18496
  v_mfma_f32_4x4x4_16b_bf16 v[0:3], v[232:233], a[48:49], v[0:3]
  v_add_f32 v216, v216, v220
  v_add_f32 v217, v217, v221
  v_add_f32 v218, v218, v222
  v_add_f32 v219, v219, v223
  ds_write_b128 v249, a[24:27] offset:19584
  v_add_f32 v216, v216, v224
  v_add_f32 v217, v217, v225
  v_add_f32 v218, v218, v226
  v_add_f32 v219, v219, v227
  v_cvt_pk_bf16_f32 v34, v216, v217
  v_cvt_pk_bf16_f32 v35, v218, v219
  s_waitcnt lgkmcnt(3)
  v_add_f32 v8, v8, v12
  v_add_f32 v9, v9, v13
  v_add_f32 v10, v10, v14
  v_add_f32 v11, v11, v15
  ds_write_b128 v249, a[28:31] offset:20672
  v_permlane32_swap_b32 v32, v34
  v_permlane32_swap_b32 v33, v35
  buffer_store_dwordx4 v[32:35], v251, s[24:27], s73 offen offset:320 sc1
  v_add_f32 v0, v0, v4
  v_add_f32 v1, v1, v5
  v_add_f32 v2, v2, v6
  v_add_f32 v3, v3, v7
  v_add_f32 v0, v0, v8
  v_add_f32 v1, v1, v9
  v_add_f32 v2, v2, v10
  v_add_f32 v3, v3, v11
  v_cvt_pk_bf16_f32 v36, v0, v1
  v_cvt_pk_bf16_f32 v37, v2, v3
  s_waitcnt lgkmcnt(0)
  s_barrier
  ds_read_b128 v[16:19], v250 offset:17408
  ds_read_b128 v[20:23], v250 offset:21760
  ds_read_b128 v[24:27], v250 offset:26112
  ds_read_b128 v[28:31], v250 offset:30464
  s_waitcnt lgkmcnt(3)
  v_pk_add_f32 v[16:17], v[16:17], v[236:237]
  v_pk_add_f32 v[18:19], v[18:19], v[238:239]
  s_waitcnt lgkmcnt(2)
  v_pk_add_f32 v[16:17], v[16:17], v[20:21]
  v_pk_add_f32 v[18:19], v[18:19], v[22:23]
  s_waitcnt lgkmcnt(0)
  v_pk_add_f32 v[24:25], v[24:25], v[28:29]
  v_pk_add_f32 v[26:27], v[26:27], v[30:31]
  v_pk_add_f32 v[16:17], v[16:17], v[24:25]
  v_pk_add_f32 v[18:19], v[18:19], v[26:27]
  v_cvt_pk_bf16_f32 v38, v16, v17
  v_cvt_pk_bf16_f32 v39, v18, v19
  s_nop 0
  v_permlane32_swap_b32 v36, v38
  v_permlane32_swap_b32 v37, v39
  buffer_store_dwordx4 v[36:39], v251, s[24:27], s75 offen offset:320 sc1
  s_endpgm
L_slow2:
  s_mov_b32 s5, 262144
L_slow2b:
  s_add_u32 s47, s44, 0
  buffer_load_dwordx4 v[48:51], v248, s[20:23], s47 offen sc1
  s_add_u32 s47, s44, 6144
  buffer_load_dwordx4 v[52:55], v248, s[20:23], s47 offen sc1
  s_add_u32 s47, s44, 12288
  buffer_load_dwordx4 v[56:59], v248, s[20:23], s47 offen sc1
  s_add_u32 s47, s44, 18432
  buffer_load_dwordx4 v[60:63], v248, s[20:23], s47 offen sc1
  s_waitcnt vmcnt(0)
  v_min3_f32 v36, v49, v51, v53
  v_min3_f32 v37, v55, v57, v59
  v_min3_f32 v36, v36, v61, v63
  v_min_f32 v36, v36, v37
  v_cmp_neq_f32 vcc, s49, v36
  s_sub_u32 s5, s5, 1
  s_cbranch_scc1 L_back2
  s_cbranch_vccnz L_slow2b
  s_branch L_back2
L_slow3:
  s_mov_b32 s5, 262144
L_slow3b:
  buffer_load_dword v96, off, s[32:35], s45 offset:192 sc1
  s_waitcnt vmcnt(0)
  v_readfirstlane_b32 s4, v96
  s_sub_u32 s5, s5, 1
  s_cbranch_scc1 L_back3
  s_cmp_lt_u32 s4, 6
  s_cbranch_scc1 L_slow3b
  s_branch L_back3
L_slow0:
  s_mov_b32 s5, 262144
L_slow0b:
  s_sleep 2
  buffer_load_dword v253, off, s[32:35], 0 offset:128 sc1
  s_waitcnt vmcnt(0)
  v_readfirstlane_b32 s4, v253
  s_sub_u32 s5, s5, 1
  s_cbranch_scc1 L_back0
  s_cmp_lt_u32 s4, 0x800
  s_cbranch_scc1 L_slow0b
  s_branch L_back0
L_slow9:
  s_mov_b32 s5, 262144
L_slow9b:
  s_sleep 2
  buffer_load_dword v253, off, s[32:35], 0 offset:128 sc1
  s_waitcnt vmcnt(0)
  v_readfirstlane_b32 s4, v253
  s_sub_u32 s5, s5, 1
  s_cbranch_scc1 L_back9
  s_cmp_lt_u32 s4, 0x818
  s_cbranch_scc1 L_slow9b
  s_branch L_back9
L_slow1:
  s_mov_b32 s5, 262144
L_slow1b:
  s_sleep 2
  buffer_load_dword v253, off, s[32:35], 0 sc1
  s_waitcnt vmcnt(0)
  v_readfirstlane_b32 s4, v253
  s_sub_u32 s5, s5, 1
  s_cbranch_scc1 L_back1
  s_cmp_lt_u32 s4, 29
  s_cbranch_scc1 L_slow1b
  s_branch L_back1
L_helper:
  s_cmp_ge_u32 s2, 256
  s_cbranch_scc1 L_endw
  s_load_dwordx2 s[24:25], s[0:1], 24
  s_load_dwordx2 s[44:45], s[0:1], 40
  s_mov_b32 s26, 294912
  s_mov_b32 s27, 0x20000
  s_sub_u32 s40, s2, 224
  s_waitcnt lgkmcnt(0)
  s_cmp_ge_u32 s40, 24
  s_cbranch_scc1 L_hp
  s_mul_i32 s41, s40, 43
  s_lshr_b32 s41, s41, 8
  s_mul_i32 s42, s41, 6
  s_sub_u32 s42, s40, s42
  s_mul_i32 s43, s41, 192
  s_lshr_b32 s46, s42, 1
  s_lshl_b32 s46, s46, 6
  s_add_u32 s43, s43, s46
  s_and_b32 s46, s42, 1
  s_lshl_b32 s46, s46, 4
  s_add_u32 s43, s43, s46
  v_lshrrev_b32 v10, 5, v0
  v_and_b32 v11, 31, v0
  v_and_b32 v13, 15, v11
  v_lshrrev_b32 v14, 4, v11
  v_lshl_add_u32 v13, v14, 5, v13
  v_lshlrev_b32 v13, 1, v13
  s_movk_i32 s47, 3072
  v_mad_u32_u24 v13, v10, s47, v13
  s_mul_i32 s47, s3, 73728
  s_lshl_b32 s48, s43, 1
  s_add_u32 s47, s47, s48
  buffer_load_ushort v40, v13, s[16:19], s47 offen offset:0
  buffer_load_ushort v41, v13, s[16:19], s47 offen offset:1536
  s_add_u32 s47, s47, 6144
  buffer_load_ushort v42, v13, s[16:19], s47 offen offset:0
  buffer_load_ushort v43, v13, s[16:19], s47 offen offset:1536
  s_add_u32 s47, s47, 6144
  buffer_load_ushort v44, v13, s[16:19], s47 offen offset:0
  buffer_load_ushort v45, v13, s[16:19], s47 offen offset:1536
  s_add_u32 s47, s47, 6144
  buffer_load_ushort v46, v13, s[16:19], s47 offen offset:0
  buffer_load_ushort v47, v13, s[16:19], s47 offen offset:1536
  s_add_u32 s47, s47, 6144
  buffer_load_ushort v48, v13, s[16:19], s47 offen offset:0
  buffer_load_ushort v49, v13, s[16:19], s47 offen offset:1536
  s_add_u32 s47, s47, 6144
  buffer_load_ushort v50, v13, s[16:19], s47 offen offset:0
  buffer_load_ushort v51, v13, s[16:19], s47 offen offset:1536
  s_add_u32 s47, s47, 6144
  buffer_load_ushort v52, v13, s[16:19], s47 offen offset:0
  buffer_load_ushort v53, v13, s[16:19], s47 offen offset:1536
  s_add_u32 s47, s47, 6144
  buffer_load_ushort v54, v13, s[16:19], s47 offen offset:0
  buffer_load_ushort v55, v13, s[16:19], s47 offen offset:1536
  s_add_u32 s47, s47, 6144
  buffer_load_ushort v56, v13, s[16:19], s47 offen offset:0
  buffer_load_ushort v57, v13, s[16:19], s47 offen offset:1536
  s_add_u32 s47, s47, 6144
  buffer_load_ushort v58, v13, s[16:19], s47 offen offset:0
  buffer_load_ushort v59, v13, s[16:19], s47 offen offset:1536
  s_add_u32 s47, s47, 6144
  buffer_load_ushort v60, v13, s[16:19], s47 offen offset:0
  buffer_load_ushort v61, v13, s[16:19], s47 offen offset:1536
  s_add_u32 s47, s47, 6144
  buffer_load_ushort v62, v13, s[16:19], s47 offen offset:0
  buffer_load_ushort v63, v13, s[16:19], s47 offen offset:1536
  s_add_u32 s47, s47, 6144
  s_movk_i32 s46, 1536
  v_lshlrev_b32 v12, 1, v11
  v_mad_u32_u24 v12, v10, s46, v12
  s_lshr_b32 s46, s3, 1
  s_lshl_b32 s46, s46, 5
  s_and_b32 s48, s3, 1
  s_lshl_b32 s48, s48, 3
  s_add_u32 s46, s46, s48
  s_add_u32 s46, s46, s43
  s_mul_i32 s46, s46, 384
  buffer_load_ushort v16, v12, s[24:27], s46 offen offset:0
  buffer_load_ushort v17, v12, s[24:27], s46 offen offset:384
  buffer_load_ushort v18, v12, s[24:27], s46 offen offset:768
  buffer_load_ushort v19, v12, s[24:27], s46 offen offset:1152
  buffer_load_ushort v20, v12, s[24:27], s46 offen offset:64
  buffer_load_ushort v21, v12, s[24:27], s46 offen offset:448
  buffer_load_ushort v22, v12, s[24:27], s46 offen offset:832
  buffer_load_ushort v23, v12, s[24:27], s46 offen offset:1216
  s_mul_i32 s46, s40, 12288
  s_mul_i32 s48, s3, 3072
  s_add_u32 s46, s46, s48
  s_waitcnt vmcnt(30)
  v_lshl_or_b32 v64, v41, 16, v40
  s_waitcnt vmcnt(28)
  v_lshl_or_b32 v65, v43, 16, v42
  s_waitcnt vmcnt(26)
  v_lshl_or_b32 v66, v45, 16, v44
  s_waitcnt vmcnt(24)
  v_lshl_or_b32 v67, v47, 16, v46
  buffer_store_dwordx4 v[64:67], v248, s[20:23], s46 offen offset:0 sc1
  s_waitcnt vmcnt(23)
  v_lshl_or_b32 v68, v49, 16, v48
  s_waitcnt vmcnt(21)
  v_lshl_or_b32 v69, v51, 16, v50
  s_waitcnt vmcnt(19)
  v_lshl_or_b32 v70, v53, 16, v52
  s_waitcnt vmcnt(17)
  v_lshl_or_b32 v71, v55, 16, v54
  buffer_store_dwordx4 v[68:71], v248, s[20:23], s46 offen offset:1024 sc1
  s_waitcnt vmcnt(16)
  v_lshl_or_b32 v72, v57, 16, v56
  s_waitcnt vmcnt(14)
  v_lshl_or_b32 v73, v59, 16, v58
  s_waitcnt vmcnt(12)
  v_lshl_or_b32 v74, v61, 16, v60
  s_waitcnt vmcnt(10)
  v_lshl_or_b32 v75, v63, 16, v62
  buffer_store_dwordx4 v[72:75], v248, s[20:23], s46 offen offset:2048 sc1
  s_waitcnt vmcnt(0)
  s_barrier
  s_cmp_lg_u32 s3, 0
  s_cbranch_scc1 L_h2
  s_cmp_ge_u32 s42, 2
  s_cselect_b32 s46, 1, 0x101
  v_mov_b32 v4, s46
  s_mov_b64 exec, 1
  buffer_atomic_add v4, off, s[32:35], 0 offset:128 sc1
  s_mov_b64 exec, -1
L_h2:
  s_mul_i32 s46, s41, 49152
  s_lshl_b32 s48, s42, 12
  s_add_u32 s46, s46, s48
  s_lshl_b32 s48, s3, 10
  s_add_u32 s46, s46, s48
  s_add_u32 s46, s46, 294912
  v_lshlrev_b32 v16, 16, v16
  v_lshlrev_b32 v17, 16, v17
  v_lshlrev_b32 v18, 16, v18
  v_lshlrev_b32 v19, 16, v19
  buffer_store_dwordx4 v[16:19], v248, s[20:23], s46 offen sc1
  s_add_u32 s46, s46, 24576
  v_lshlrev_b32 v20, 16, v20
  v_lshlrev_b32 v21, 16, v21
  v_lshlrev_b32 v22, 16, v22
  v_lshlrev_b32 v23, 16, v23
  buffer_store_dwordx4 v[20:23], v248, s[20:23], s46 offen sc1
  s_add_u32 s46, s46, 24576
  s_waitcnt vmcnt(0)
  s_barrier
  s_cmp_lg_u32 s3, 0
  s_cbranch_scc1 L_h3
  v_mov_b32 v4, 1
  s_mov_b64 exec, 1
  buffer_atomic_add v4, off, s[32:35], 0 sc1
  s_mov_b64 exec, -1
L_h3:
  s_load_dwordx2 s[28:29], s[0:1], 32
  s_mov_b32 s30, 1536
  s_mov_b32 s31, 0x20000
  s_lshr_b32 s46, s3, 1
  s_lshl_b32 s47, s46, 5
  s_add_u32 s47, s47, s43
  s_mul_i32 s47, s47, 384
  s_and_b32 s48, s3, 1
  s_lshl_b32 s49, s48, 7
  s_add_u32 s47, s47, s49
  s_add_u32 s47, s47, 128
  s_add_u32 s49, s47, 3072
  buffer_load_ushort v64, v12, s[24:27], s47 offen offset:0
  buffer_load_ushort v65, v12, s[24:27], s47 offen offset:384
  buffer_load_ushort v66, v12, s[24:27], s47 offen offset:768
  buffer_load_ushort v67, v12, s[24:27], s47 offen offset:1152
  buffer_load_ushort v68, v12, s[24:27], s49 offen offset:0
  buffer_load_ushort v69, v12, s[24:27], s49 offen offset:384
  buffer_load_ushort v70, v12, s[24:27], s49 offen offset:768
  buffer_load_ushort v71, v12, s[24:27], s49 offen offset:1152
  buffer_load_ushort v72, v12, s[24:27], s47 offen offset:64
  buffer_load_ushort v73, v12, s[24:27], s47 offen offset:448
  buffer_load_ushort v74, v12, s[24:27], s47 offen offset:832
  buffer_load_ushort v75, v12, s[24:27], s47 offen offset:1216
  buffer_load_ushort v76, v12, s[24:27], s49 offen offset:64
  buffer_load_ushort v77, v12, s[24:27], s49 offen offset:448
  buffer_load_ushort v78, v12, s[24:27], s49 offen offset:832
  buffer_load_ushort v79, v12, s[24:27], s49 offen offset:1216
  s_lshl_b32 s52, s42, 1
  s_add_u32 s52, s52, s46
  s_lshl_b32 s53, s41, 2
  s_lshl_b32 s48, s48, 1
  s_add_u32 s53, s53, s48
  s_mul_i32 s53, s53, 12
  s_add_u32 s53, s53, s52
  s_lshl_b32 s53, s53, 10
  s_add_u32 s53, s53, 491520
  s_lshl_b32 s52, s52, 6
  s_lshl_b32 s54, s41, 10
  s_add_u32 s52, s52, s54
  s_add_u32 s52, s52, 4096
  v_lshrrev_b32 v29, 9, v248
  v_lshl_add_u32 v80, v29, 4, s52
  v_bfe_u32 v254, v248, 8, 1
  v_bfe_u32 v253, v248, 4, 3
  v_lshlrev_b32 v254, 5, v254
  v_bfe_u32 v255, v248, 7, 1
  v_lshl_add_u32 v254, v253, 2, v254
  v_lshrrev_b32 v253, 9, v248
  v_lshl_add_u32 v254, v255, 6, v254
  s_mul_i32 s45, s3, 384
  v_lshl_add_u32 v253, v253, 7, v254
  s_waitcnt lgkmcnt(0)
  buffer_load_dword v255, v254, s[28:31], s45 offen offset:256
  buffer_load_dword v253, v253, s[28:31], s45 offen
  v_lshrrev_b32 v31, 1, v248
  s_mul_i32 s44, s3, 1536
  s_add_u32 s44, s44, 888832
  s_lshl_b32 s47, s3, 10
  s_add_u32 s46, s47, 913408
  v_lshrrev_b32 v28, 4, v248
  v_bfe_u32 v30, v248, 4, 5
  s_add_u32 s47, s47, 4096
  v_lshl_add_u32 v32, v28, 3, s47
  v_lshl_add_u32 v33, v30, 3, s47
  s_mov_b32 s48, 0x2291afa4
  s_mov_b32 s49, 0x42600000
  v_mov_b32 v29, 0x358637bd
  v_mov_b32 v30, 0x31088e99
  s_lshl_b32 s47, s3, 2
  s_add_u32 s47, s47, 768
  v_mov_b32 v28, s47
  v_mov_b32 v22, 768
  v_mov_b32 v23, 0x3aaaaaab
  s_waitcnt vmcnt(0)
  v_and_b32 v25, 0xffff0000, v253
  v_lshlrev_b32 v24, 16, v253
  v_and_b32 v27, 0xffff0000, v255
  v_lshlrev_b32 v26, 16, v255
  v_lshlrev_b32 v64, 16, v64
  v_lshlrev_b32 v65, 16, v65
  v_lshlrev_b32 v66, 16, v66
  v_lshlrev_b32 v67, 16, v67
  v_lshlrev_b32 v68, 16, v68
  v_lshlrev_b32 v69, 16, v69
  v_lshlrev_b32 v70, 16, v70
  v_lshlrev_b32 v71, 16, v71
  v_lshlrev_b32 v72, 16, v72
  v_lshlrev_b32 v73, 16, v73
  v_lshlrev_b32 v74, 16, v74
  v_lshlrev_b32 v75, 16, v75
  v_lshlrev_b32 v76, 16, v76
  v_lshlrev_b32 v77, 16, v77
  v_lshlrev_b32 v78, 16, v78
  v_lshlrev_b32 v79, 16, v79
  s_waitcnt vmcnt(0) lgkmcnt(0)
  s_mov_b32 s5, 262144
L_s0:
  s_sleep 8
  buffer_load_dword v36, off, s[32:35], 0 sc1
  s_waitcnt vmcnt(0)
  v_cmp_gt_u32 vcc, 29, v36
  s_sub_u32 s5, s5, 1
  s_cbranch_scc1 L_s0_x
  s_cbranch_vccnz L_s0
L_s0_x:
  s_mov_b32 s5, 262144
L_s2:
  s_sleep 8
  buffer_load_dwordx2 v[8:9], v31, s[20:23], s46 offen sc1
  buffer_load_dwordx2 v[10:11], v31, s[20:23], s46 offen offset:512 sc1
  s_waitcnt vmcnt(0)
  v_max3_u32 v36, v10, v9, v8
  v_max_u32 v36, v36, v11
  v_cmp_eq_u32 vcc, -1, v36
  s_sub_u32 s5, s5, 1
  s_cbranch_scc1 L_s2_x
  s_cbranch_vccnz L_s2
L_s2_x:
  s_mov_b32 s5, 262144
L_s1:
  s_sleep 1
  s_add_u32 s47, s44, 0
  buffer_load_dwordx4 v[48:51], v248, s[20:23], s47 offen sc1
  s_add_u32 s47, s44, 6144
  buffer_load_dwordx4 v[52:55], v248, s[20:23], s47 offen sc1
  s_add_u32 s47, s44, 12288
  buffer_load_dwordx4 v[56:59], v248, s[20:23], s47 offen sc1
  s_add_u32 s47, s44, 18432
  buffer_load_dwordx4 v[60:63], v248, s[20:23], s47 offen sc1
  s_waitcnt vmcnt(1)
  v_min3_f32 v37, v55, v57, v59
  s_waitcnt vmcnt(0)
  v_min3_f32 v37, v37, v61, v63
  v_min3_f32 v36, v49, v51, v53
  v_min_f32 v36, v36, v37
  v_cmp_neq_f32 vcc, s49, v36
  s_sub_u32 s5, s5, 1
  s_cbranch_scc1 L_s1_x
  s_cbranch_vccnz L_s1
L_s1_x:
  v_add_f32 v48, v48, v52
  v_add_f32 v56, v56, v60
  v_add_f32 v50, v50, v54
  v_add_f32 v58, v58, v62
  v_add_f32 v16, v48, v56
  v_add_f32 v18, v50, v58
  v_fma_f32 v16, v16, s48, v29
  v_fma_f32 v18, v18, s48, v29
  v_sqrt_f32 v16, v16
  v_sqrt_f32 v18, v18
  s_nop 0
  v_add_f32 v20, v16, v18
  v_mul_f32 v24, v24, v16
  v_mul_f32 v25, v25, v18
  v_add_f32 v8, v8, v10
  v_add_f32 v10, v9, v11
  v_mov_b32 v9, v8
  v_mov_b32 v11, v10
  s_nop 0
  v_permlane32_swap_b32 v8, v9
  v_permlane32_swap_b32 v10, v11
  v_add_f32 v8, v8, v9
  v_add_f32 v10, v10, v11
  v_fma_f32 v8, v8, s48, v29
  v_fma_f32 v10, v10, s48, v29
  v_sqrt_f32 v8, v8
  v_sqrt_f32 v10, v10
  v_fma_f32 v20, v8, 0.5, v20
  v_fma_f32 v20, v10, 0.5, v20
  v_mul_f32 v26, v26, v8
  s_nop 0
  v_add_f32_dpp v20, v20, v20 quad_perm:[1,0,3,2] row_mask:0xf bank_mask:0xf
  v_mul_f32 v27, v27, v10
  s_nop 0
  v_add_f32_dpp v20, v20, v20 quad_perm:[2,3,0,1] row_mask:0xf bank_mask:0xf
  s_nop 1
  v_add_f32_dpp v20, v20, v20 row_half_mirror row_mask:0xf bank_mask:0xf
  s_nop 1
  v_add_f32_dpp v20, v20, v20 row_ror:8 row_mask:0xf bank_mask:0xf
  v_mov_b32 v21, v20
  s_nop 1
  v_permlane16_swap_b32 v20, v21
  v_add_f32 v20, v20, v21
  v_mov_b32 v21, v20
  s_nop 1
  v_permlane32_swap_b32 v20, v21
  v_add_f32 v20, v20, v21
  ds_write_b32 v28, v20
  s_waitcnt lgkmcnt(0)
  s_barrier
  ds_read_b128 v[0:3], v22
  s_waitcnt lgkmcnt(0)
  v_add_f32 v0, v0, v1
  v_add_f32 v2, v2, v3
  v_add_f32 v0, v0, v2
  v_fma_f32 v0, v0, v23, v29
  v_rcp_f32 v0, v0
  s_nop 0
  v_mul_f32 v0, v0, v30
  v_fma_f32 v26, v26, v0, v30
  v_fma_f32 v27, v27, v0, v30
  ds_write_b64 v33, v[26:27] offset:512
  v_fma_f32 v24, v24, v0, v30
  v_fma_f32 v25, v25, v0, v30
  ds_write_b64 v32, v[24:25]
  s_waitcnt lgkmcnt(0)
  s_barrier
  ds_read_b128 v[48:51], v80 offset:0
  ds_read_b128 v[52:55], v80 offset:32
  s_waitcnt lgkmcnt(1)
  v_mul_f32 v64, v64, v48
  v_mul_f32 v65, v65, v49
  v_mul_f32 v66, v66, v50
  v_mul_f32 v67, v67, v51
  s_waitcnt lgkmcnt(0)
  v_mul_f32 v68, v68, v52
  v_mul_f32 v69, v69, v53
  v_mul_f32 v70, v70, v54
  v_mul_f32 v71, v71, v55
  v_cvt_pk_bf16_f32 v64, v64, v65
  v_cvt_pk_bf16_f32 v65, v66, v67
  v_cvt_pk_bf16_f32 v66, v68, v69
  v_cvt_pk_bf16_f32 v67, v70, v71
  buffer_store_dwordx4 v[64:67], v248, s[20:23], s53 offen sc1
  s_add_u32 s53, s53, 12288
  v_mul_f32 v72, v72, v48
  v_mul_f32 v73, v73, v49
  v_mul_f32 v74, v74, v50
  v_mul_f32 v75, v75, v51
  v_mul_f32 v76, v76, v52
  v_mul_f32 v77, v77, v53
  v_mul_f32 v78, v78, v54
  v_mul_f32 v79, v79, v55
  v_cvt_pk_bf16_f32 v72, v72, v73
  v_cvt_pk_bf16_f32 v73, v74, v75
  v_cvt_pk_bf16_f32 v74, v76, v77
  v_cvt_pk_bf16_f32 v75, v78, v79
  buffer_store_dwordx4 v[72:75], v248, s[20:23], s53 offen sc1
  s_add_u32 s53, s53, 12288
  s_waitcnt vmcnt(0)
  s_barrier
  s_cmp_lg_u32 s3, 0
  s_cbranch_scc1 L_end
  s_lshl_b32 s45, s41, 2
  v_mov_b32 v4, 1
  s_mov_b64 exec, 1
  buffer_atomic_add v4, off, s[32:35], s45 offset:192 sc1
  v_mov_b32 v5, 0
  s_branch L_hst
L_hp:
  s_getpc_b64 s[46:47]
L_pc:
  s_sub_u32 s46, s46, L_pc-standalone__modern_conv_block_convnext_v2__vision_kernel
  s_subb_u32 s47, s47, 0
  s_lshl_b32 s48, s3, 10
  v_add_u32 v2, s48, v248
  s_mov_b32 s48, (L_helper-standalone__modern_conv_block_convnext_v2__vision_kernel)/4096
L_pf:
  global_load_dwordx4 v[252:255], v2, s[46:47]
  v_add_u32 v2, 4096, v2
  s_sub_u32 s48, s48, 1
  s_cmp_lg_u32 s48, 0
  s_cbranch_scc1 L_pf
  s_cmp_ge_u32 s40, 29
  s_cbranch_scc1 L_end
  s_cmp_ge_u32 s40, 28
  s_cbranch_scc1 L_hz
  s_sub_u32 s41, s40, 24
  s_mul_i32 s42, s41, 192
  s_mul_i32 s43, s3, 48
  s_add_u32 s42, s42, s43
  s_lshl_b32 s43, s42, 1
  s_add_u32 s44, s44, s43
  s_addc_u32 s45, s45, 0
  s_load_dwordx8 s[72:79], s[44:45], 0
  s_load_dwordx8 s[80:87], s[44:45], 32
  s_load_dwordx8 s[88:95], s[44:45], 64
  s_mul_i32 s42, s42, 384
  v_lshlrev_b32 v12, 3, v0
  v_cmp_gt_u32 vcc, 48, v0
  v_mov_b32 v13, 0x80000000
  s_nop 0
  v_cndmask_b32 v12, v13, v12, vcc
  buffer_load_dwordx2 v[104:105], v12, s[24:27], s42 offen offset:0
  buffer_load_dwordx2 v[106:107], v12, s[24:27], s42 offen offset:384
  buffer_load_dwordx2 v[108:109], v12, s[24:27], s42 offen offset:768
  buffer_load_dwordx2 v[110:111], v12, s[24:27], s42 offen offset:1152
  buffer_load_dwordx2 v[112:113], v12, s[24:27], s42 offen offset:1536
  buffer_load_dwordx2 v[114:115], v12, s[24:27], s42 offen offset:1920
  buffer_load_dwordx2 v[116:117], v12, s[24:27], s42 offen offset:2304
  buffer_load_dwordx2 v[118:119], v12, s[24:27], s42 offen offset:2688
  s_add_u32 s42, s42, 3072
  buffer_load_dwordx2 v[120:121], v12, s[24:27], s42 offen offset:0
  buffer_load_dwordx2 v[122:123], v12, s[24:27], s42 offen offset:384
  buffer_load_dwordx2 v[124:125], v12, s[24:27], s42 offen offset:768
  buffer_load_dwordx2 v[126:127], v12, s[24:27], s42 offen offset:1152
  buffer_load_dwordx2 v[128:129], v12, s[24:27], s42 offen offset:1536
  buffer_load_dwordx2 v[130:131], v12, s[24:27], s42 offen offset:1920
  buffer_load_dwordx2 v[132:133], v12, s[24:27], s42 offen offset:2304
  buffer_load_dwordx2 v[134:135], v12, s[24:27], s42 offen offset:2688
  s_add_u32 s42, s42, 3072
  buffer_load_dwordx2 v[136:137], v12, s[24:27], s42 offen offset:0
  buffer_load_dwordx2 v[138:139], v12, s[24:27], s42 offen offset:384
  buffer_load_dwordx2 v[140:141], v12, s[24:27], s42 offen offset:768
  buffer_load_dwordx2 v[142:143], v12, s[24:27], s42 offen offset:1152
  buffer_load_dwordx2 v[144:145], v12, s[24:27], s42 offen offset:1536
  buffer_load_dwordx2 v[146:147], v12, s[24:27], s42 offen offset:1920
  buffer_load_dwordx2 v[148:149], v12, s[24:27], s42 offen offset:2304
  buffer_load_dwordx2 v[150:151], v12, s[24:27], s42 offen offset:2688
  s_add_u32 s42, s42, 3072
  buffer_load_dwordx2 v[152:153], v12, s[24:27], s42 offen offset:0
  buffer_load_dwordx2 v[154:155], v12, s[24:27], s42 offen offset:384
  buffer_load_dwordx2 v[156:157], v12, s[24:27], s42 offen offset:768
  buffer_load_dwordx2 v[158:159], v12, s[24:27], s42 offen offset:1152
  buffer_load_dwordx2 v[160:161], v12, s[24:27], s42 offen offset:1536
  buffer_load_dwordx2 v[162:163], v12, s[24:27], s42 offen offset:1920
  buffer_load_dwordx2 v[164:165], v12, s[24:27], s42 offen offset:2304
  buffer_load_dwordx2 v[166:167], v12, s[24:27], s42 offen offset:2688
  s_add_u32 s42, s42, 3072
  buffer_load_dwordx2 v[168:169], v12, s[24:27], s42 offen offset:0
  buffer_load_dwordx2 v[170:171], v12, s[24:27], s42 offen offset:384
  buffer_load_dwordx2 v[172:173], v12, s[24:27], s42 offen offset:768
  buffer_load_dwordx2 v[174:175], v12, s[24:27], s42 offen offset:1152
  buffer_load_dwordx2 v[176:177], v12, s[24:27], s42 offen offset:1536
  buffer_load_dwordx2 v[178:179], v12, s[24:27], s42 offen offset:1920
  buffer_load_dwordx2 v[180:181], v12, s[24:27], s42 offen offset:2304
  buffer_load_dwordx2 v[182:183], v12, s[24:27], s42 offen offset:2688
  s_add_u32 s42, s42, 3072
  buffer_load_dwordx2 v[184:185], v12, s[24:27], s42 offen offset:0
  buffer_load_dwordx2 v[186:187], v12, s[24:27], s42 offen offset:384
  buffer_load_dwordx2 v[188:189], v12, s[24:27], s42 offen offset:768
  buffer_load_dwordx2 v[190:191], v12, s[24:27], s42 offen offset:1152
  buffer_load_dwordx2 v[192:193], v12, s[24:27], s42 offen offset:1536
  buffer_load_dwordx2 v[194:195], v12, s[24:27], s42 offen offset:1920
  buffer_load_dwordx2 v[196:197], v12, s[24:27], s42 offen offset:2304
  buffer_load_dwordx2 v[198:199], v12, s[24:27], s42 offen offset:2688
  s_add_u32 s42, s42, 3072
  v_mov_b32 v4, 0
  v_mov_b32 v5, 0
  v_mov_b32 v6, 0
  v_mov_b32 v7, 0
  s_waitcnt lgkmcnt(0)
  s_lshl_b32 s46, s72, 16
  s_waitcnt vmcnt(47)
  v_lshlrev_b32 v8, 16, v104
  v_and_b32 v9, 0xffff0000, v104
  v_fmac_f32 v4, s46, v8
  v_fmac_f32 v5, s46, v9
  v_lshlrev_b32 v8, 16, v105
  v_and_b32 v9, 0xffff0000, v105
  v_fmac_f32 v6, s46, v8
  v_fmac_f32 v7, s46, v9
  s_and_b32 s46, s72, 0xffff0000
  s_waitcnt vmcnt(46)
  v_lshlrev_b32 v8, 16, v106
  v_and_b32 v9, 0xffff0000, v106
  v_fmac_f32 v4, s46, v8
  v_fmac_f32 v5, s46, v9
  v_lshlrev_b32 v8, 16, v107
  v_and_b32 v9, 0xffff0000, v107
  v_fmac_f32 v6, s46, v8
  v_fmac_f32 v7, s46, v9
  s_lshl_b32 s46, s73, 16
  s_waitcnt vmcnt(45)
  v_lshlrev_b32 v8, 16, v108
  v_and_b32 v9, 0xffff0000, v108
  v_fmac_f32 v4, s46, v8
  v_fmac_f32 v5, s46, v9
  v_lshlrev_b32 v8, 16, v109
  v_and_b32 v9, 0xffff0000, v109
  v_fmac_f32 v6, s46, v8
  v_fmac_f32 v7, s46, v9
  s_and_b32 s46, s73, 0xffff0000
  s_waitcnt vmcnt(44)
  v_lshlrev_b32 v8, 16, v110
  v_and_b32 v9, 0xffff0000, v110
  v_fmac_f32 v4, s46, v8
  v_fmac_f32 v5, s46, v9
  v_lshlrev_b32 v8, 16, v111
  v_and_b32 v9, 0xffff0000, v111
  v_fmac_f32 v6, s46, v8
  v_fmac_f32 v7, s46, v9
  s_lshl_b32 s46, s74, 16
  s_waitcnt vmcnt(43)
  v_lshlrev_b32 v8, 16, v112
  v_and_b32 v9, 0xffff0000, v112
  v_fmac_f32 v4, s46, v8
  v_fmac_f32 v5, s46, v9
  v_lshlrev_b32 v8, 16, v113
  v_and_b32 v9, 0xffff0000, v113
  v_fmac_f32 v6, s46, v8
  v_fmac_f32 v7, s46, v9
  s_and_b32 s46, s74, 0xffff0000
  s_waitcnt vmcnt(42)
  v_lshlrev_b32 v8, 16, v114
  v_and_b32 v9, 0xffff0000, v114
  v_fmac_f32 v4, s46, v8
  v_fmac_f32 v5, s46, v9
  v_lshlrev_b32 v8, 16, v115
  v_and_b32 v9, 0xffff0000, v115
  v_fmac_f32 v6, s46, v8
  v_fmac_f32 v7, s46, v9
  s_lshl_b32 s46, s75, 16
  s_waitcnt vmcnt(41)
  v_lshlrev_b32 v8, 16, v116
  v_and_b32 v9, 0xffff0000, v116
  v_fmac_f32 v4, s46, v8
  v_fmac_f32 v5, s46, v9
  v_lshlrev_b32 v8, 16, v117
  v_and_b32 v9, 0xffff0000, v117
  v_fmac_f32 v6, s46, v8
  v_fmac_f32 v7, s46, v9
  s_and_b32 s46, s75, 0xffff0000
  s_waitcnt vmcnt(40)
  v_lshlrev_b32 v8, 16, v118
  v_and_b32 v9, 0xffff0000, v118
  v_fmac_f32 v4, s46, v8
  v_fmac_f32 v5, s46, v9
  v_lshlrev_b32 v8, 16, v119
  v_and_b32 v9, 0xffff0000, v119
  v_fmac_f32 v6, s46, v8
  v_fmac_f32 v7, s46, v9
  s_lshl_b32 s46, s76, 16
  s_waitcnt vmcnt(39)
  v_lshlrev_b32 v8, 16, v120
  v_and_b32 v9, 0xffff0000, v120
  v_fmac_f32 v4, s46, v8
  v_fmac_f32 v5, s46, v9
  v_lshlrev_b32 v8, 16, v121
  v_and_b32 v9, 0xffff0000, v121
  v_fmac_f32 v6, s46, v8
  v_fmac_f32 v7, s46, v9
  s_and_b32 s46, s76, 0xffff0000
  s_waitcnt vmcnt(38)
  v_lshlrev_b32 v8, 16, v122
  v_and_b32 v9, 0xffff0000, v122
  v_fmac_f32 v4, s46, v8
  v_fmac_f32 v5, s46, v9
  v_lshlrev_b32 v8, 16, v123
  v_and_b32 v9, 0xffff0000, v123
  v_fmac_f32 v6, s46, v8
  v_fmac_f32 v7, s46, v9
  s_lshl_b32 s46, s77, 16
  s_waitcnt vmcnt(37)
  v_lshlrev_b32 v8, 16, v124
  v_and_b32 v9, 0xffff0000, v124
  v_fmac_f32 v4, s46, v8
  v_fmac_f32 v5, s46, v9
  v_lshlrev_b32 v8, 16, v125
  v_and_b32 v9, 0xffff0000, v125
  v_fmac_f32 v6, s46, v8
  v_fmac_f32 v7, s46, v9
  s_and_b32 s46, s77, 0xffff0000
  s_waitcnt vmcnt(36)
  v_lshlrev_b32 v8, 16, v126
  v_and_b32 v9, 0xffff0000, v126
  v_fmac_f32 v4, s46, v8
  v_fmac_f32 v5, s46, v9
  v_lshlrev_b32 v8, 16, v127
  v_and_b32 v9, 0xffff0000, v127
  v_fmac_f32 v6, s46, v8
  v_fmac_f32 v7, s46, v9
  s_lshl_b32 s46, s78, 16
  s_waitcnt vmcnt(35)
  v_lshlrev_b32 v8, 16, v128
  v_and_b32 v9, 0xffff0000, v128
  v_fmac_f32 v4, s46, v8
  v_fmac_f32 v5, s46, v9
  v_lshlrev_b32 v8, 16, v129
  v_and_b32 v9, 0xffff0000, v129
  v_fmac_f32 v6, s46, v8
  v_fmac_f32 v7, s46, v9
  s_and_b32 s46, s78, 0xffff0000
  s_waitcnt vmcnt(34)
  v_lshlrev_b32 v8, 16, v130
  v_and_b32 v9, 0xffff0000, v130
  v_fmac_f32 v4, s46, v8
  v_fmac_f32 v5, s46, v9
  v_lshlrev_b32 v8, 16, v131
  v_and_b32 v9, 0xffff0000, v131
  v_fmac_f32 v6, s46, v8
  v_fmac_f32 v7, s46, v9
  s_lshl_b32 s46, s79, 16
  s_waitcnt vmcnt(33)
  v_lshlrev_b32 v8, 16, v132
  v_and_b32 v9, 0xffff0000, v132
  v_fmac_f32 v4, s46, v8
  v_fmac_f32 v5, s46, v9
  v_lshlrev_b32 v8, 16, v133
  v_and_b32 v9, 0xffff0000, v133
  v_fmac_f32 v6, s46, v8
  v_fmac_f32 v7, s46, v9
  s_and_b32 s46, s79, 0xffff0000
  s_waitcnt vmcnt(32)
  v_lshlrev_b32 v8, 16, v134
  v_and_b32 v9, 0xffff0000, v134
  v_fmac_f32 v4, s46, v8
  v_fmac_f32 v5, s46, v9
  v_lshlrev_b32 v8, 16, v135
  v_and_b32 v9, 0xffff0000, v135
  v_fmac_f32 v6, s46, v8
  v_fmac_f32 v7, s46, v9
  s_lshl_b32 s46, s80, 16
  s_waitcnt vmcnt(31)
  v_lshlrev_b32 v8, 16, v136
  v_and_b32 v9, 0xffff0000, v136
  v_fmac_f32 v4, s46, v8
  v_fmac_f32 v5, s46, v9
  v_lshlrev_b32 v8, 16, v137
  v_and_b32 v9, 0xffff0000, v137
  v_fmac_f32 v6, s46, v8
  v_fmac_f32 v7, s46, v9
  s_and_b32 s46, s80, 0xffff0000
  s_waitcnt vmcnt(30)
  v_lshlrev_b32 v8, 16, v138
  v_and_b32 v9, 0xffff0000, v138
  v_fmac_f32 v4, s46, v8
  v_fmac_f32 v5, s46, v9
  v_lshlrev_b32 v8, 16, v139
  v_and_b32 v9, 0xffff0000, v139
  v_fmac_f32 v6, s46, v8
  v_fmac_f32 v7, s46, v9
  s_lshl_b32 s46, s81, 16
  s_waitcnt vmcnt(29)
  v_lshlrev_b32 v8, 16, v140
  v_and_b32 v9, 0xffff0000, v140
  v_fmac_f32 v4, s46, v8
  v_fmac_f32 v5, s46, v9
  v_lshlrev_b32 v8, 16, v141
  v_and_b32 v9, 0xffff0000, v141
  v_fmac_f32 v6, s46, v8
  v_fmac_f32 v7, s46, v9
  s_and_b32 s46, s81, 0xffff0000
  s_waitcnt vmcnt(28)
  v_lshlrev_b32 v8, 16, v142
  v_and_b32 v9, 0xffff0000, v142
  v_fmac_f32 v4, s46, v8
  v_fmac_f32 v5, s46, v9
  v_lshlrev_b32 v8, 16, v143
  v_and_b32 v9, 0xffff0000, v143
  v_fmac_f32 v6, s46, v8
  v_fmac_f32 v7, s46, v9
  s_lshl_b32 s46, s82, 16
  s_waitcnt vmcnt(27)
  v_lshlrev_b32 v8, 16, v144
  v_and_b32 v9, 0xffff0000, v144
  v_fmac_f32 v4, s46, v8
  v_fmac_f32 v5, s46, v9
  v_lshlrev_b32 v8, 16, v145
  v_and_b32 v9, 0xffff0000, v145
  v_fmac_f32 v6, s46, v8
  v_fmac_f32 v7, s46, v9
  s_and_b32 s46, s82, 0xffff0000
  s_waitcnt vmcnt(26)
  v_lshlrev_b32 v8, 16, v146
  v_and_b32 v9, 0xffff0000, v146
  v_fmac_f32 v4, s46, v8
  v_fmac_f32 v5, s46, v9
  v_lshlrev_b32 v8, 16, v147
  v_and_b32 v9, 0xffff0000, v147
  v_fmac_f32 v6, s46, v8
  v_fmac_f32 v7, s46, v9
  s_lshl_b32 s46, s83, 16
  s_waitcnt vmcnt(25)
  v_lshlrev_b32 v8, 16, v148
  v_and_b32 v9, 0xffff0000, v148
  v_fmac_f32 v4, s46, v8
  v_fmac_f32 v5, s46, v9
  v_lshlrev_b32 v8, 16, v149
  v_and_b32 v9, 0xffff0000, v149
  v_fmac_f32 v6, s46, v8
  v_fmac_f32 v7, s46, v9
  s_and_b32 s46, s83, 0xffff0000
  s_waitcnt vmcnt(24)
  v_lshlrev_b32 v8, 16, v150
  v_and_b32 v9, 0xffff0000, v150
  v_fmac_f32 v4, s46, v8
  v_fmac_f32 v5, s46, v9
  v_lshlrev_b32 v8, 16, v151
  v_and_b32 v9, 0xffff0000, v151
  v_fmac_f32 v6, s46, v8
  v_fmac_f32 v7, s46, v9
  s_lshl_b32 s46, s84, 16
  s_waitcnt vmcnt(23)
  v_lshlrev_b32 v8, 16, v152
  v_and_b32 v9, 0xffff0000, v152
  v_fmac_f32 v4, s46, v8
  v_fmac_f32 v5, s46, v9
  v_lshlrev_b32 v8, 16, v153
  v_and_b32 v9, 0xffff0000, v153
  v_fmac_f32 v6, s46, v8
  v_fmac_f32 v7, s46, v9
  s_and_b32 s46, s84, 0xffff0000
  s_waitcnt vmcnt(22)
  v_lshlrev_b32 v8, 16, v154
  v_and_b32 v9, 0xffff0000, v154
  v_fmac_f32 v4, s46, v8
  v_fmac_f32 v5, s46, v9
  v_lshlrev_b32 v8, 16, v155
  v_and_b32 v9, 0xffff0000, v155
  v_fmac_f32 v6, s46, v8
  v_fmac_f32 v7, s46, v9
  s_lshl_b32 s46, s85, 16
  s_waitcnt vmcnt(21)
  v_lshlrev_b32 v8, 16, v156
  v_and_b32 v9, 0xffff0000, v156
  v_fmac_f32 v4, s46, v8
  v_fmac_f32 v5, s46, v9
  v_lshlrev_b32 v8, 16, v157
  v_and_b32 v9, 0xffff0000, v157
  v_fmac_f32 v6, s46, v8
  v_fmac_f32 v7, s46, v9
  s_and_b32 s46, s85, 0xffff0000
  s_waitcnt vmcnt(20)
  v_lshlrev_b32 v8, 16, v158
  v_and_b32 v9, 0xffff0000, v158
  v_fmac_f32 v4, s46, v8
  v_fmac_f32 v5, s46, v9
  v_lshlrev_b32 v8, 16, v159
  v_and_b32 v9, 0xffff0000, v159
  v_fmac_f32 v6, s46, v8
  v_fmac_f32 v7, s46, v9
  s_lshl_b32 s46, s86, 16
  s_waitcnt vmcnt(19)
  v_lshlrev_b32 v8, 16, v160
  v_and_b32 v9, 0xffff0000, v160
  v_fmac_f32 v4, s46, v8
  v_fmac_f32 v5, s46, v9
  v_lshlrev_b32 v8, 16, v161
  v_and_b32 v9, 0xffff0000, v161
  v_fmac_f32 v6, s46, v8
  v_fmac_f32 v7, s46, v9
  s_and_b32 s46, s86, 0xffff0000
  s_waitcnt vmcnt(18)
  v_lshlrev_b32 v8, 16, v162
  v_and_b32 v9, 0xffff0000, v162
  v_fmac_f32 v4, s46, v8
  v_fmac_f32 v5, s46, v9
  v_lshlrev_b32 v8, 16, v163
  v_and_b32 v9, 0xffff0000, v163
  v_fmac_f32 v6, s46, v8
  v_fmac_f32 v7, s46, v9
  s_lshl_b32 s46, s87, 16
  s_waitcnt vmcnt(17)
  v_lshlrev_b32 v8, 16, v164
  v_and_b32 v9, 0xffff0000, v164
  v_fmac_f32 v4, s46, v8
  v_fmac_f32 v5, s46, v9
  v_lshlrev_b32 v8, 16, v165
  v_and_b32 v9, 0xffff0000, v165
  v_fmac_f32 v6, s46, v8
  v_fmac_f32 v7, s46, v9
  s_and_b32 s46, s87, 0xffff0000
  s_waitcnt vmcnt(16)
  v_lshlrev_b32 v8, 16, v166
  v_and_b32 v9, 0xffff0000, v166
  v_fmac_f32 v4, s46, v8
  v_fmac_f32 v5, s46, v9
  v_lshlrev_b32 v8, 16, v167
  v_and_b32 v9, 0xffff0000, v167
  v_fmac_f32 v6, s46, v8
  v_fmac_f32 v7, s46, v9
  s_lshl_b32 s46, s88, 16
  s_waitcnt vmcnt(15)
  v_lshlrev_b32 v8, 16, v168
  v_and_b32 v9, 0xffff0000, v168
  v_fmac_f32 v4, s46, v8
  v_fmac_f32 v5, s46, v9
  v_lshlrev_b32 v8, 16, v169
  v_and_b32 v9, 0xffff0000, v169
  v_fmac_f32 v6, s46, v8
  v_fmac_f32 v7, s46, v9
  s_and_b32 s46, s88, 0xffff0000
  s_waitcnt vmcnt(14)
  v_lshlrev_b32 v8, 16, v170
  v_and_b32 v9, 0xffff0000, v170
  v_fmac_f32 v4, s46, v8
  v_fmac_f32 v5, s46, v9
  v_lshlrev_b32 v8, 16, v171
  v_and_b32 v9, 0xffff0000, v171
  v_fmac_f32 v6, s46, v8
  v_fmac_f32 v7, s46, v9
  s_lshl_b32 s46, s89, 16
  s_waitcnt vmcnt(13)
  v_lshlrev_b32 v8, 16, v172
  v_and_b32 v9, 0xffff0000, v172
  v_fmac_f32 v4, s46, v8
  v_fmac_f32 v5, s46, v9
  v_lshlrev_b32 v8, 16, v173
  v_and_b32 v9, 0xffff0000, v173
  v_fmac_f32 v6, s46, v8
  v_fmac_f32 v7, s46, v9
  s_and_b32 s46, s89, 0xffff0000
  s_waitcnt vmcnt(12)
  v_lshlrev_b32 v8, 16, v174
  v_and_b32 v9, 0xffff0000, v174
  v_fmac_f32 v4, s46, v8
  v_fmac_f32 v5, s46, v9
  v_lshlrev_b32 v8, 16, v175
  v_and_b32 v9, 0xffff0000, v175
  v_fmac_f32 v6, s46, v8
  v_fmac_f32 v7, s46, v9
  s_lshl_b32 s46, s90, 16
  s_waitcnt vmcnt(11)
  v_lshlrev_b32 v8, 16, v176
  v_and_b32 v9, 0xffff0000, v176
  v_fmac_f32 v4, s46, v8
  v_fmac_f32 v5, s46, v9
  v_lshlrev_b32 v8, 16, v177
  v_and_b32 v9, 0xffff0000, v177
  v_fmac_f32 v6, s46, v8
  v_fmac_f32 v7, s46, v9
  s_and_b32 s46, s90, 0xffff0000
  s_waitcnt vmcnt(10)
  v_lshlrev_b32 v8, 16, v178
  v_and_b32 v9, 0xffff0000, v178
  v_fmac_f32 v4, s46, v8
  v_fmac_f32 v5, s46, v9
  v_lshlrev_b32 v8, 16, v179
  v_and_b32 v9, 0xffff0000, v179
  v_fmac_f32 v6, s46, v8
  v_fmac_f32 v7, s46, v9
  s_lshl_b32 s46, s91, 16
  s_waitcnt vmcnt(9)
  v_lshlrev_b32 v8, 16, v180
  v_and_b32 v9, 0xffff0000, v180
  v_fmac_f32 v4, s46, v8
  v_fmac_f32 v5, s46, v9
  v_lshlrev_b32 v8, 16, v181
  v_and_b32 v9, 0xffff0000, v181
  v_fmac_f32 v6, s46, v8
  v_fmac_f32 v7, s46, v9
  s_and_b32 s46, s91, 0xffff0000
  s_waitcnt vmcnt(8)
  v_lshlrev_b32 v8, 16, v182
  v_and_b32 v9, 0xffff0000, v182
  v_fmac_f32 v4, s46, v8
  v_fmac_f32 v5, s46, v9
  v_lshlrev_b32 v8, 16, v183
  v_and_b32 v9, 0xffff0000, v183
  v_fmac_f32 v6, s46, v8
  v_fmac_f32 v7, s46, v9
  s_lshl_b32 s46, s92, 16
  s_waitcnt vmcnt(7)
  v_lshlrev_b32 v8, 16, v184
  v_and_b32 v9, 0xffff0000, v184
  v_fmac_f32 v4, s46, v8
  v_fmac_f32 v5, s46, v9
  v_lshlrev_b32 v8, 16, v185
  v_and_b32 v9, 0xffff0000, v185
  v_fmac_f32 v6, s46, v8
  v_fmac_f32 v7, s46, v9
  s_and_b32 s46, s92, 0xffff0000
  s_waitcnt vmcnt(6)
  v_lshlrev_b32 v8, 16, v186
  v_and_b32 v9, 0xffff0000, v186
  v_fmac_f32 v4, s46, v8
  v_fmac_f32 v5, s46, v9
  v_lshlrev_b32 v8, 16, v187
  v_and_b32 v9, 0xffff0000, v187
  v_fmac_f32 v6, s46, v8
  v_fmac_f32 v7, s46, v9
  s_lshl_b32 s46, s93, 16
  s_waitcnt vmcnt(5)
  v_lshlrev_b32 v8, 16, v188
  v_and_b32 v9, 0xffff0000, v188
  v_fmac_f32 v4, s46, v8
  v_fmac_f32 v5, s46, v9
  v_lshlrev_b32 v8, 16, v189
  v_and_b32 v9, 0xffff0000, v189
  v_fmac_f32 v6, s46, v8
  v_fmac_f32 v7, s46, v9
  s_and_b32 s46, s93, 0xffff0000
  s_waitcnt vmcnt(4)
  v_lshlrev_b32 v8, 16, v190
  v_and_b32 v9, 0xffff0000, v190
  v_fmac_f32 v4, s46, v8
  v_fmac_f32 v5, s46, v9
  v_lshlrev_b32 v8, 16, v191
  v_and_b32 v9, 0xffff0000, v191
  v_fmac_f32 v6, s46, v8
  v_fmac_f32 v7, s46, v9
  s_lshl_b32 s46, s94, 16
  s_waitcnt vmcnt(3)
  v_lshlrev_b32 v8, 16, v192
  v_and_b32 v9, 0xffff0000, v192
  v_fmac_f32 v4, s46, v8
  v_fmac_f32 v5, s46, v9
  v_lshlrev_b32 v8, 16, v193
  v_and_b32 v9, 0xffff0000, v193
  v_fmac_f32 v6, s46, v8
  v_fmac_f32 v7, s46, v9
  s_and_b32 s46, s94, 0xffff0000
  s_waitcnt vmcnt(2)
  v_lshlrev_b32 v8, 16, v194
  v_and_b32 v9, 0xffff0000, v194
  v_fmac_f32 v4, s46, v8
  v_fmac_f32 v5, s46, v9
  v_lshlrev_b32 v8, 16, v195
  v_and_b32 v9, 0xffff0000, v195
  v_fmac_f32 v6, s46, v8
  v_fmac_f32 v7, s46, v9
  s_lshl_b32 s46, s95, 16
  s_waitcnt vmcnt(1)
  v_lshlrev_b32 v8, 16, v196
  v_and_b32 v9, 0xffff0000, v196
  v_fmac_f32 v4, s46, v8
  v_fmac_f32 v5, s46, v9
  v_lshlrev_b32 v8, 16, v197
  v_and_b32 v9, 0xffff0000, v197
  v_fmac_f32 v6, s46, v8
  v_fmac_f32 v7, s46, v9
  s_and_b32 s46, s95, 0xffff0000
  s_waitcnt vmcnt(0)
  v_lshlrev_b32 v8, 16, v198
  v_and_b32 v9, 0xffff0000, v198
  v_fmac_f32 v4, s46, v8
  v_fmac_f32 v5, s46, v9
  v_lshlrev_b32 v8, 16, v199
  v_and_b32 v9, 0xffff0000, v199
  v_fmac_f32 v6, s46, v8
  v_fmac_f32 v7, s46, v9
  s_lshl_b32 s46, s3, 10
  v_add_u32 v10, s46, v248
  ds_write_b128 v10, v[4:7]
  s_waitcnt lgkmcnt(0)
  s_barrier
  ds_read_b128 v[16:19], v248 offset:0
  ds_read_b128 v[20:23], v248 offset:1024
  ds_read_b128 v[24:27], v248 offset:2048
  ds_read_b128 v[28:31], v248 offset:3072
  s_waitcnt lgkmcnt(2)
  v_add_f32 v16, v16, v20
  v_add_f32 v17, v17, v21
  v_add_f32 v18, v18, v22
  v_add_f32 v19, v19, v23
  s_waitcnt lgkmcnt(1)
  v_add_f32 v16, v16, v24
  v_add_f32 v17, v17, v25
  v_add_f32 v18, v18, v26
  v_add_f32 v19, v19, v27
  s_waitcnt lgkmcnt(0)
  v_add_f32 v16, v16, v28
  v_add_f32 v17, v17, v29
  v_add_f32 v18, v18, v30
  v_add_f32 v19, v19, v31
  v_cndmask_b32 v12, v13, v248, vcc
  s_mul_i32 s46, s41, 768
  s_add_u32 s46, s46, 884736
  s_cmp_lg_u32 s3, 0
  s_cbranch_scc1 L_hdone
  buffer_store_dwordx4 v[16:19], v12, s[20:23], s46 offen sc1
  s_branch L_hdone
L_hz:
  v_mov_b32 v4, 0
  v_mov_b32 v5, 0
  v_mov_b32 v6, 0
  v_mov_b32 v7, 0
  s_lshl_b32 s46, s3, 10
  s_add_u32 s46, s46, 888832
  buffer_store_dwordx4 v[4:7], v248, s[20:23], s46 offen sc1
  s_add_u32 s46, s46, 4096
  buffer_store_dwordx4 v[4:7], v248, s[20:23], s46 offen sc1
  s_add_u32 s46, s46, 4096
  buffer_store_dwordx4 v[4:7], v248, s[20:23], s46 offen sc1
  s_add_u32 s46, s46, 4096
  buffer_store_dwordx4 v[4:7], v248, s[20:23], s46 offen sc1
  s_add_u32 s46, s46, 4096
  buffer_store_dwordx4 v[4:7], v248, s[20:23], s46 offen sc1
  s_add_u32 s46, s46, 4096
  buffer_store_dwordx4 v[4:7], v248, s[20:23], s46 offen sc1
  s_add_u32 s46, s46, 4096
  v_mov_b32 v8, -1
  v_mov_b32 v9, -1
  v_mov_b32 v10, -1
  v_mov_b32 v11, -1
  buffer_store_dwordx4 v[8:11], v248, s[20:23], s46 offen sc1
L_hdone:
  s_waitcnt vmcnt(0) lgkmcnt(0)
  s_barrier
  s_cmp_lg_u32 s3, 0
  s_cbranch_scc1 L_end
  v_mov_b32 v4, 1
  v_mov_b32 v5, 0
  s_mov_b64 exec, 1
  buffer_atomic_add v4, v5, s[32:35], 0 offen sc1
L_hst:
L_end:
  s_endpgm
L_endw:
  s_waitcnt vmcnt(0)
  s_endpgm
L_fin:
.section .rodata,"a"
.p2align 6
.amdhsa_kernel standalone__modern_conv_block_convnext_v2__vision_kernel
  .amdhsa_next_free_vgpr 512
  .amdhsa_next_free_sgpr 102
  .amdhsa_accum_offset 256
  .amdhsa_group_segment_fixed_size 0
  .amdhsa_kernarg_size 72
  .amdhsa_user_sgpr_count 2
  .amdhsa_user_sgpr_kernarg_segment_ptr 1
  .amdhsa_system_sgpr_workgroup_id_x 1
.end_amdhsa_kernel
```
